```python
import torch

def _softmax(x, axis=-1):
    return torch.softmax(x, dim=axis)

def _gelu(x):
    return torch.nn.functional.gelu(x, approximate='tanh')

def _silu(x):
    return torch.nn.functional.silu(x)

def _sigmoid(x):
    return torch.sigmoid(x)

def _layernorm(x, axis=-1, eps=1e-05):
    m = x.mean(dim=axis, keepdim=True)
    v = x.var(dim=axis, keepdim=True, unbiased=False)
    return (x - m) / torch.sqrt(v + eps)

def _scatter_add(tgt, idx, src, axis=0):
    return tgt.clone().index_add_(axis, idx, src)

def _segment_sum(src, seg, n):
    out = torch.zeros((n,) + src.shape[1:], dtype=src.dtype)
    return out.index_add_(0, seg, src)

def _pad(x, pw):
    flat = tuple((v for pair in reversed(pw) for v in pair))
    return torch.nn.functional.pad(x, flat)
kernel_name = 'sequential_preLN__ssm_conv_s4__mixer_gmlp__prompt'

def setup_inputs():

    _w = lambda a: (lambda t: t.to(torch.bfloat16) if t.is_floating_point() else t)(torch.as_tensor(a))

    def _A_setup():
        B, L, D, N = (1, 2048, 640, 192)
        A_re = -(lambda _x: torch.exp(torch.as_tensor(_x)))((lambda *s: torch.randn(*s, dtype=torch.bfloat16) * 3.2)(D, N))
        A_im = torch.pi * (lambda *s: torch.randn(*s, dtype=torch.bfloat16) * 0.05)(D, N)
        B_re = (lambda *s: torch.randn(*s, dtype=torch.bfloat16) * 0.1)(D, N)
        B_im = (lambda *s: torch.randn(*s, dtype=torch.bfloat16) * 0.05)(D, N)
        C_re = (lambda *s: torch.randn(*s, dtype=torch.bfloat16) * 0.05)(D, N)
        C_im = (lambda *s: torch.randn(*s, dtype=torch.bfloat16) * 0.05)(D, N)
        log_dt = (lambda *s: torch.randn(*s, dtype=torch.bfloat16) * 0.05)(D) * 0.5 - 4.0
        Dskip = (lambda *s: torch.randn(*s, dtype=torch.bfloat16) * 0.05)(D)
        return {'u': _w((lambda *s: torch.randn(*s, dtype=torch.bfloat16) * 0.05)(B, L, D)), 'A_re': _w(A_re), 'A_im': _w(A_im), 'B_re': _w(B_re), 'B_im': _w(B_im), 'C_re': _w(C_re), 'C_im': _w(C_im), 'log_dt': _w(log_dt), 'Dskip': _w(Dskip)}
    _A_in = _A_setup()

    def _B_setup():
        B, S, D, F = (1, 2048, 640, 1536)
        Fh = F // 2
        return {'x': _w((lambda *s: torch.randn(*s, dtype=torch.bfloat16) * 0.05)(B, S, D)), 'w_in': _w((lambda *s: torch.randn(*s, dtype=torch.bfloat16) * 0.4)(D, 2 * Fh)), 'w_sp': _w(0.01 * (lambda *s: torch.randn(*s, dtype=torch.bfloat16) * 0.4)(S, S)), 'b_sp': _w(1.0 + 0.01 * (lambda *s: torch.randn(*s, dtype=torch.bfloat16) * 0.05)(S)), 'w_out': _w((lambda *s: torch.randn(*s, dtype=torch.bfloat16) * 0.05)(Fh, D))}
    _B_in = _B_setup()
    return {'A_u': _A_in['u'], 'A_A_re': _A_in['A_re'], 'A_A_im': _A_in['A_im'], 'A_B_re': _A_in['B_re'], 'A_B_im': _A_in['B_im'], 'A_C_re': _A_in['C_re'], 'A_C_im': _A_in['C_im'], 'A_log_dt': _A_in['log_dt'], 'A_Dskip': _A_in['Dskip'], 'B_x': _B_in['x'], 'B_w_in': _B_in['w_in'], 'B_w_sp': _B_in['w_sp'], 'B_b_sp': _B_in['b_sp'], 'B_w_out': _B_in['w_out']}

def reference(A_u, A_A_re, A_A_im, A_B_re, A_B_im, A_C_re, A_C_im, A_log_dt, A_Dskip, B_x, B_w_in, B_w_sp, B_b_sp, B_w_out):

    def _A_ref(u, A_re, A_im, B_re, B_im, C_re, C_im, log_dt, Dskip):
        Bsz, L, D = u.shape
        dt = torch.exp(log_dt)[:, None]
        A = A_re + 1j * A_im
        Bc = B_re + 1j * B_im
        Cc = C_re + 1j * C_im
        logdA = dt * A
        dB = dt * Bc
        l = (lambda x, dt: x.to(dt))(torch.arange(L), A_re.dtype)
        P = torch.exp(logdA[:, :, None] * l[None, None, :])
        K = torch.einsum('dn,dnl,dn->dl', Cc, P, dB).real
        L2 = 2 * L
        Kp = _pad(K, ((0, 0), (0, L)))
        up = (lambda x, *d: x.permute(*d))(u, 0, 2, 1)
        up = _pad(up, ((0, 0), (0, 0), (0, L)))
        Kf = (lambda x, axes=(-2, -1): torch.fft.rfft2(x.float(), dim=axes))(Kp[:, None, :], axes=(-2, -1))
        Uf = (lambda x, axes=(-2, -1): torch.fft.rfft2(x.float(), dim=axes))(up[:, :, None, :], axes=(-2, -1))
        Yf = Uf * Kf[None, :, :, :]
        y = (lambda x, s, axes=(-2, -1): torch.fft.irfft2(x, s=s, dim=axes).to(torch.bfloat16))(Yf, (1, L2), axes=(-2, -1))[:, :, 0, :L]
        y = (lambda x, *d: x.permute(*d))(y, 0, 2, 1) + u * Dskip[None, None, :]
        return y

    def _B_ref(x, w_in, w_sp, b_sp, w_out):
        B, S, D = x.shape
        F = w_in.shape[-1]
        Fh = F // 2
        z = _gelu(torch.einsum('bsd,df->bsf', x, w_in))
        z1 = z[..., :Fh].clone()
        z2 = _layernorm(z[..., Fh:], axis=-1)
        g = torch.einsum('ts,bsf->btf', w_sp, z2) + b_sp[None, :, None]
        return torch.einsum('bsf,fd->bsd', z1 * g, w_out)
    x = A_u
    h = x + _A_ref(_layernorm(x, axis=-1), A_A_re, A_A_im, A_B_re, A_B_im, A_C_re, A_C_im, A_log_dt, A_Dskip)
    h2 = h + _B_ref(_layernorm(h, axis=-1), B_w_in, B_w_sp, B_b_sp, B_w_out)
    return h2
```

```asm
; @launch grid=(256,1,1) block=(256,1,1) lds=163840
.amdgcn_target "amdgcn-amd-amdhsa--gfx950"
.text
.globl sequential_preLN__ssm_conv_s4__mixer_gmlp__prompt_kernel
.p2align 8
.type sequential_preLN__ssm_conv_s4__mixer_gmlp__prompt_kernel,@function
sequential_preLN__ssm_conv_s4__mixer_gmlp__prompt_kernel:
    s_load_dwordx16 s[36:51], s[0:1], 0
    s_load_dwordx16 s[52:67], s[0:1], 64
    s_load_dwordx2 s[68:69], s[0:1], 128
    s_cmp_lt_u32 s2, 224
    s_cbranch_scc1 L_e1
    s_cmp_ge_u32 s2, 256
    s_cbranch_scc1 L_end
    s_getpc_b64 s[30:31]
    s_and_b32 s3, s2, 24
    s_lshl_b32 s3, s3, 4
    v_min_u32 v7, 95, v0
    v_lshl_add_u32 v7, v7, 9, s3
    global_load_dword v14, v7, s[30:31]
L_e1:
    v_mov_b32 v1, v0
    v_lshrrev_b32 v4, 6, v0
    v_and_b32 v0, 63, v0
    v_readfirstlane_b32 s20, v4
    s_and_b32 s21, s2, 7
    s_lshr_b32 s22, s2, 3
    s_cmp_lt_u32 s2, 160
    s_cbranch_scc1 L_conv
    s_sub_u32 s23, s2, 160
    s_cmp_ge_u32 s23, 64
    s_cbranch_scc1 L_nostat
    s_lshl_b32 s24, s23, 5
    v_lshrrev_b32 v3, 3, v1
    v_add_u32_e64 v3, s24, v3
    v_mul_u32_u24 v7, 1280, v3
    v_and_b32 v14, 7, v0
    v_lshl_add_u32 v7, v14, 4, v7
    s_waitcnt lgkmcnt(0)
    global_load_dwordx4 v[16:19], v7, s[36:37] offset:0
    global_load_dwordx4 v[20:23], v7, s[36:37] offset:128
    global_load_dwordx4 v[24:27], v7, s[36:37] offset:256
    global_load_dwordx4 v[28:31], v7, s[36:37] offset:384
    global_load_dwordx4 v[32:35], v7, s[36:37] offset:512
    global_load_dwordx4 v[36:39], v7, s[36:37] offset:640
    global_load_dwordx4 v[40:43], v7, s[36:37] offset:768
    global_load_dwordx4 v[44:47], v7, s[36:37] offset:896
    global_load_dwordx4 v[48:51], v7, s[36:37] offset:1024
    global_load_dwordx4 v[52:55], v7, s[36:37] offset:1152
    s_branch L_help
L_conv:
    s_mul_i32 s23, s21, 20
    s_add_u32 s23, s23, s22
    s_lshl_b32 s24, s23, 2
    s_add_u32 s24, s24, s20
    s_mul_i32 s25, s24, 384
    v_lshl_add_u32 v7, v0, 1, s25
    v_lshl_add_u32 v14, v0, 2, s25
    s_lshl_b32 s25, s24, 1
    v_mov_b32 v15, s25
    v_mov_b32 v28, 0
    v_mov_b32_e64 v22, 0
    v_mov_b32 v23, 0
    v_mov_b32 v24, 0
    v_mov_b32 v25, 0
    v_mov_b32 v26, 0
    v_mov_b32 v27, 0
    s_lshl_b32 s25, s23, 3
    v_mul_u32_u24 v208, 2560, v1
    v_add_u32_e64 v208, s25, v208
    s_and_b32 s4, s22, 3
    s_xor_b32 s5, s4, 1
    s_xor_b32 s6, s4, 2
    s_xor_b32 s7, s4, 3
    s_mul_i32 s16, s4, 655360
    s_mul_i32 s17, s5, 655360
    s_mul_i32 s18, s6, 655360
    s_mul_i32 s19, s7, 655360
    v_add_u32 v4, s16, v208
    s_waitcnt lgkmcnt(0)
    s_load_dwordx2 s[30:31], s[52:53], s25
    global_load_short_d16_hi v28, v15, s[50:51]
    global_load_short_d16_hi v22, v7, s[38:39] offset:256
    global_load_short_d16_hi v23, v7, s[40:41] offset:256
    global_load_short_d16_hi v24, v7, s[42:43] offset:256
    global_load_short_d16_hi v25, v7, s[44:45] offset:256
    global_load_short_d16_hi v26, v7, s[46:47] offset:256
    global_load_short_d16_hi v27, v7, s[48:49] offset:256
    global_load_dword v16, v14, s[38:39]
    global_load_dword v17, v14, s[40:41]
    global_load_dword v18, v14, s[42:43]
    global_load_dword v19, v14, s[44:45]
    global_load_dword v20, v14, s[46:47]
    global_load_dword v21, v14, s[48:49]
    s_barrier
    global_load_dwordx2 v[180:181], v4, s[36:37]
    v_lshlrev_b32 v2, 4, v0
    v_and_b32 v5, 15, v0
    v_lshrrev_b32 v6, 4, v0
    s_lshr_b32 s80, s21, 1
    s_and_b32 s79, s21, 1
    s_and_b32 s81, s22, 7
    s_lshr_b32 s82, s22, 3
    s_lshr_b32 s83, s81, 1
    s_add_u32 s82, s82, s83
    s_and_b32 s82, s82, 3
    s_lshl_b32 s70, s80, 2
    s_add_u32 s70, s70, s82
    s_lshl_b32 s71, s81, 1
    s_add_u32 s71, s71, s79
    s_lshl_b32 s72, s70, 1
    s_add_u32 s72, s72, s79
    s_mov_b32 s73, s81
    s_lshl_b32 s89, s80, 10
    s_add_u32 s89, s89, s79
    s_lshl_b32 s89, s89, 11
    s_lshl_b32 s78, s70, 2
    s_add_u32 s78, s78, s20
    s_lshl_b32 s74, s78, 17
    s_lshl_b32 s79, s79, 11
    s_add_u32 s74, s74, s79
    s_lshl_b32 s85, s78, 4
    s_add_u32 s85, s85, s71
    s_mul_i32 s86, s85, 3072
    s_add_u32 s86, s86, 12582912
    s_xor_b32 s87, s85, 1
    s_mul_i32 s87, s87, 3072
    s_add_u32 s87, s87, 12582912
    v_lshrrev_b32 v8, 3, v0
    v_lshrrev_b32 v9, 1, v8
    v_and_b32 v10, 7, v0
    v_xor_b32 v10, v10, v9
    v_lshlrev_b32 v8, 13, v8
    v_lshl_add_u32 v8, v10, 4, v8
    v_add_u32 v8, s74, v8
    v_xor_b32 v9, 64, v8
    v_add_u32 v10, 4096-2048, v8
    v_add_u32 v11, 65536+4096-3072, v9
    v_add_u32 v9, 65536-1024, v9
    s_mul_i32 s75, s20, 16384
    s_add_u32 s75, s75, 88064
    v_lshrrev_b32_e64 v12, 1, v5
    v_xor_b32 v12, v12, v6
    v_lshlrev_b32 v12, 4, v12
    v_lshl_add_u32 v12, v5, 7, v12
    v_add_u32 v12, s75, v12
    v_xor_b32 v13, 64, v12
    s_mul_i32 s26, s20, 17408
    s_mov_b32 m0, s26
    v_and_b32 v7, 31, v0
    v_mul_u32_u24 v7, 272, v7
    v_lshrrev_b32_e64 v14, 5, v0
    v_lshl_add_u32 v7, v14, 4, v7
    v_add_u32_e64 v7, s26, v7
    v_mov_b32 v48, 0x3f80
    v_mov_b32 v50, 0
    v_mov_b32 v51, 0
    s_mul_i32 s27, s20, 4608
    s_add_u32 s27, s27, 69632
    v_lshl_add_u32 v52, v0, 3, s27
    ds_write_addtid_b32 v48 offset:8704
    ds_write_b64 v52, v[50:51]
    v_add_u32 v14, 1, v5
    v_lshrrev_b32 v14, 1, v14
    v_lshlrev_b32_e64 v14, 2, v14
    v_lshl_add_u32 v14, v6, 4, v14
    v_and_b32_e64 v15, 1, v5
    v_mul_u32_u24 v15, 4160, v15
    v_add_u32_e64 v14, v14, v15
    s_add_u32 s28, s26, 7312
    v_sub_u32_e64 v244, s28, v14
    v_subrev_u32 v245, 1024, v244
    v_subrev_u32 v246, 2048, v244
    v_lshlrev_b32 v14, 2, v5
    v_lshlrev_b32 v15, 4, v6
    v_sub_u32 v14, v15, v14
    s_add_u32 s28, s26, 60
    v_add_u32 v247, s28, v14
    v_lshlrev_b32 v14, 5, v5
    v_lshlrev_b32 v15, 4, v6
    v_sub_u32 v14, v14, v15
    s_add_u32 s28, s27, 80
    v_add_u32 v248, s28, v14
    v_lshlrev_b32 v251, 2, v1
    v_add_u32 v251, 70144, v251
    v_bfe_u32 v14, v5, 1, 2
    v_xor_b32 v14, v14, v6
    v_lshlrev_b32 v14, 4, v14
    v_lshl_add_u32 v14, v5, 6, v14
    s_add_u32 s28, s26, 8448
    v_add_u32_e64 v249, s28, v14
    v_bfe_u32 v14, v1, 4, 2
    v_lshlrev_b32_e64 v14, 4, v14
    v_lshlrev_b32 v15, 3, v1
    v_xor_b32 v14, v14, v15
    v_add_u32 v250, 8448, v14
    s_add_u32 s28, s26, 1008
    v_sub_u32 v252, s28, v2
    v_and_b32 v3, 3, v0
    v_lshlrev_b32 v3, 6, v3
    v_mov_b32 v29, 16
    s_mul_i32 s28, s22, 154
    v_min_u32 v14, 153, v1
    v_add_u32_e64 v14, s28, v14
    v_mul_u32_u24 v15, 10923, v14
    v_lshrrev_b32_e64 v15, 16, v15
    v_mul_u32_u24 v15, 3328, v15
    v_lshl_add_u32 v254, v14, 7, v15
    s_add_u32 s34, s89, 768
    v_lshl_add_u32 v54, v6, 3, v5
    s_mov_b32 s28, 0x10001
    v_sub_u32 v55, 42, v54
    v_min_u32 v55, 31, v55
    v_mov_b32 v56, 0x7fc00000
    v_lshrrev_b32_e64 v55, v55, v56
    v_bfe_u32 v56, v55, 0, 2
    v_lshl_or_b32 v56, v56, 15, v56
    v_and_b32_e64 v56, s28, v56
    v_mul_u32_u24 v56, 0x3f80, v56
    v_accvgpr_write_b32 a248, v56
    v_bfe_u32 v56, v55, 2, 2
    v_lshl_or_b32 v56, v56, 15, v56
    v_and_b32_e64 v56, s28, v56
    v_mul_u32_u24 v56, 0x3f80, v56
    v_accvgpr_write_b32 a249, v56
    v_bfe_u32 v56, v55, 4, 2
    v_lshl_or_b32 v56, v56, 15, v56
    v_and_b32_e64 v56, s28, v56
    v_mul_u32_u24 v56, 0x3f80, v56
    v_accvgpr_write_b32 a250, v56
    v_bfe_u32 v56, v55, 6, 2
    v_lshl_or_b32 v56, v56, 15, v56
    v_and_b32_e64 v56, s28, v56
    v_mul_u32_u24 v56, 0x3f80, v56
    v_accvgpr_write_b32 a251, v56
    v_sub_u32 v55, 43, v54
    v_min_u32 v55, 31, v55
    v_mov_b32 v56, 0x7f000000
    v_lshrrev_b32_e64 v55, v55, v56
    v_bfe_u32 v56, v55, 0, 2
    v_lshl_or_b32 v56, v56, 15, v56
    v_and_b32_e64 v56, s28, v56
    v_mul_u32_u24 v56, 0x3f80, v56
    v_accvgpr_write_b32 a252, v56
    v_bfe_u32 v56, v55, 2, 2
    v_lshl_or_b32 v56, v56, 15, v56
    v_and_b32_e64 v56, s28, v56
    v_mul_u32_u24 v56, 0x3f80, v56
    v_accvgpr_write_b32 a253, v56
    v_bfe_u32 v56, v55, 4, 2
    v_lshl_or_b32 v56, v56, 15, v56
    v_and_b32_e64 v56, s28, v56
    v_mul_u32_u24 v56, 0x3f80, v56
    v_accvgpr_write_b32 a254, v56
    v_bfe_u32 v56, v55, 6, 2
    v_lshl_or_b32 v56, v56, 15, v56
    v_and_b32_e64 v56, s28, v56
    v_mul_u32_u24 v56, 0x3f80, v56
    v_accvgpr_write_b32 a255, v56
    v_and_b32 v15, 31, v0
    v_lshlrev_b32 v15, 4, v15
    s_mov_b32 s29, 5964800
    global_load_dwordx2 v[182:183], v4, s[36:37] offset:1280
    v_add_u32 v4, s17, v208
    s_mov_b32 s8, s68
    s_and_b32 s9, s69, 0xffff
    s_mov_b32 s10, 0xf00000
    s_mov_b32 s11, 0x20000
    s_mov_b32 s12, s58
    s_and_b32 s13, s59, 0xffff
    s_mov_b32 s14, 0x800000
    s_mov_b32 s15, 0x20000
    s_mov_b64 exec, 0
    s_cmp_eq_u32 s20, 1
    s_cbranch_scc1 L_pg1
    s_cmp_eq_u32 s20, 2
    s_cbranch_scc1 L_pg2
    s_cmp_eq_u32 s20, 3
    s_cbranch_scc1 L_pg3
L_w0:
    s_mov_b64 exec, -1
    s_branch L_base
.p2align 12
L_base:
    s_waitcnt vmcnt(12)
    v_mul_f32 v28, 0x3fb8aa3b, v28
    v_exp_f32 v28, v28
    s_nop 0
    v_cvt_pk_bf16_f32 v28, v28, v28
    v_lshlrev_b32 v28, 16, v28
    v_mul_f32 v44, v28, v22
    v_mul_f32 v45, v28, v23
    v_mul_f32 v44, 0x3fb8aa3b, v44
    v_mul_f32_e64 v45, 0.15915494, v45
    v_mul_f32 v47, 0x41000000, v45
    v_mul_f32 v46, 0x41000000, v44
    v_fract_f32 v47, v47
    v_exp_f32 v46, v46
    v_cos_f32 v38, v47
    v_sin_f32 v39, v47
    v_mul_f32 v38, v38, v46
    v_mul_f32 v39, v39, v46
    v_fract_f32 v47, v45
    v_exp_f32 v46, v44
    v_cos_f32 v36, v47
    v_sin_f32 v37, v47
    v_mul_f32 v36, v36, v46
    v_mul_f32 v37, v37, v46
    v_mul_f32 v47, 0x43800000, v45
    v_mul_f32 v46, 0x43800000, v44
    v_fract_f32 v47, v47
    v_exp_f32 v46, v46
    v_cos_f32 v40, v47
    v_sin_f32 v41, v47
    v_mul_f32 v40, v40, v46
    v_mul_f32 v41, v41, v46
    v_pk_mul_f32 v[52:53], v[38:39], v[38:39] op_sel:[0,0] op_sel_hi:[0,1]
    v_pk_fma_f32 v[52:53], v[38:39], v[38:39], v[52:53] op_sel:[1,1,0] op_sel_hi:[1,0,1] neg_lo:[0,1,0]
    v_pk_mul_f32 v[54:55], v[52:53], v[38:39] op_sel:[0,0] op_sel_hi:[0,1]
    v_pk_fma_f32 v[54:55], v[52:53], v[38:39], v[54:55] op_sel:[1,1,0] op_sel_hi:[1,0,1] neg_lo:[0,1,0]
    v_pk_mul_f32 v[56:57], v[54:55], v[38:39] op_sel:[0,0] op_sel_hi:[0,1]
    v_pk_fma_f32 v[56:57], v[54:55], v[38:39], v[56:57] op_sel:[1,1,0] op_sel_hi:[1,0,1] neg_lo:[0,1,0]
    v_pk_mul_f32 v[58:59], v[56:57], v[38:39] op_sel:[0,0] op_sel_hi:[0,1]
    v_pk_fma_f32 v[58:59], v[56:57], v[38:39], v[58:59] op_sel:[1,1,0] op_sel_hi:[1,0,1] neg_lo:[0,1,0]
    v_pk_mul_f32 v[60:61], v[58:59], v[38:39] op_sel:[0,0] op_sel_hi:[0,1]
    v_pk_fma_f32 v[60:61], v[58:59], v[38:39], v[60:61] op_sel:[1,1,0] op_sel_hi:[1,0,1] neg_lo:[0,1,0]
    v_pk_mul_f32 v[62:63], v[60:61], v[38:39] op_sel:[0,0] op_sel_hi:[0,1]
    v_pk_fma_f32 v[62:63], v[60:61], v[38:39], v[62:63] op_sel:[1,1,0] op_sel_hi:[1,0,1] neg_lo:[0,1,0]
    v_pk_mul_f32 v[64:65], v[62:63], v[38:39] op_sel:[0,0] op_sel_hi:[0,1]
    v_pk_fma_f32 v[64:65], v[62:63], v[38:39], v[64:65] op_sel:[1,1,0] op_sel_hi:[1,0,1] neg_lo:[0,1,0]
    v_pk_mul_f32 v[66:67], v[64:65], v[38:39] op_sel:[0,0] op_sel_hi:[0,1]
    v_pk_fma_f32 v[66:67], v[64:65], v[38:39], v[66:67] op_sel:[1,1,0] op_sel_hi:[1,0,1] neg_lo:[0,1,0]
    v_pk_mul_f32 v[68:69], v[66:67], v[38:39] op_sel:[0,0] op_sel_hi:[0,1]
    v_pk_fma_f32 v[68:69], v[66:67], v[38:39], v[68:69] op_sel:[1,1,0] op_sel_hi:[1,0,1] neg_lo:[0,1,0]
    v_pk_mul_f32 v[70:71], v[68:69], v[38:39] op_sel:[0,0] op_sel_hi:[0,1]
    v_pk_fma_f32 v[70:71], v[68:69], v[38:39], v[70:71] op_sel:[1,1,0] op_sel_hi:[1,0,1] neg_lo:[0,1,0]
    v_cvt_pk_bf16_f32 v88, v38, v39
    v_cvt_pk_bf16_f32 v89, v52, v53
    v_cvt_pk_bf16_f32 v90, v54, v55
    v_cvt_pk_bf16_f32 v91, v56, v57
    v_cvt_pk_bf16_f32 v92, v58, v59
    v_cvt_pk_bf16_f32 v93, v60, v61
    v_cvt_pk_bf16_f32 v94, v62, v63
    v_cvt_pk_bf16_f32 v95, v64, v65
    v_cvt_pk_bf16_f32 v96, v66, v67
    v_cvt_pk_bf16_f32 v97, v68, v69
    v_cvt_pk_bf16_f32 v98, v70, v71
    ds_write_addtid_b32 v88 offset:8976
    ds_write_addtid_b32 v89 offset:9248
    ds_write_addtid_b32 v90 offset:9520
    ds_write_addtid_b32 v91 offset:9792
    ds_write_addtid_b32 v92 offset:10064
    ds_write_addtid_b32 v93 offset:10336
    ds_write_addtid_b32 v94 offset:10608
    ds_write_addtid_b32 v95 offset:10880
    ds_write_addtid_b32 v96 offset:11152
    ds_write_addtid_b32 v97 offset:11424
    ds_write_addtid_b32 v98 offset:11696
    v_pk_mul_f32 v[48:49], v[70:71], v[38:39] op_sel:[0,0] op_sel_hi:[0,1]
    v_pk_fma_f32 v[48:49], v[70:71], v[38:39], v[48:49] op_sel:[1,1,0] op_sel_hi:[1,0,1] neg_lo:[0,1,0]
    v_pk_mul_f32 v[50:51], v[48:49], v[38:39] op_sel:[0,0] op_sel_hi:[0,1]
    v_pk_fma_f32 v[50:51], v[48:49], v[38:39], v[50:51] op_sel:[1,1,0] op_sel_hi:[1,0,1] neg_lo:[0,1,0]
    v_pk_mul_f32 v[52:53], v[50:51], v[38:39] op_sel:[0,0] op_sel_hi:[0,1]
    v_pk_fma_f32 v[52:53], v[50:51], v[38:39], v[52:53] op_sel:[1,1,0] op_sel_hi:[1,0,1] neg_lo:[0,1,0]
    v_pk_mul_f32 v[54:55], v[52:53], v[38:39] op_sel:[0,0] op_sel_hi:[0,1]
    v_pk_fma_f32 v[54:55], v[52:53], v[38:39], v[54:55] op_sel:[1,1,0] op_sel_hi:[1,0,1] neg_lo:[0,1,0]
    v_pk_mul_f32 v[56:57], v[54:55], v[38:39] op_sel:[0,0] op_sel_hi:[0,1]
    v_pk_fma_f32 v[56:57], v[54:55], v[38:39], v[56:57] op_sel:[1,1,0] op_sel_hi:[1,0,1] neg_lo:[0,1,0]
    v_pk_mul_f32 v[58:59], v[56:57], v[38:39] op_sel:[0,0] op_sel_hi:[0,1]
    v_pk_fma_f32 v[58:59], v[56:57], v[38:39], v[58:59] op_sel:[1,1,0] op_sel_hi:[1,0,1] neg_lo:[0,1,0]
    v_pk_mul_f32 v[60:61], v[58:59], v[38:39] op_sel:[0,0] op_sel_hi:[0,1]
    v_pk_fma_f32 v[60:61], v[58:59], v[38:39], v[60:61] op_sel:[1,1,0] op_sel_hi:[1,0,1] neg_lo:[0,1,0]
    v_pk_mul_f32 v[62:63], v[60:61], v[38:39] op_sel:[0,0] op_sel_hi:[0,1]
    v_pk_fma_f32 v[62:63], v[60:61], v[38:39], v[62:63] op_sel:[1,1,0] op_sel_hi:[1,0,1] neg_lo:[0,1,0]
    v_pk_mul_f32 v[64:65], v[62:63], v[38:39] op_sel:[0,0] op_sel_hi:[0,1]
    v_pk_fma_f32 v[64:65], v[62:63], v[38:39], v[64:65] op_sel:[1,1,0] op_sel_hi:[1,0,1] neg_lo:[0,1,0]
    v_pk_mul_f32 v[66:67], v[64:65], v[38:39] op_sel:[0,0] op_sel_hi:[0,1]
    v_pk_fma_f32 v[66:67], v[64:65], v[38:39], v[66:67] op_sel:[1,1,0] op_sel_hi:[1,0,1] neg_lo:[0,1,0]
    v_cvt_pk_bf16_f32 v88, v48, v49
    v_cvt_pk_bf16_f32 v89, v50, v51
    v_cvt_pk_bf16_f32 v90, v52, v53
    v_cvt_pk_bf16_f32 v91, v54, v55
    v_cvt_pk_bf16_f32 v92, v56, v57
    v_cvt_pk_bf16_f32 v93, v58, v59
    v_cvt_pk_bf16_f32 v94, v60, v61
    v_cvt_pk_bf16_f32 v95, v62, v63
    v_cvt_pk_bf16_f32 v96, v64, v65
    v_cvt_pk_bf16_f32 v97, v66, v67
    ds_write_addtid_b32 v88 offset:11968
    ds_write_addtid_b32 v89 offset:12240
    ds_write_addtid_b32 v90 offset:12512
    ds_write_addtid_b32 v91 offset:12784
    ds_write_addtid_b32 v92 offset:13056
    ds_write_addtid_b32 v93 offset:13328
    ds_write_addtid_b32 v94 offset:13600
    ds_write_addtid_b32 v95 offset:13872
    ds_write_addtid_b32 v96 offset:14144
    ds_write_addtid_b32 v97 offset:14416
    global_load_dwordx2 v[184:185], v4, s[36:37]
    v_pk_mul_f32 v[68:69], v[66:67], v[38:39] op_sel:[0,0] op_sel_hi:[0,1]
    v_pk_fma_f32 v[68:69], v[66:67], v[38:39], v[68:69] op_sel:[1,1,0] op_sel_hi:[1,0,1] neg_lo:[0,1,0]
    v_pk_mul_f32 v[70:71], v[68:69], v[38:39] op_sel:[0,0] op_sel_hi:[0,1]
    v_pk_fma_f32 v[70:71], v[68:69], v[38:39], v[70:71] op_sel:[1,1,0] op_sel_hi:[1,0,1] neg_lo:[0,1,0]
    v_pk_mul_f32 v[48:49], v[70:71], v[38:39] op_sel:[0,0] op_sel_hi:[0,1]
    v_pk_fma_f32 v[48:49], v[70:71], v[38:39], v[48:49] op_sel:[1,1,0] op_sel_hi:[1,0,1] neg_lo:[0,1,0]
    v_pk_mul_f32 v[50:51], v[48:49], v[38:39] op_sel:[0,0] op_sel_hi:[0,1]
    v_pk_fma_f32 v[50:51], v[48:49], v[38:39], v[50:51] op_sel:[1,1,0] op_sel_hi:[1,0,1] neg_lo:[0,1,0]
    v_pk_mul_f32 v[52:53], v[50:51], v[38:39] op_sel:[0,0] op_sel_hi:[0,1]
    v_pk_fma_f32 v[52:53], v[50:51], v[38:39], v[52:53] op_sel:[1,1,0] op_sel_hi:[1,0,1] neg_lo:[0,1,0]
    v_pk_mul_f32 v[54:55], v[52:53], v[38:39] op_sel:[0,0] op_sel_hi:[0,1]
    v_pk_fma_f32 v[54:55], v[52:53], v[38:39], v[54:55] op_sel:[1,1,0] op_sel_hi:[1,0,1] neg_lo:[0,1,0]
    v_pk_mul_f32 v[56:57], v[54:55], v[38:39] op_sel:[0,0] op_sel_hi:[0,1]
    v_pk_fma_f32 v[56:57], v[54:55], v[38:39], v[56:57] op_sel:[1,1,0] op_sel_hi:[1,0,1] neg_lo:[0,1,0]
    v_pk_mul_f32 v[58:59], v[56:57], v[38:39] op_sel:[0,0] op_sel_hi:[0,1]
    v_pk_fma_f32 v[58:59], v[56:57], v[38:39], v[58:59] op_sel:[1,1,0] op_sel_hi:[1,0,1] neg_lo:[0,1,0]
    v_pk_mul_f32 v[60:61], v[58:59], v[38:39] op_sel:[0,0] op_sel_hi:[0,1]
    v_pk_fma_f32 v[60:61], v[58:59], v[38:39], v[60:61] op_sel:[1,1,0] op_sel_hi:[1,0,1] neg_lo:[0,1,0]
    v_pk_mul_f32 v[62:63], v[60:61], v[38:39] op_sel:[0,0] op_sel_hi:[0,1]
    v_pk_fma_f32 v[62:63], v[60:61], v[38:39], v[62:63] op_sel:[1,1,0] op_sel_hi:[1,0,1] neg_lo:[0,1,0]
    v_cvt_pk_bf16_f32 v88, v68, v69
    v_cvt_pk_bf16_f32 v89, v70, v71
    v_cvt_pk_bf16_f32 v90, v48, v49
    v_cvt_pk_bf16_f32 v91, v50, v51
    v_cvt_pk_bf16_f32 v92, v52, v53
    v_cvt_pk_bf16_f32 v93, v54, v55
    v_cvt_pk_bf16_f32 v94, v56, v57
    v_cvt_pk_bf16_f32 v95, v58, v59
    v_cvt_pk_bf16_f32 v96, v60, v61
    v_cvt_pk_bf16_f32 v97, v62, v63
    ds_write_addtid_b32 v88 offset:14688
    ds_write_addtid_b32 v89 offset:14960
    ds_write_addtid_b32 v90 offset:15232
    ds_write_addtid_b32 v91 offset:15504
    ds_write_addtid_b32 v92 offset:15776
    ds_write_addtid_b32 v93 offset:16048
    ds_write_addtid_b32 v94 offset:16320
    ds_write_addtid_b32 v95 offset:16592
    ds_write_addtid_b32 v96 offset:16864
    ds_write_addtid_b32 v97 offset:17136
    ds_read_b128 v[104:107], v7 offset:8704
    ds_read_b128 v[112:115], v7 offset:8736
    ds_read_b128 v[120:123], v7 offset:8768
    ds_read_b128 v[128:131], v7 offset:8800
    ds_read_b128 v[136:139], v7 offset:8832
    ds_read_b128 v[144:147], v7 offset:8864
    ds_read_b128 v[152:155], v7 offset:8896
    ds_read_b128 v[160:163], v7 offset:8928
    s_waitcnt vmcnt(9)
    v_mul_f32 v42, v24, v26
    v_mul_f32_e64 v43, v24, v27
    v_fma_f32 v42, -v25, v27, v42
    v_fma_f32 v43, v25, v26, v43
    v_mul_f32 v42, v42, v28
    v_mul_f32 v43, v43, v28
    v_pk_mul_f32 v[48:49], v[42:43], v[36:37] op_sel:[0,0] op_sel_hi:[0,1]
    v_pk_fma_f32 v[48:49], v[42:43], v[36:37], v[48:49] op_sel:[1,1,0] op_sel_hi:[1,0,1] neg_lo:[0,1,0]
    v_pk_mul_f32 v[50:51], v[48:49], v[36:37] op_sel:[0,0] op_sel_hi:[0,1]
    v_pk_fma_f32 v[50:51], v[48:49], v[36:37], v[50:51] op_sel:[1,1,0] op_sel_hi:[1,0,1] neg_lo:[0,1,0]
    v_pk_mul_f32 v[52:53], v[50:51], v[36:37] op_sel:[0,0] op_sel_hi:[0,1]
    v_pk_fma_f32 v[52:53], v[50:51], v[36:37], v[52:53] op_sel:[1,1,0] op_sel_hi:[1,0,1] neg_lo:[0,1,0]
    v_pk_mul_f32 v[54:55], v[52:53], v[36:37] op_sel:[0,0] op_sel_hi:[0,1]
    v_pk_fma_f32 v[54:55], v[52:53], v[36:37], v[54:55] op_sel:[1,1,0] op_sel_hi:[1,0,1] neg_lo:[0,1,0]
    v_pk_mul_f32 v[56:57], v[54:55], v[36:37] op_sel:[0,0] op_sel_hi:[0,1]
    v_pk_fma_f32 v[56:57], v[54:55], v[36:37], v[56:57] op_sel:[1,1,0] op_sel_hi:[1,0,1] neg_lo:[0,1,0]
    v_pk_mul_f32 v[58:59], v[56:57], v[36:37] op_sel:[0,0] op_sel_hi:[0,1]
    v_pk_fma_f32 v[58:59], v[56:57], v[36:37], v[58:59] op_sel:[1,1,0] op_sel_hi:[1,0,1] neg_lo:[0,1,0]
    v_pk_mul_f32 v[60:61], v[58:59], v[36:37] op_sel:[0,0] op_sel_hi:[0,1]
    v_pk_fma_f32 v[60:61], v[58:59], v[36:37], v[60:61] op_sel:[1,1,0] op_sel_hi:[1,0,1] neg_lo:[0,1,0]
    v_pk_mul_f32 v[62:63], v[42:43], v[40:41] op_sel:[0,0] op_sel_hi:[0,1]
    v_pk_fma_f32 v[62:63], v[42:43], v[40:41], v[62:63] op_sel:[1,1,0] op_sel_hi:[1,0,1] neg_lo:[0,1,0]
    v_pk_mul_f32 v[64:65], v[50:51], v[40:41] op_sel:[0,0] op_sel_hi:[0,1]
    v_pk_fma_f32 v[64:65], v[50:51], v[40:41], v[64:65] op_sel:[1,1,0] op_sel_hi:[1,0,1] neg_lo:[0,1,0]
    v_cvt_pk_bf16_f32 v88, v42, -v43
    v_cvt_pk_bf16_f32 v89, v48, -v49
    v_cvt_pk_bf16_f32 v90, v50, -v51
    v_cvt_pk_bf16_f32 v91, v52, -v53
    v_cvt_pk_bf16_f32 v92, v54, -v55
    v_cvt_pk_bf16_f32 v93, v56, -v57
    v_cvt_pk_bf16_f32 v94, v58, -v59
    v_cvt_pk_bf16_f32 v95, v60, -v61
    v_cvt_pk_bf16_f32 v96, v62, -v63
    v_cvt_pk_bf16_f32 v97, v64, -v65
    ds_write_addtid_b32 v88 offset:0
    ds_write_addtid_b32 v89 offset:272
    ds_write_addtid_b32 v90 offset:544
    ds_write_addtid_b32 v91 offset:816
    ds_write_addtid_b32 v92 offset:2176
    ds_write_addtid_b32 v93 offset:2448
    ds_write_addtid_b32 v94 offset:2720
    ds_write_addtid_b32 v95 offset:2992
    ds_write_addtid_b32 v96 offset:1088
    ds_write_addtid_b32 v96 offset:1360
    ds_write_addtid_b32 v97 offset:1632
    global_load_dwordx2 v[186:187], v4, s[36:37] offset:1280
    v_add_u32_e64 v4, s18, v208
    v_pk_mul_f32 v[66:67], v[54:55], v[40:41] op_sel:[0,0] op_sel_hi:[0,1]
    v_pk_fma_f32 v[66:67], v[54:55], v[40:41], v[66:67] op_sel:[1,1,0] op_sel_hi:[1,0,1] neg_lo:[0,1,0]
    v_pk_mul_f32 v[68:69], v[58:59], v[40:41] op_sel:[0,0] op_sel_hi:[0,1]
    v_pk_fma_f32 v[68:69], v[58:59], v[40:41], v[68:69] op_sel:[1,1,0] op_sel_hi:[1,0,1] neg_lo:[0,1,0]
    v_pk_mul_f32 v[70:71], v[62:63], v[40:41] op_sel:[0,0] op_sel_hi:[0,1]
    v_pk_fma_f32 v[70:71], v[62:63], v[40:41], v[70:71] op_sel:[1,1,0] op_sel_hi:[1,0,1] neg_lo:[0,1,0]
    v_pk_mul_f32 v[72:73], v[66:67], v[40:41] op_sel:[0,0] op_sel_hi:[0,1]
    v_pk_fma_f32 v[72:73], v[66:67], v[40:41], v[72:73] op_sel:[1,1,0] op_sel_hi:[1,0,1] neg_lo:[0,1,0]
    v_pk_mul_f32 v[74:75], v[70:71], v[40:41] op_sel:[0,0] op_sel_hi:[0,1]
    v_pk_fma_f32 v[74:75], v[70:71], v[40:41], v[74:75] op_sel:[1,1,0] op_sel_hi:[1,0,1] neg_lo:[0,1,0]
    v_pk_mul_f32 v[76:77], v[72:73], v[40:41] op_sel:[0,0] op_sel_hi:[0,1]
    v_pk_fma_f32 v[76:77], v[72:73], v[40:41], v[76:77] op_sel:[1,1,0] op_sel_hi:[1,0,1] neg_lo:[0,1,0]
    v_pk_mul_f32 v[78:79], v[74:75], v[40:41] op_sel:[0,0] op_sel_hi:[0,1]
    v_pk_fma_f32 v[78:79], v[74:75], v[40:41], v[78:79] op_sel:[1,1,0] op_sel_hi:[1,0,1] neg_lo:[0,1,0]
    v_pk_mul_f32 v[80:81], v[78:79], v[40:41] op_sel:[0,0] op_sel_hi:[0,1]
    v_pk_fma_f32 v[80:81], v[78:79], v[40:41], v[80:81] op_sel:[1,1,0] op_sel_hi:[1,0,1] neg_lo:[0,1,0]
    v_pk_mul_f32 v[82:83], v[80:81], v[40:41] op_sel:[0,0] op_sel_hi:[0,1]
    v_pk_fma_f32 v[82:83], v[80:81], v[40:41], v[82:83] op_sel:[1,1,0] op_sel_hi:[1,0,1] neg_lo:[0,1,0]
    v_pk_mul_f32 v[84:85], v[82:83], v[40:41] op_sel:[0,0] op_sel_hi:[0,1]
    v_pk_fma_f32 v[84:85], v[82:83], v[40:41], v[84:85] op_sel:[1,1,0] op_sel_hi:[1,0,1] neg_lo:[0,1,0]
    v_pk_mul_f32 v[86:87], v[84:85], v[40:41] op_sel:[0,0] op_sel_hi:[0,1]
    v_pk_fma_f32 v[86:87], v[84:85], v[40:41], v[86:87] op_sel:[1,1,0] op_sel_hi:[1,0,1] neg_lo:[0,1,0]
    v_cvt_pk_bf16_f32 v88, v66, -v67
    v_cvt_pk_bf16_f32 v89, v68, -v69
    v_cvt_pk_bf16_f32 v90, v70, -v71
    v_cvt_pk_bf16_f32 v91, v72, -v73
    v_cvt_pk_bf16_f32 v92, v74, -v75
    v_cvt_pk_bf16_f32 v93, v76, -v77
    v_cvt_pk_bf16_f32 v94, v78, -v79
    v_cvt_pk_bf16_f32 v95, v80, -v81
    v_cvt_pk_bf16_f32 v96, v82, -v83
    v_cvt_pk_bf16_f32 v97, v84, -v85
    v_cvt_pk_bf16_f32 v98, v86, -v87
    ds_write_addtid_b32 v88 offset:1904
    ds_write_addtid_b32 v88 offset:3264
    ds_write_addtid_b32 v88 offset:3536
    ds_write_addtid_b32 v89 offset:3808
    ds_write_addtid_b32 v90 offset:4352
    ds_write_addtid_b32 v91 offset:4624
    ds_write_addtid_b32 v92 offset:5440
    ds_write_addtid_b32 v93 offset:5712
    ds_write_addtid_b32 v94 offset:4896
    ds_write_addtid_b32 v95 offset:5984
    ds_write_addtid_b32 v96 offset:5168
    ds_write_addtid_b32 v97 offset:6256
    ds_write_addtid_b32 v98 offset:6528
    ds_read_b128 v[100:103], v7 offset:0
    ds_read_b128 v[108:111], v7 offset:32
    ds_read_b128 v[116:119], v7 offset:64
    ds_read_b128 v[124:127], v7 offset:96
    ds_read_b128 v[132:135], v7 offset:128
    ds_read_b128 v[140:143], v7 offset:160
    ds_read_b128 v[148:151], v7 offset:192
    ds_read_b128 v[156:159], v7 offset:224
    s_waitcnt vmcnt(4)
    v_lshlrev_b32 v30, 16, v16
    v_lshlrev_b32_e64 v31, 16, v17
    v_lshlrev_b32 v32, 16, v18
    v_lshlrev_b32 v33, 16, v19
    v_lshlrev_b32 v34, 16, v20
    v_lshlrev_b32 v35, 16, v21
    v_mul_f32 v44, v28, v30
    v_mul_f32 v45, v28, v31
    v_mul_f32 v44, 0x3fb8aa3b, v44
    v_mul_f32_e64 v45, 0.15915494, v45
    v_mul_f32 v47, 0x41000000, v45
    v_mul_f32 v46, 0x41000000, v44
    v_fract_f32 v47, v47
    s_waitcnt lgkmcnt(7)
    v_mfma_f32_32x32x16_bf16 v[164:179], v[100:103], v[104:107], 0
    v_exp_f32 v46, v46
    v_cos_f32 v38, v47
    v_sin_f32 v39, v47
    s_waitcnt lgkmcnt(6)
    v_mfma_f32_32x32x16_bf16 v[164:179], v[108:111], v[112:115], v[164:179]
    v_mul_f32 v42, v32, v34
    v_mul_f32 v43, v32, v35
    v_mul_f32 v38, v38, v46
    v_mul_f32 v39, v39, v46
    v_fract_f32 v47, v45
    s_waitcnt lgkmcnt(5)
    v_mfma_f32_32x32x16_bf16 v[164:179], v[116:119], v[120:123], v[164:179]
    v_exp_f32 v46, v44
    v_cos_f32 v36, v47
    v_sin_f32 v37, v47
    s_waitcnt lgkmcnt(4)
    v_mfma_f32_32x32x16_bf16 v[164:179], v[124:127], v[128:131], v[164:179]
    v_fma_f32 v42, -v33, v35, v42
    v_fma_f32 v43, v33, v34, v43
    v_mul_f32 v36, v36, v46
    v_mul_f32 v37, v37, v46
    v_mul_f32 v47, 0x43800000, v45
    v_mul_f32 v46, 0x43800000, v44
    s_waitcnt lgkmcnt(3)
    v_mfma_f32_32x32x16_bf16 v[164:179], v[132:135], v[136:139], v[164:179]
    v_fract_f32 v47, v47
    v_exp_f32 v46, v46
    v_cos_f32 v40, v47
    v_sin_f32_e64 v41, v47
    v_mul_f32 v42, v42, v28
    v_mul_f32 v43, v43, v28
    v_mul_f32 v40, v40, v46
    v_mul_f32 v41, v41, v46
    v_pk_mul_f32 v[52:53], v[38:39], v[38:39] op_sel:[0,0] op_sel_hi:[0,1]
    v_pk_fma_f32 v[52:53], v[38:39], v[38:39], v[52:53] op_sel:[1,1,0] op_sel_hi:[1,0,1] neg_lo:[0,1,0]
    v_pk_mul_f32 v[54:55], v[52:53], v[38:39] op_sel:[0,0] op_sel_hi:[0,1]
    v_pk_fma_f32 v[54:55], v[52:53], v[38:39], v[54:55] op_sel:[1,1,0] op_sel_hi:[1,0,1] neg_lo:[0,1,0]
    v_pk_mul_f32 v[56:57], v[54:55], v[38:39] op_sel:[0,0] op_sel_hi:[0,1]
    v_pk_fma_f32 v[56:57], v[54:55], v[38:39], v[56:57] op_sel:[1,1,0] op_sel_hi:[1,0,1] neg_lo:[0,1,0]
    v_pk_mul_f32 v[58:59], v[56:57], v[38:39] op_sel:[0,0] op_sel_hi:[0,1]
    v_pk_fma_f32 v[58:59], v[56:57], v[38:39], v[58:59] op_sel:[1,1,0] op_sel_hi:[1,0,1] neg_lo:[0,1,0]
    v_pk_mul_f32 v[60:61], v[58:59], v[38:39] op_sel:[0,0] op_sel_hi:[0,1]
    v_pk_fma_f32 v[60:61], v[58:59], v[38:39], v[60:61] op_sel:[1,1,0] op_sel_hi:[1,0,1] neg_lo:[0,1,0]
    v_pk_mul_f32 v[62:63], v[60:61], v[38:39] op_sel:[0,0] op_sel_hi:[0,1]
    v_pk_fma_f32 v[62:63], v[60:61], v[38:39], v[62:63] op_sel:[1,1,0] op_sel_hi:[1,0,1] neg_lo:[0,1,0]
    v_pk_mul_f32 v[64:65], v[62:63], v[38:39] op_sel:[0,0] op_sel_hi:[0,1]
    v_pk_fma_f32 v[64:65], v[62:63], v[38:39], v[64:65] op_sel:[1,1,0] op_sel_hi:[1,0,1] neg_lo:[0,1,0]
    v_pk_mul_f32 v[66:67], v[64:65], v[38:39] op_sel:[0,0] op_sel_hi:[0,1]
    v_pk_fma_f32 v[66:67], v[64:65], v[38:39], v[66:67] op_sel:[1,1,0] op_sel_hi:[1,0,1] neg_lo:[0,1,0]
    v_pk_mul_f32 v[68:69], v[66:67], v[38:39] op_sel:[0,0] op_sel_hi:[0,1]
    v_pk_fma_f32 v[68:69], v[66:67], v[38:39], v[68:69] op_sel:[1,1,0] op_sel_hi:[1,0,1] neg_lo:[0,1,0]
    v_pk_mul_f32 v[70:71], v[68:69], v[38:39] op_sel:[0,0] op_sel_hi:[0,1]
    v_pk_fma_f32 v[70:71], v[68:69], v[38:39], v[70:71] op_sel:[1,1,0] op_sel_hi:[1,0,1] neg_lo:[0,1,0]
    s_waitcnt lgkmcnt(2)
    v_mfma_f32_32x32x16_bf16 v[164:179], v[140:143], v[144:147], v[164:179]
    v_cvt_pk_bf16_f32 v88, v38, v39
    v_cvt_pk_bf16_f32 v89, v52, v53
    v_cvt_pk_bf16_f32 v90, v54, v55
    v_cvt_pk_bf16_f32 v91, v56, v57
    v_cvt_pk_bf16_f32 v92, v58, v59
    v_cvt_pk_bf16_f32 v93, v60, v61
    s_waitcnt lgkmcnt(1)
    v_mfma_f32_32x32x16_bf16 v[164:179], v[148:151], v[152:155], v[164:179]
    v_cvt_pk_bf16_f32 v94, v62, v63
    v_cvt_pk_bf16_f32 v95, v64, v65
    v_cvt_pk_bf16_f32 v96, v66, v67
    v_cvt_pk_bf16_f32 v97, v68, v69
    v_cvt_pk_bf16_f32 v98, v70, v71
    ds_write_addtid_b32 v88 offset:8976
    s_waitcnt lgkmcnt(1)
    s_nop 0
    v_mfma_f32_32x32x16_bf16 v[164:179], v[156:159], v[160:163], v[164:179]
    ds_write_addtid_b32 v89 offset:9248
    ds_write_addtid_b32 v90 offset:9520
    ds_write_addtid_b32 v91 offset:9792
    ds_write_addtid_b32 v92 offset:10064
    ds_write_addtid_b32 v93 offset:10336
    ds_write_addtid_b32 v94 offset:10608
    ds_write_addtid_b32 v95 offset:10880
    ds_write_addtid_b32 v96 offset:11152
    ds_write_addtid_b32 v97 offset:11424
    ds_write_addtid_b32 v98 offset:11696
    global_load_dwordx2 v[188:189], v4, s[36:37]
    v_pk_mul_f32 v[48:49], v[70:71], v[38:39] op_sel:[0,0] op_sel_hi:[0,1]
    v_pk_fma_f32 v[48:49], v[70:71], v[38:39], v[48:49] op_sel:[1,1,0] op_sel_hi:[1,0,1] neg_lo:[0,1,0]
    v_pk_mul_f32 v[50:51], v[48:49], v[38:39] op_sel:[0,0] op_sel_hi:[0,1]
    v_pk_fma_f32 v[50:51], v[48:49], v[38:39], v[50:51] op_sel:[1,1,0] op_sel_hi:[1,0,1] neg_lo:[0,1,0]
    v_pk_mul_f32 v[52:53], v[50:51], v[38:39] op_sel:[0,0] op_sel_hi:[0,1]
    v_pk_fma_f32 v[52:53], v[50:51], v[38:39], v[52:53] op_sel:[1,1,0] op_sel_hi:[1,0,1] neg_lo:[0,1,0]
    v_pk_mul_f32 v[54:55], v[52:53], v[38:39] op_sel:[0,0] op_sel_hi:[0,1]
    v_pk_fma_f32 v[54:55], v[52:53], v[38:39], v[54:55] op_sel:[1,1,0] op_sel_hi:[1,0,1] neg_lo:[0,1,0]
    v_pk_mul_f32 v[56:57], v[54:55], v[38:39] op_sel:[0,0] op_sel_hi:[0,1]
    v_pk_fma_f32 v[56:57], v[54:55], v[38:39], v[56:57] op_sel:[1,1,0] op_sel_hi:[1,0,1] neg_lo:[0,1,0]
    v_pk_mul_f32 v[58:59], v[56:57], v[38:39] op_sel:[0,0] op_sel_hi:[0,1]
    v_pk_fma_f32 v[58:59], v[56:57], v[38:39], v[58:59] op_sel:[1,1,0] op_sel_hi:[1,0,1] neg_lo:[0,1,0]
    v_pk_mul_f32 v[60:61], v[58:59], v[38:39] op_sel:[0,0] op_sel_hi:[0,1]
    v_pk_fma_f32 v[60:61], v[58:59], v[38:39], v[60:61] op_sel:[1,1,0] op_sel_hi:[1,0,1] neg_lo:[0,1,0]
    v_pk_mul_f32 v[62:63], v[60:61], v[38:39] op_sel:[0,0] op_sel_hi:[0,1]
    v_pk_fma_f32 v[62:63], v[60:61], v[38:39], v[62:63] op_sel:[1,1,0] op_sel_hi:[1,0,1] neg_lo:[0,1,0]
    v_pk_mul_f32 v[64:65], v[62:63], v[38:39] op_sel:[0,0] op_sel_hi:[0,1]
    v_pk_fma_f32 v[64:65], v[62:63], v[38:39], v[64:65] op_sel:[1,1,0] op_sel_hi:[1,0,1] neg_lo:[0,1,0]
    v_pk_mul_f32 v[66:67], v[64:65], v[38:39] op_sel:[0,0] op_sel_hi:[0,1]
    v_pk_fma_f32 v[66:67], v[64:65], v[38:39], v[66:67] op_sel:[1,1,0] op_sel_hi:[1,0,1] neg_lo:[0,1,0]
    v_cvt_pk_bf16_f32 v88, v48, v49
    v_cvt_pk_bf16_f32 v89, v50, v51
    v_cvt_pk_bf16_f32 v90, v52, v53
    v_cvt_pk_bf16_f32 v91, v54, v55
    v_cvt_pk_bf16_f32 v92, v56, v57
    v_cvt_pk_bf16_f32 v93, v58, v59
    v_cvt_pk_bf16_f32 v94, v60, v61
    v_cvt_pk_bf16_f32 v95, v62, v63
    v_cvt_pk_bf16_f32 v96, v64, v65
    v_cvt_pk_bf16_f32 v97, v66, v67
    ds_write_addtid_b32 v88 offset:11968
    ds_write_addtid_b32 v89 offset:12240
    ds_write_addtid_b32 v90 offset:12512
    ds_write_addtid_b32 v91 offset:12784
    ds_write_addtid_b32 v92 offset:13056
    ds_write_addtid_b32 v93 offset:13328
    ds_write_addtid_b32 v94 offset:13600
    ds_write_addtid_b32 v95 offset:13872
    ds_write_addtid_b32 v96 offset:14144
    ds_write_addtid_b32 v97 offset:14416
    v_pk_mul_f32 v[68:69], v[66:67], v[38:39] op_sel:[0,0] op_sel_hi:[0,1]
    v_pk_fma_f32 v[68:69], v[66:67], v[38:39], v[68:69] op_sel:[1,1,0] op_sel_hi:[1,0,1] neg_lo:[0,1,0]
    v_pk_mul_f32 v[70:71], v[68:69], v[38:39] op_sel:[0,0] op_sel_hi:[0,1]
    v_pk_fma_f32 v[70:71], v[68:69], v[38:39], v[70:71] op_sel:[1,1,0] op_sel_hi:[1,0,1] neg_lo:[0,1,0]
    v_pk_mul_f32 v[48:49], v[70:71], v[38:39] op_sel:[0,0] op_sel_hi:[0,1]
    v_pk_fma_f32 v[48:49], v[70:71], v[38:39], v[48:49] op_sel:[1,1,0] op_sel_hi:[1,0,1] neg_lo:[0,1,0]
    v_pk_mul_f32 v[50:51], v[48:49], v[38:39] op_sel:[0,0] op_sel_hi:[0,1]
    v_pk_fma_f32 v[50:51], v[48:49], v[38:39], v[50:51] op_sel:[1,1,0] op_sel_hi:[1,0,1] neg_lo:[0,1,0]
    v_pk_mul_f32 v[52:53], v[50:51], v[38:39] op_sel:[0,0] op_sel_hi:[0,1]
    v_pk_fma_f32 v[52:53], v[50:51], v[38:39], v[52:53] op_sel:[1,1,0] op_sel_hi:[1,0,1] neg_lo:[0,1,0]
    v_pk_mul_f32 v[54:55], v[52:53], v[38:39] op_sel:[0,0] op_sel_hi:[0,1]
    v_pk_fma_f32 v[54:55], v[52:53], v[38:39], v[54:55] op_sel:[1,1,0] op_sel_hi:[1,0,1] neg_lo:[0,1,0]
    v_pk_mul_f32 v[56:57], v[54:55], v[38:39] op_sel:[0,0] op_sel_hi:[0,1]
    v_pk_fma_f32 v[56:57], v[54:55], v[38:39], v[56:57] op_sel:[1,1,0] op_sel_hi:[1,0,1] neg_lo:[0,1,0]
    v_pk_mul_f32 v[58:59], v[56:57], v[38:39] op_sel:[0,0] op_sel_hi:[0,1]
    v_pk_fma_f32 v[58:59], v[56:57], v[38:39], v[58:59] op_sel:[1,1,0] op_sel_hi:[1,0,1] neg_lo:[0,1,0]
    v_pk_mul_f32 v[60:61], v[58:59], v[38:39] op_sel:[0,0] op_sel_hi:[0,1]
    v_pk_fma_f32 v[60:61], v[58:59], v[38:39], v[60:61] op_sel:[1,1,0] op_sel_hi:[1,0,1] neg_lo:[0,1,0]
    v_pk_mul_f32 v[62:63], v[60:61], v[38:39] op_sel:[0,0] op_sel_hi:[0,1]
    v_pk_fma_f32 v[62:63], v[60:61], v[38:39], v[62:63] op_sel:[1,1,0] op_sel_hi:[1,0,1] neg_lo:[0,1,0]
    v_cvt_pk_bf16_f32 v88, v68, v69
    v_cvt_pk_bf16_f32 v89, v70, v71
    v_cvt_pk_bf16_f32 v90, v48, v49
    v_cvt_pk_bf16_f32 v91, v50, v51
    v_cvt_pk_bf16_f32 v92, v52, v53
    v_cvt_pk_bf16_f32 v93, v54, v55
    v_cvt_pk_bf16_f32 v94, v56, v57
    v_cvt_pk_bf16_f32 v95, v58, v59
    v_cvt_pk_bf16_f32 v96, v60, v61
    v_cvt_pk_bf16_f32 v97, v62, v63
    ds_write_addtid_b32 v88 offset:14688
    ds_write_addtid_b32 v89 offset:14960
    ds_write_addtid_b32 v90 offset:15232
    ds_write_addtid_b32 v91 offset:15504
    ds_write_addtid_b32 v92 offset:15776
    ds_write_addtid_b32 v93 offset:16048
    ds_write_addtid_b32 v94 offset:16320
    ds_write_addtid_b32 v95 offset:16592
    ds_write_addtid_b32 v96 offset:16864
    ds_write_addtid_b32 v97 offset:17136
    global_load_dwordx2 v[190:191], v4, s[36:37] offset:1280
    v_add_u32_e64 v4, s19, v208
    ds_read_b128 v[104:107], v7 offset:8704
    ds_read_b128 v[112:115], v7 offset:8736
    ds_read_b128 v[120:123], v7 offset:8768
    ds_read_b128 v[128:131], v7 offset:8800
    ds_read_b128 v[136:139], v7 offset:8832
    ds_read_b128 v[144:147], v7 offset:8864
    ds_read_b128 v[152:155], v7 offset:8896
    ds_read_b128 v[160:163], v7 offset:8928
    v_pk_mul_f32 v[48:49], v[42:43], v[36:37] op_sel:[0,0] op_sel_hi:[0,1]
    v_pk_fma_f32 v[48:49], v[42:43], v[36:37], v[48:49] op_sel:[1,1,0] op_sel_hi:[1,0,1] neg_lo:[0,1,0]
    v_pk_mul_f32 v[50:51], v[48:49], v[36:37] op_sel:[0,0] op_sel_hi:[0,1]
    v_pk_fma_f32 v[50:51], v[48:49], v[36:37], v[50:51] op_sel:[1,1,0] op_sel_hi:[1,0,1] neg_lo:[0,1,0]
    v_pk_mul_f32 v[52:53], v[50:51], v[36:37] op_sel:[0,0] op_sel_hi:[0,1]
    v_pk_fma_f32 v[52:53], v[50:51], v[36:37], v[52:53] op_sel:[1,1,0] op_sel_hi:[1,0,1] neg_lo:[0,1,0]
    v_pk_mul_f32 v[54:55], v[52:53], v[36:37] op_sel:[0,0] op_sel_hi:[0,1]
    v_pk_fma_f32 v[54:55], v[52:53], v[36:37], v[54:55] op_sel:[1,1,0] op_sel_hi:[1,0,1] neg_lo:[0,1,0]
    v_pk_mul_f32 v[56:57], v[54:55], v[36:37] op_sel:[0,0] op_sel_hi:[0,1]
    v_pk_fma_f32 v[56:57], v[54:55], v[36:37], v[56:57] op_sel:[1,1,0] op_sel_hi:[1,0,1] neg_lo:[0,1,0]
    v_pk_mul_f32 v[58:59], v[56:57], v[36:37] op_sel:[0,0] op_sel_hi:[0,1]
    v_pk_fma_f32 v[58:59], v[56:57], v[36:37], v[58:59] op_sel:[1,1,0] op_sel_hi:[1,0,1] neg_lo:[0,1,0]
    v_pk_mul_f32 v[60:61], v[58:59], v[36:37] op_sel:[0,0] op_sel_hi:[0,1]
    v_pk_fma_f32 v[60:61], v[58:59], v[36:37], v[60:61] op_sel:[1,1,0] op_sel_hi:[1,0,1] neg_lo:[0,1,0]
    v_pk_mul_f32 v[62:63], v[42:43], v[40:41] op_sel:[0,0] op_sel_hi:[0,1]
    v_pk_fma_f32 v[62:63], v[42:43], v[40:41], v[62:63] op_sel:[1,1,0] op_sel_hi:[1,0,1] neg_lo:[0,1,0]
    v_pk_mul_f32 v[64:65], v[50:51], v[40:41] op_sel:[0,0] op_sel_hi:[0,1]
    v_pk_fma_f32 v[64:65], v[50:51], v[40:41], v[64:65] op_sel:[1,1,0] op_sel_hi:[1,0,1] neg_lo:[0,1,0]
    v_cvt_pk_bf16_f32 v88, v42, -v43
    v_cvt_pk_bf16_f32 v89, v48, -v49
    v_cvt_pk_bf16_f32 v90, v50, -v51
    v_cvt_pk_bf16_f32 v91, v52, -v53
    v_cvt_pk_bf16_f32 v92, v54, -v55
    v_cvt_pk_bf16_f32 v93, v56, -v57
    v_cvt_pk_bf16_f32 v94, v58, -v59
    v_cvt_pk_bf16_f32 v95, v60, -v61
    v_cvt_pk_bf16_f32 v96, v62, -v63
    v_cvt_pk_bf16_f32 v97, v64, -v65
    ds_write_addtid_b32 v88 offset:0
    ds_write_addtid_b32 v89 offset:272
    ds_write_addtid_b32 v90 offset:544
    ds_write_addtid_b32 v91 offset:816
    ds_write_addtid_b32 v92 offset:2176
    ds_write_addtid_b32 v93 offset:2448
    ds_write_addtid_b32 v94 offset:2720
    ds_write_addtid_b32 v95 offset:2992
    ds_write_addtid_b32 v96 offset:1088
    ds_write_addtid_b32 v96 offset:1360
    ds_write_addtid_b32 v97 offset:1632
    v_pk_mul_f32 v[66:67], v[54:55], v[40:41] op_sel:[0,0] op_sel_hi:[0,1]
    v_pk_fma_f32 v[66:67], v[54:55], v[40:41], v[66:67] op_sel:[1,1,0] op_sel_hi:[1,0,1] neg_lo:[0,1,0]
    v_pk_mul_f32 v[68:69], v[58:59], v[40:41] op_sel:[0,0] op_sel_hi:[0,1]
    v_pk_fma_f32 v[68:69], v[58:59], v[40:41], v[68:69] op_sel:[1,1,0] op_sel_hi:[1,0,1] neg_lo:[0,1,0]
    v_pk_mul_f32 v[70:71], v[62:63], v[40:41] op_sel:[0,0] op_sel_hi:[0,1]
    v_pk_fma_f32 v[70:71], v[62:63], v[40:41], v[70:71] op_sel:[1,1,0] op_sel_hi:[1,0,1] neg_lo:[0,1,0]
    v_pk_mul_f32 v[72:73], v[66:67], v[40:41] op_sel:[0,0] op_sel_hi:[0,1]
    v_pk_fma_f32 v[72:73], v[66:67], v[40:41], v[72:73] op_sel:[1,1,0] op_sel_hi:[1,0,1] neg_lo:[0,1,0]
    v_pk_mul_f32 v[74:75], v[70:71], v[40:41] op_sel:[0,0] op_sel_hi:[0,1]
    v_pk_fma_f32 v[74:75], v[70:71], v[40:41], v[74:75] op_sel:[1,1,0] op_sel_hi:[1,0,1] neg_lo:[0,1,0]
    v_pk_mul_f32 v[76:77], v[72:73], v[40:41] op_sel:[0,0] op_sel_hi:[0,1]
    v_pk_fma_f32 v[76:77], v[72:73], v[40:41], v[76:77] op_sel:[1,1,0] op_sel_hi:[1,0,1] neg_lo:[0,1,0]
    v_pk_mul_f32 v[78:79], v[74:75], v[40:41] op_sel:[0,0] op_sel_hi:[0,1]
    v_pk_fma_f32 v[78:79], v[74:75], v[40:41], v[78:79] op_sel:[1,1,0] op_sel_hi:[1,0,1] neg_lo:[0,1,0]
    v_pk_mul_f32 v[80:81], v[78:79], v[40:41] op_sel:[0,0] op_sel_hi:[0,1]
    v_pk_fma_f32 v[80:81], v[78:79], v[40:41], v[80:81] op_sel:[1,1,0] op_sel_hi:[1,0,1] neg_lo:[0,1,0]
    v_pk_mul_f32 v[82:83], v[80:81], v[40:41] op_sel:[0,0] op_sel_hi:[0,1]
    v_pk_fma_f32 v[82:83], v[80:81], v[40:41], v[82:83] op_sel:[1,1,0] op_sel_hi:[1,0,1] neg_lo:[0,1,0]
    v_pk_mul_f32 v[84:85], v[82:83], v[40:41] op_sel:[0,0] op_sel_hi:[0,1]
    v_pk_fma_f32 v[84:85], v[82:83], v[40:41], v[84:85] op_sel:[1,1,0] op_sel_hi:[1,0,1] neg_lo:[0,1,0]
    v_pk_mul_f32 v[86:87], v[84:85], v[40:41] op_sel:[0,0] op_sel_hi:[0,1]
    v_pk_fma_f32 v[86:87], v[84:85], v[40:41], v[86:87] op_sel:[1,1,0] op_sel_hi:[1,0,1] neg_lo:[0,1,0]
    v_cvt_pk_bf16_f32 v88, v66, -v67
    v_cvt_pk_bf16_f32 v89, v68, -v69
    v_cvt_pk_bf16_f32 v90, v70, -v71
    v_cvt_pk_bf16_f32 v91, v72, -v73
    v_cvt_pk_bf16_f32 v92, v74, -v75
    v_cvt_pk_bf16_f32 v93, v76, -v77
    v_cvt_pk_bf16_f32 v94, v78, -v79
    v_cvt_pk_bf16_f32 v95, v80, -v81
    v_cvt_pk_bf16_f32 v96, v82, -v83
    v_cvt_pk_bf16_f32 v97, v84, -v85
    v_cvt_pk_bf16_f32 v98, v86, -v87
    ds_write_addtid_b32 v88 offset:1904
    ds_write_addtid_b32 v88 offset:3264
    ds_write_addtid_b32 v88 offset:3536
    ds_write_addtid_b32 v89 offset:3808
    ds_write_addtid_b32 v90 offset:4352
    ds_write_addtid_b32 v91 offset:4624
    ds_write_addtid_b32 v92 offset:5440
    ds_write_addtid_b32 v93 offset:5712
    ds_write_addtid_b32 v94 offset:4896
    ds_write_addtid_b32 v95 offset:5984
    ds_write_addtid_b32 v96 offset:5168
    ds_write_addtid_b32 v97 offset:6256
    ds_write_addtid_b32 v98 offset:6528
    global_load_dwordx2 v[192:193], v4, s[36:37]
    ds_read_b128 v[100:103], v7 offset:0
    ds_read_b128 v[108:111], v7 offset:32
    ds_read_b128 v[116:119], v7 offset:64
    ds_read_b128 v[124:127], v7 offset:96
    ds_read_b128 v[132:135], v7 offset:128
    ds_read_b128 v[140:143], v7 offset:160
L_pg1:
    s_cbranch_execz L_w0
    s_nop 0
    ds_read_b128 v[148:151], v7 offset:192
    ds_read_b128 v[156:159], v7 offset:224
    v_and_b32 v30, 0xffff0000, v16
    v_and_b32 v31, 0xffff0000, v17
    v_and_b32 v32, 0xffff0000, v18
    v_and_b32 v33, 0xffff0000, v19
    v_and_b32 v34, 0xffff0000, v20
    v_and_b32 v35, 0xffff0000, v21
    v_mul_f32 v44, v28, v30
    v_mul_f32 v45, v28, v31
    v_mul_f32 v44, 0x3fb8aa3b, v44
    v_mul_f32_e64 v45, 0.15915494, v45
    v_mul_f32 v47, 0x41000000, v45
    v_mul_f32 v46, 0x41000000, v44
    v_fract_f32 v47, v47
    s_waitcnt lgkmcnt(7)
    v_mfma_f32_32x32x16_bf16 v[164:179], v[100:103], v[104:107], v[164:179]
    v_exp_f32 v46, v46
    v_cos_f32 v38, v47
    v_sin_f32 v39, v47
    s_waitcnt lgkmcnt(6)
    v_mfma_f32_32x32x16_bf16 v[164:179], v[108:111], v[112:115], v[164:179]
    v_mul_f32 v42, v32, v34
    v_mul_f32 v43, v32, v35
    v_mul_f32 v38, v38, v46
    v_mul_f32 v39, v39, v46
    v_fract_f32 v47, v45
    s_waitcnt lgkmcnt(5)
    v_mfma_f32_32x32x16_bf16 v[164:179], v[116:119], v[120:123], v[164:179]
    v_exp_f32 v46, v44
    v_cos_f32 v36, v47
    v_sin_f32 v37, v47
    s_waitcnt lgkmcnt(4)
    v_mfma_f32_32x32x16_bf16 v[164:179], v[124:127], v[128:131], v[164:179]
    v_fma_f32 v42, -v33, v35, v42
    v_fma_f32 v43, v33, v34, v43
    v_mul_f32 v36, v36, v46
    v_mul_f32 v37, v37, v46
    v_mul_f32 v47, 0x43800000, v45
    v_mul_f32 v46, 0x43800000, v44
    s_waitcnt lgkmcnt(3)
    v_mfma_f32_32x32x16_bf16 v[164:179], v[132:135], v[136:139], v[164:179]
    v_fract_f32 v47, v47
    v_exp_f32 v46, v46
    v_cos_f32 v40, v47
    v_sin_f32 v41, v47
    v_mul_f32 v42, v42, v28
    v_mul_f32 v43, v43, v28
    v_mul_f32 v40, v40, v46
    v_mul_f32_e64 v41, v41, v46
    v_pk_mul_f32 v[52:53], v[38:39], v[38:39] op_sel:[0,0] op_sel_hi:[0,1]
    v_pk_fma_f32 v[52:53], v[38:39], v[38:39], v[52:53] op_sel:[1,1,0] op_sel_hi:[1,0,1] neg_lo:[0,1,0]
    v_pk_mul_f32 v[54:55], v[52:53], v[38:39] op_sel:[0,0] op_sel_hi:[0,1]
    v_pk_fma_f32 v[54:55], v[52:53], v[38:39], v[54:55] op_sel:[1,1,0] op_sel_hi:[1,0,1] neg_lo:[0,1,0]
    v_pk_mul_f32 v[56:57], v[54:55], v[38:39] op_sel:[0,0] op_sel_hi:[0,1]
    v_pk_fma_f32 v[56:57], v[54:55], v[38:39], v[56:57] op_sel:[1,1,0] op_sel_hi:[1,0,1] neg_lo:[0,1,0]
    v_pk_mul_f32 v[58:59], v[56:57], v[38:39] op_sel:[0,0] op_sel_hi:[0,1]
    v_pk_fma_f32 v[58:59], v[56:57], v[38:39], v[58:59] op_sel:[1,1,0] op_sel_hi:[1,0,1] neg_lo:[0,1,0]
    v_pk_mul_f32 v[60:61], v[58:59], v[38:39] op_sel:[0,0] op_sel_hi:[0,1]
    v_pk_fma_f32 v[60:61], v[58:59], v[38:39], v[60:61] op_sel:[1,1,0] op_sel_hi:[1,0,1] neg_lo:[0,1,0]
    v_pk_mul_f32 v[62:63], v[60:61], v[38:39] op_sel:[0,0] op_sel_hi:[0,1]
    v_pk_fma_f32 v[62:63], v[60:61], v[38:39], v[62:63] op_sel:[1,1,0] op_sel_hi:[1,0,1] neg_lo:[0,1,0]
    v_pk_mul_f32 v[64:65], v[62:63], v[38:39] op_sel:[0,0] op_sel_hi:[0,1]
    v_pk_fma_f32 v[64:65], v[62:63], v[38:39], v[64:65] op_sel:[1,1,0] op_sel_hi:[1,0,1] neg_lo:[0,1,0]
    v_pk_mul_f32 v[66:67], v[64:65], v[38:39] op_sel:[0,0] op_sel_hi:[0,1]
    v_pk_fma_f32 v[66:67], v[64:65], v[38:39], v[66:67] op_sel:[1,1,0] op_sel_hi:[1,0,1] neg_lo:[0,1,0]
    v_pk_mul_f32 v[68:69], v[66:67], v[38:39] op_sel:[0,0] op_sel_hi:[0,1]
    v_pk_fma_f32 v[68:69], v[66:67], v[38:39], v[68:69] op_sel:[1,1,0] op_sel_hi:[1,0,1] neg_lo:[0,1,0]
    v_pk_mul_f32 v[70:71], v[68:69], v[38:39] op_sel:[0,0] op_sel_hi:[0,1]
    v_pk_fma_f32 v[70:71], v[68:69], v[38:39], v[70:71] op_sel:[1,1,0] op_sel_hi:[1,0,1] neg_lo:[0,1,0]
    s_nop 0
    s_waitcnt lgkmcnt(2)
    v_mfma_f32_32x32x16_bf16 v[164:179], v[140:143], v[144:147], v[164:179]
    v_cvt_pk_bf16_f32 v88, v38, v39
    v_cvt_pk_bf16_f32 v89, v52, v53
    v_cvt_pk_bf16_f32 v90, v54, v55
    v_cvt_pk_bf16_f32 v91, v56, v57
    v_cvt_pk_bf16_f32 v92, v58, v59
    v_cvt_pk_bf16_f32 v93, v60, v61
    s_waitcnt lgkmcnt(1)
    v_mfma_f32_32x32x16_bf16 v[164:179], v[148:151], v[152:155], v[164:179]
    v_cvt_pk_bf16_f32 v94, v62, v63
    v_cvt_pk_bf16_f32 v95, v64, v65
    v_cvt_pk_bf16_f32 v96, v66, v67
    v_cvt_pk_bf16_f32 v97, v68, v69
    v_cvt_pk_bf16_f32 v98, v70, v71
    ds_write_addtid_b32 v88 offset:8976
    s_waitcnt lgkmcnt(1)
    v_mfma_f32_32x32x16_bf16 v[164:179], v[156:159], v[160:163], v[164:179]
    ds_write_addtid_b32 v89 offset:9248
    ds_write_addtid_b32 v90 offset:9520
    ds_write_addtid_b32 v91 offset:9792
    ds_write_addtid_b32 v92 offset:10064
    ds_write_addtid_b32 v93 offset:10336
    ds_write_addtid_b32 v94 offset:10608
    ds_write_addtid_b32 v95 offset:10880
    ds_write_addtid_b32 v96 offset:11152
    ds_write_addtid_b32 v97 offset:11424
    ds_write_addtid_b32 v98 offset:11696
    v_pk_mul_f32 v[48:49], v[70:71], v[38:39] op_sel:[0,0] op_sel_hi:[0,1]
    v_pk_fma_f32 v[48:49], v[70:71], v[38:39], v[48:49] op_sel:[1,1,0] op_sel_hi:[1,0,1] neg_lo:[0,1,0]
    v_pk_mul_f32 v[50:51], v[48:49], v[38:39] op_sel:[0,0] op_sel_hi:[0,1]
    v_pk_fma_f32 v[50:51], v[48:49], v[38:39], v[50:51] op_sel:[1,1,0] op_sel_hi:[1,0,1] neg_lo:[0,1,0]
    v_pk_mul_f32 v[52:53], v[50:51], v[38:39] op_sel:[0,0] op_sel_hi:[0,1]
    v_pk_fma_f32 v[52:53], v[50:51], v[38:39], v[52:53] op_sel:[1,1,0] op_sel_hi:[1,0,1] neg_lo:[0,1,0]
    v_pk_mul_f32 v[54:55], v[52:53], v[38:39] op_sel:[0,0] op_sel_hi:[0,1]
    v_pk_fma_f32 v[54:55], v[52:53], v[38:39], v[54:55] op_sel:[1,1,0] op_sel_hi:[1,0,1] neg_lo:[0,1,0]
    v_pk_mul_f32 v[56:57], v[54:55], v[38:39] op_sel:[0,0] op_sel_hi:[0,1]
    v_pk_fma_f32 v[56:57], v[54:55], v[38:39], v[56:57] op_sel:[1,1,0] op_sel_hi:[1,0,1] neg_lo:[0,1,0]
    v_pk_mul_f32 v[58:59], v[56:57], v[38:39] op_sel:[0,0] op_sel_hi:[0,1]
    v_pk_fma_f32 v[58:59], v[56:57], v[38:39], v[58:59] op_sel:[1,1,0] op_sel_hi:[1,0,1] neg_lo:[0,1,0]
    v_pk_mul_f32 v[60:61], v[58:59], v[38:39] op_sel:[0,0] op_sel_hi:[0,1]
    v_pk_fma_f32 v[60:61], v[58:59], v[38:39], v[60:61] op_sel:[1,1,0] op_sel_hi:[1,0,1] neg_lo:[0,1,0]
    v_pk_mul_f32 v[62:63], v[60:61], v[38:39] op_sel:[0,0] op_sel_hi:[0,1]
    v_pk_fma_f32 v[62:63], v[60:61], v[38:39], v[62:63] op_sel:[1,1,0] op_sel_hi:[1,0,1] neg_lo:[0,1,0]
    v_pk_mul_f32 v[64:65], v[62:63], v[38:39] op_sel:[0,0] op_sel_hi:[0,1]
    v_pk_fma_f32 v[64:65], v[62:63], v[38:39], v[64:65] op_sel:[1,1,0] op_sel_hi:[1,0,1] neg_lo:[0,1,0]
    v_pk_mul_f32 v[66:67], v[64:65], v[38:39] op_sel:[0,0] op_sel_hi:[0,1]
    v_pk_fma_f32 v[66:67], v[64:65], v[38:39], v[66:67] op_sel:[1,1,0] op_sel_hi:[1,0,1] neg_lo:[0,1,0]
    v_cvt_pk_bf16_f32 v88, v48, v49
    v_cvt_pk_bf16_f32 v89, v50, v51
    v_cvt_pk_bf16_f32 v90, v52, v53
    v_cvt_pk_bf16_f32 v91, v54, v55
    v_cvt_pk_bf16_f32 v92, v56, v57
    v_cvt_pk_bf16_f32 v93, v58, v59
    v_cvt_pk_bf16_f32 v94, v60, v61
    v_cvt_pk_bf16_f32 v95, v62, v63
    v_cvt_pk_bf16_f32 v96, v64, v65
    v_cvt_pk_bf16_f32 v97, v66, v67
    ds_write_addtid_b32 v88 offset:11968
    ds_write_addtid_b32 v89 offset:12240
    ds_write_addtid_b32 v90 offset:12512
    ds_write_addtid_b32 v91 offset:12784
    ds_write_addtid_b32 v92 offset:13056
    ds_write_addtid_b32 v93 offset:13328
    ds_write_addtid_b32 v94 offset:13600
    ds_write_addtid_b32 v95 offset:13872
    ds_write_addtid_b32 v96 offset:14144
    ds_write_addtid_b32 v97 offset:14416
    global_load_dwordx2 v[194:195], v4, s[36:37] offset:1280
    v_lshlrev_b32_e64 v4, 4, v1
    v_pk_mul_f32 v[68:69], v[66:67], v[38:39] op_sel:[0,0] op_sel_hi:[0,1]
    v_pk_fma_f32 v[68:69], v[66:67], v[38:39], v[68:69] op_sel:[1,1,0] op_sel_hi:[1,0,1] neg_lo:[0,1,0]
    v_pk_mul_f32 v[70:71], v[68:69], v[38:39] op_sel:[0,0] op_sel_hi:[0,1]
    v_pk_fma_f32 v[70:71], v[68:69], v[38:39], v[70:71] op_sel:[1,1,0] op_sel_hi:[1,0,1] neg_lo:[0,1,0]
    v_pk_mul_f32 v[48:49], v[70:71], v[38:39] op_sel:[0,0] op_sel_hi:[0,1]
    v_pk_fma_f32 v[48:49], v[70:71], v[38:39], v[48:49] op_sel:[1,1,0] op_sel_hi:[1,0,1] neg_lo:[0,1,0]
    v_pk_mul_f32 v[50:51], v[48:49], v[38:39] op_sel:[0,0] op_sel_hi:[0,1]
    v_pk_fma_f32 v[50:51], v[48:49], v[38:39], v[50:51] op_sel:[1,1,0] op_sel_hi:[1,0,1] neg_lo:[0,1,0]
    v_pk_mul_f32 v[52:53], v[50:51], v[38:39] op_sel:[0,0] op_sel_hi:[0,1]
    v_pk_fma_f32 v[52:53], v[50:51], v[38:39], v[52:53] op_sel:[1,1,0] op_sel_hi:[1,0,1] neg_lo:[0,1,0]
    v_pk_mul_f32 v[54:55], v[52:53], v[38:39] op_sel:[0,0] op_sel_hi:[0,1]
    v_pk_fma_f32 v[54:55], v[52:53], v[38:39], v[54:55] op_sel:[1,1,0] op_sel_hi:[1,0,1] neg_lo:[0,1,0]
    v_pk_mul_f32 v[56:57], v[54:55], v[38:39] op_sel:[0,0] op_sel_hi:[0,1]
    v_pk_fma_f32 v[56:57], v[54:55], v[38:39], v[56:57] op_sel:[1,1,0] op_sel_hi:[1,0,1] neg_lo:[0,1,0]
    v_pk_mul_f32 v[58:59], v[56:57], v[38:39] op_sel:[0,0] op_sel_hi:[0,1]
    v_pk_fma_f32 v[58:59], v[56:57], v[38:39], v[58:59] op_sel:[1,1,0] op_sel_hi:[1,0,1] neg_lo:[0,1,0]
    v_pk_mul_f32 v[60:61], v[58:59], v[38:39] op_sel:[0,0] op_sel_hi:[0,1]
    v_pk_fma_f32 v[60:61], v[58:59], v[38:39], v[60:61] op_sel:[1,1,0] op_sel_hi:[1,0,1] neg_lo:[0,1,0]
    v_pk_mul_f32 v[62:63], v[60:61], v[38:39] op_sel:[0,0] op_sel_hi:[0,1]
    v_pk_fma_f32 v[62:63], v[60:61], v[38:39], v[62:63] op_sel:[1,1,0] op_sel_hi:[1,0,1] neg_lo:[0,1,0]
    v_cvt_pk_bf16_f32 v88, v68, v69
    v_cvt_pk_bf16_f32 v89, v70, v71
    v_cvt_pk_bf16_f32 v90, v48, v49
    v_cvt_pk_bf16_f32 v91, v50, v51
    v_cvt_pk_bf16_f32 v92, v52, v53
    v_cvt_pk_bf16_f32 v93, v54, v55
    v_cvt_pk_bf16_f32 v94, v56, v57
    v_cvt_pk_bf16_f32 v95, v58, v59
    v_cvt_pk_bf16_f32 v96, v60, v61
    v_cvt_pk_bf16_f32 v97, v62, v63
    ds_write_addtid_b32 v88 offset:14688
    ds_write_addtid_b32 v89 offset:14960
    ds_write_addtid_b32 v90 offset:15232
    ds_write_addtid_b32 v91 offset:15504
    ds_write_addtid_b32 v92 offset:15776
    ds_write_addtid_b32 v93 offset:16048
    ds_write_addtid_b32 v94 offset:16320
    ds_write_addtid_b32 v95 offset:16592
    ds_write_addtid_b32 v96 offset:16864
    ds_write_addtid_b32 v97 offset:17136
    ds_read_b128 v[104:107], v7 offset:8704
    ds_read_b128 v[112:115], v7 offset:8736
    ds_read_b128 v[120:123], v7 offset:8768
    ds_read_b128 v[128:131], v7 offset:8800
    ds_read_b128 v[136:139], v7 offset:8832
    ds_read_b128 v[144:147], v7 offset:8864
    ds_read_b128 v[152:155], v7 offset:8896
    ds_read_b128 v[160:163], v7 offset:8928
    v_pk_mul_f32 v[48:49], v[42:43], v[36:37] op_sel:[0,0] op_sel_hi:[0,1]
    v_pk_fma_f32 v[48:49], v[42:43], v[36:37], v[48:49] op_sel:[1,1,0] op_sel_hi:[1,0,1] neg_lo:[0,1,0]
    v_pk_mul_f32 v[50:51], v[48:49], v[36:37] op_sel:[0,0] op_sel_hi:[0,1]
    v_pk_fma_f32 v[50:51], v[48:49], v[36:37], v[50:51] op_sel:[1,1,0] op_sel_hi:[1,0,1] neg_lo:[0,1,0]
    v_pk_mul_f32 v[52:53], v[50:51], v[36:37] op_sel:[0,0] op_sel_hi:[0,1]
    v_pk_fma_f32 v[52:53], v[50:51], v[36:37], v[52:53] op_sel:[1,1,0] op_sel_hi:[1,0,1] neg_lo:[0,1,0]
    v_pk_mul_f32 v[54:55], v[52:53], v[36:37] op_sel:[0,0] op_sel_hi:[0,1]
    v_pk_fma_f32 v[54:55], v[52:53], v[36:37], v[54:55] op_sel:[1,1,0] op_sel_hi:[1,0,1] neg_lo:[0,1,0]
    v_pk_mul_f32 v[56:57], v[54:55], v[36:37] op_sel:[0,0] op_sel_hi:[0,1]
    v_pk_fma_f32 v[56:57], v[54:55], v[36:37], v[56:57] op_sel:[1,1,0] op_sel_hi:[1,0,1] neg_lo:[0,1,0]
    v_pk_mul_f32 v[58:59], v[56:57], v[36:37] op_sel:[0,0] op_sel_hi:[0,1]
    v_pk_fma_f32 v[58:59], v[56:57], v[36:37], v[58:59] op_sel:[1,1,0] op_sel_hi:[1,0,1] neg_lo:[0,1,0]
    v_pk_mul_f32 v[60:61], v[58:59], v[36:37] op_sel:[0,0] op_sel_hi:[0,1]
    v_pk_fma_f32 v[60:61], v[58:59], v[36:37], v[60:61] op_sel:[1,1,0] op_sel_hi:[1,0,1] neg_lo:[0,1,0]
    v_pk_mul_f32 v[62:63], v[42:43], v[40:41] op_sel:[0,0] op_sel_hi:[0,1]
    v_pk_fma_f32 v[62:63], v[42:43], v[40:41], v[62:63] op_sel:[1,1,0] op_sel_hi:[1,0,1] neg_lo:[0,1,0]
    v_pk_mul_f32 v[64:65], v[50:51], v[40:41] op_sel:[0,0] op_sel_hi:[0,1]
    v_pk_fma_f32 v[64:65], v[50:51], v[40:41], v[64:65] op_sel:[1,1,0] op_sel_hi:[1,0,1] neg_lo:[0,1,0]
    v_cvt_pk_bf16_f32 v88, v42, -v43
    v_cvt_pk_bf16_f32 v89, v48, -v49
    v_cvt_pk_bf16_f32 v90, v50, -v51
    v_cvt_pk_bf16_f32 v91, v52, -v53
    v_cvt_pk_bf16_f32 v92, v54, -v55
    v_cvt_pk_bf16_f32 v93, v56, -v57
    v_cvt_pk_bf16_f32 v94, v58, -v59
    v_cvt_pk_bf16_f32 v95, v60, -v61
    v_cvt_pk_bf16_f32 v96, v62, -v63
    v_cvt_pk_bf16_f32 v97, v64, -v65
    ds_write_addtid_b32 v88 offset:0
    ds_write_addtid_b32 v89 offset:272
    ds_write_addtid_b32 v90 offset:544
    ds_write_addtid_b32 v91 offset:816
    ds_write_addtid_b32 v92 offset:2176
    ds_write_addtid_b32 v93 offset:2448
    ds_write_addtid_b32 v94 offset:2720
    ds_write_addtid_b32 v95 offset:2992
    ds_write_addtid_b32 v96 offset:1088
    ds_write_addtid_b32 v96 offset:1360
    ds_write_addtid_b32 v97 offset:1632
    v_pk_mul_f32 v[66:67], v[54:55], v[40:41] op_sel:[0,0] op_sel_hi:[0,1]
    v_pk_fma_f32 v[66:67], v[54:55], v[40:41], v[66:67] op_sel:[1,1,0] op_sel_hi:[1,0,1] neg_lo:[0,1,0]
    v_pk_mul_f32 v[68:69], v[58:59], v[40:41] op_sel:[0,0] op_sel_hi:[0,1]
    v_pk_fma_f32 v[68:69], v[58:59], v[40:41], v[68:69] op_sel:[1,1,0] op_sel_hi:[1,0,1] neg_lo:[0,1,0]
    v_pk_mul_f32 v[70:71], v[62:63], v[40:41] op_sel:[0,0] op_sel_hi:[0,1]
    v_pk_fma_f32 v[70:71], v[62:63], v[40:41], v[70:71] op_sel:[1,1,0] op_sel_hi:[1,0,1] neg_lo:[0,1,0]
    v_pk_mul_f32 v[72:73], v[66:67], v[40:41] op_sel:[0,0] op_sel_hi:[0,1]
    v_pk_fma_f32 v[72:73], v[66:67], v[40:41], v[72:73] op_sel:[1,1,0] op_sel_hi:[1,0,1] neg_lo:[0,1,0]
    v_pk_mul_f32 v[74:75], v[70:71], v[40:41] op_sel:[0,0] op_sel_hi:[0,1]
    v_pk_fma_f32 v[74:75], v[70:71], v[40:41], v[74:75] op_sel:[1,1,0] op_sel_hi:[1,0,1] neg_lo:[0,1,0]
    v_pk_mul_f32 v[76:77], v[72:73], v[40:41] op_sel:[0,0] op_sel_hi:[0,1]
    v_pk_fma_f32 v[76:77], v[72:73], v[40:41], v[76:77] op_sel:[1,1,0] op_sel_hi:[1,0,1] neg_lo:[0,1,0]
    v_pk_mul_f32 v[78:79], v[74:75], v[40:41] op_sel:[0,0] op_sel_hi:[0,1]
    v_pk_fma_f32 v[78:79], v[74:75], v[40:41], v[78:79] op_sel:[1,1,0] op_sel_hi:[1,0,1] neg_lo:[0,1,0]
    v_pk_mul_f32 v[80:81], v[78:79], v[40:41] op_sel:[0,0] op_sel_hi:[0,1]
    v_pk_fma_f32 v[80:81], v[78:79], v[40:41], v[80:81] op_sel:[1,1,0] op_sel_hi:[1,0,1] neg_lo:[0,1,0]
    v_pk_mul_f32 v[82:83], v[80:81], v[40:41] op_sel:[0,0] op_sel_hi:[0,1]
    v_pk_fma_f32 v[82:83], v[80:81], v[40:41], v[82:83] op_sel:[1,1,0] op_sel_hi:[1,0,1] neg_lo:[0,1,0]
    v_pk_mul_f32 v[84:85], v[82:83], v[40:41] op_sel:[0,0] op_sel_hi:[0,1]
    v_pk_fma_f32 v[84:85], v[82:83], v[40:41], v[84:85] op_sel:[1,1,0] op_sel_hi:[1,0,1] neg_lo:[0,1,0]
    v_pk_mul_f32 v[86:87], v[84:85], v[40:41] op_sel:[0,0] op_sel_hi:[0,1]
    v_pk_fma_f32 v[86:87], v[84:85], v[40:41], v[86:87] op_sel:[1,1,0] op_sel_hi:[1,0,1] neg_lo:[0,1,0]
    v_cvt_pk_bf16_f32 v88, v66, -v67
    v_cvt_pk_bf16_f32 v89, v68, -v69
    v_cvt_pk_bf16_f32 v90, v70, -v71
    v_cvt_pk_bf16_f32 v91, v72, -v73
    v_cvt_pk_bf16_f32 v92, v74, -v75
    v_cvt_pk_bf16_f32 v93, v76, -v77
    v_cvt_pk_bf16_f32 v94, v78, -v79
    v_cvt_pk_bf16_f32 v95, v80, -v81
    v_cvt_pk_bf16_f32 v96, v82, -v83
    v_cvt_pk_bf16_f32 v97, v84, -v85
    v_cvt_pk_bf16_f32 v98, v86, -v87
    ds_write_addtid_b32 v88 offset:1904
    ds_write_addtid_b32 v88 offset:3264
    ds_write_addtid_b32 v88 offset:3536
    ds_write_addtid_b32 v89 offset:3808
    ds_write_addtid_b32 v90 offset:4352
    ds_write_addtid_b32 v91 offset:4624
    ds_write_addtid_b32 v92 offset:5440
    ds_write_addtid_b32 v93 offset:5712
    ds_write_addtid_b32 v94 offset:4896
    ds_write_addtid_b32 v95 offset:5984
    ds_write_addtid_b32 v96 offset:5168
    ds_write_addtid_b32 v97 offset:6256
    ds_write_addtid_b32 v98 offset:6528
    ds_read_b128 v[100:103], v7 offset:0
    ds_read_b128 v[108:111], v7 offset:32
    ds_read_b128 v[116:119], v7 offset:64
    ds_read_b128 v[124:127], v7 offset:96
    ds_read_b128 v[132:135], v7 offset:128
    ds_read_b128 v[140:143], v7 offset:160
    ds_read_b128 v[148:151], v7 offset:192
    ds_read_b128 v[156:159], v7 offset:224
    s_cmp_lg_u32 s20, 0
    s_cbranch_scc1 L_np1
    global_load_dword v29, v3, s[66:67] sc1
L_np1:
    s_lshl_b32 s16, s4, 12
    s_lshl_b32 s17, s5, 12
    s_lshl_b32 s18, s6, 12
    s_lshl_b32 s19, s7, 12
    v_add_u32 v86, 5603328, v4
    v_lshl_add_u32 v84, v0, 2, s26
    v_lshlrev_b32_e64 v85, 1, v0
    s_add_u32 s28, s26, 126
    v_sub_u32 v85, s28, v85
    v_mov_b32 v81, 0
    v_mov_b32 v64, 0
    v_mov_b32 v68, 0
    v_mov_b32 v69, 0
    v_cmp_eq_u32 s[24:25], 0, v0
    s_waitcnt lgkmcnt(7)
    v_mfma_f32_32x32x16_bf16 v[164:179], v[100:103], v[104:107], v[164:179]
    v_lshl_add_u32 v208, s4, 10, v251
    v_lshl_add_u32 v209, s5, 10, v251
    v_lshl_add_u32 v210, s6, 10, v251
    v_lshl_add_u32 v211, s7, 10, v251
    s_waitcnt vmcnt(6)
    v_lshlrev_b32_e64 v212, 16, v180
    s_waitcnt lgkmcnt(6)
    v_mfma_f32_32x32x16_bf16 v[164:179], v[108:111], v[112:115], v[164:179]
    v_and_b32 v214, 0xffff0000, v180
    v_lshlrev_b32_e64 v216, 16, v181
    v_and_b32 v218, 0xffff0000, v181
    v_lshlrev_b32_e64 v213, 16, v182
    v_and_b32 v215, 0xffff0000, v182
    v_lshlrev_b32 v217, 16, v183
    s_waitcnt lgkmcnt(5)
    v_mfma_f32_32x32x16_bf16 v[164:179], v[116:119], v[120:123], v[164:179]
    v_and_b32 v219, 0xffff0000, v183
    s_waitcnt vmcnt(4)
    v_lshlrev_b32 v220, 16, v184
    v_and_b32 v222, 0xffff0000, v184
    v_lshlrev_b32_e64 v224, 16, v185
    v_and_b32 v226, 0xffff0000, v185
    s_waitcnt lgkmcnt(4)
    v_mfma_f32_32x32x16_bf16 v[164:179], v[124:127], v[128:131], v[164:179]
    v_lshlrev_b32 v221, 16, v186
    v_and_b32 v223, 0xffff0000, v186
    v_lshlrev_b32 v225, 16, v187
    v_and_b32 v227, 0xffff0000, v187
    s_waitcnt vmcnt(2)
    v_lshlrev_b32 v228, 16, v188
    s_waitcnt lgkmcnt(3)
    v_mfma_f32_32x32x16_bf16 v[164:179], v[132:135], v[136:139], v[164:179]
    v_and_b32 v230, 0xffff0000, v188
    v_lshlrev_b32_e64 v232, 16, v189
    v_and_b32 v234, 0xffff0000, v189
    v_lshlrev_b32_e64 v229, 16, v190
    v_and_b32 v231, 0xffff0000, v190
    v_lshlrev_b32 v233, 16, v191
    s_waitcnt lgkmcnt(2)
    v_mfma_f32_32x32x16_bf16 v[164:179], v[140:143], v[144:147], v[164:179]
    v_and_b32 v235, 0xffff0000, v191
    s_waitcnt lgkmcnt(1)
    v_mfma_f32_32x32x16_bf16 v[164:179], v[148:151], v[152:155], v[164:179]
    s_waitcnt lgkmcnt(0)
    v_mfma_f32_32x32x16_bf16 v[164:179], v[156:159], v[160:163], v[164:179]
    s_cmp_lg_u32 s20, 0
    s_cbranch_scc1 S1_d
    s_waitcnt vmcnt(0)
    v_cmp_gt_u32 vcc, 16, v29
    s_cbranch_vccnz S1_r
S1_d:
    s_barrier
    buffer_load_dwordx4 v[32:35], v86, s[8:11], s16 offen sc1
    buffer_load_dwordx4 v[36:39], v86, s[8:11], s17 offen sc1
    buffer_load_dwordx4 v[40:43], v86, s[8:11], s18 offen sc1
    buffer_load_dwordx4 v[44:47], v86, s[8:11], s19 offen sc1
    s_nop 4
    s_nop 0
    v_mov_b32_dpp v90, v172 wave_rol:1 row_mask:0xf bank_mask:0xf
    v_mov_b32_dpp v91, v174 wave_rol:1 row_mask:0xf bank_mask:0xf
    v_mov_b32_dpp v92, v175 wave_rol:1 row_mask:0xf bank_mask:0xf
    v_mov_b32_dpp v93, v176 wave_rol:1 row_mask:0xf bank_mask:0xf
    v_mov_b32_dpp v90, v164 wave_shl:1 row_mask:0xf bank_mask:0xf
    v_mov_b32_dpp v91, v172 wave_shl:1 row_mask:0xf bank_mask:0xf
    v_mov_b32_dpp v92, v174 wave_shl:1 row_mask:0xf bank_mask:0xf
    v_mov_b32_dpp v93, v175 wave_shl:1 row_mask:0xf bank_mask:0xf
    v_cvt_pk_bf16_f32 v80, v164, v81
    v_mov_b32_dpp v171, v90 quad_perm:[0,1,2,3] row_mask:0xc bank_mask:0xf
    v_cvt_pk_bf16_f32 v66, v174, v174
    v_cvt_pk_bf16_f32 v82, v93, v92
    v_cndmask_b32 v80, v81, v80, s[24:25]
    v_cndmask_b32 v66, v81, v66, s[24:25]
    v_and_b32 v65, 0xffff0000, v66
    v_mov_b32_e64 v67, v66
    v_mov_b32 v70, v66
    v_mov_b32 v71, v66
    ds_write_b16 v85, v82
    ds_write_b16_d16_hi v85, v82 offset:128
    s_mov_b64 exec, 0xffff
    ds_write_b32 v84, v81 offset:256
    ds_write_b32 v84, v81 offset:4096
    ds_write_b32 v84, v80 offset:8256
    ds_write_b128 v252, v[64:67] offset:1024
    ds_write_b128 v252, v[68:71] offset:5184
    s_mov_b64 exec, -1
    s_nop 0
    buffer_load_dword v253, v254, s[12:15], s34 offen
    v_cvt_pk_bf16_f32 v48, v171, v170
    v_cvt_pk_bf16_f32 v49, v169, v168
    v_cvt_pk_bf16_f32 v50, v167, v166
    v_cvt_pk_bf16_f32 v51, v165, v164
    v_cvt_pk_bf16_f32 v52, v90, v171
    v_cvt_pk_bf16_f32 v53, v170, v169
    v_cvt_pk_bf16_f32 v54, v168, v167
    v_cvt_pk_bf16_f32 v55, v166, v165
    ds_write_b128 v252, v[48:51] offset:3072
    v_cvt_pk_bf16_f32 v56, v91, v91
    v_cvt_pk_bf16_f32 v57, v173, v173
    v_cvt_pk_bf16_f32 v58, v173, v172
    v_cvt_pk_bf16_f32 v59, v172, v172
    v_cvt_pk_bf16_f32 v60, v91, v91
    v_cvt_pk_bf16_f32 v61, v91, v173
    v_cvt_pk_bf16_f32 v62, v173, v173
    v_cvt_pk_bf16_f32 v63, v172, v172
    ds_write_b128 v252, v[52:55] offset:7232
    s_waitcnt vmcnt(5)
    v_lshlrev_b32 v236, 16, v192
    v_and_b32 v238, 0xffff0000, v192
    v_lshlrev_b32_e64 v240, 16, v193
    v_and_b32 v242, 0xffff0000, v193
    v_lshlrev_b32_e64 v237, 16, v194
    v_and_b32 v239, 0xffff0000, v194
    v_lshlrev_b32_e64 v241, 16, v195
    v_and_b32 v243, 0xffff0000, v195
    ds_write_b128 v252, v[56:59] offset:2048
    ds_write_b128 v252, v[60:63] offset:6208
    ds_read2_b32 v[48:49], v244 offset0:240 offset1:241
    ds_read2_b32 v[50:51], v244 offset0:242 offset1:243
    ds_read2_b32 v[52:53], v244 offset0:112 offset1:113
    ds_read2_b32 v[54:55], v244 offset0:114 offset1:115
    ds_read2_b32 v[56:57], v245 offset0:240 offset1:241
    ds_read2_b32 v[58:59], v245 offset0:242 offset1:243
    ds_read2_b32 v[60:61], v245 offset0:112 offset1:113
    ds_read2_b32 v[62:63], v245 offset0:114 offset1:115
    ds_read2_b32 v[64:65], v246 offset0:240 offset1:241
    ds_read2_b32 v[66:67], v246 offset0:242 offset1:243
    s_waitcnt vmcnt(4)
    v_pk_fma_f32 v[176:177], v[212:213], v[32:33], v[34:35] neg_lo:[0,0,1] neg_hi:[0,0,1]
    v_pk_fma_f32 v[178:179], v[214:215], v[32:33], v[34:35] neg_lo:[0,0,1] neg_hi:[0,0,1]
    v_pk_fma_f32 v[180:181], v[216:217], v[32:33], v[34:35] neg_lo:[0,0,1] neg_hi:[0,0,1]
    v_pk_fma_f32 v[182:183], v[218:219], v[32:33], v[34:35] neg_lo:[0,0,1] neg_hi:[0,0,1]
    v_cvt_pk_bf16_f32 v144, v176, v177
    v_cvt_pk_bf16_f32 v145, v178, v179
    v_cvt_pk_bf16_f32 v146, v180, v181
    v_cvt_pk_bf16_f32 v147, v182, v183
    s_waitcnt vmcnt(3)
    v_pk_fma_f32 v[184:185], v[220:221], v[36:37], v[38:39] neg_lo:[0,0,1] neg_hi:[0,0,1]
    v_pk_fma_f32 v[186:187], v[222:223], v[36:37], v[38:39] neg_lo:[0,0,1] neg_hi:[0,0,1]
    v_pk_fma_f32 v[188:189], v[224:225], v[36:37], v[38:39] neg_lo:[0,0,1] neg_hi:[0,0,1]
    v_pk_fma_f32 v[190:191], v[226:227], v[36:37], v[38:39] neg_lo:[0,0,1] neg_hi:[0,0,1]
    v_cvt_pk_bf16_f32 v148, v184, v185
    v_cvt_pk_bf16_f32 v149, v186, v187
    v_cvt_pk_bf16_f32 v150, v188, v189
    v_cvt_pk_bf16_f32 v151, v190, v191
    ds_write2st64_b32 v208, v144, v145 offset0:0 offset1:18
    ds_write2st64_b32 v208, v146, v147 offset0:36 offset1:54
    ds_write2st64_b32 v209, v148, v149 offset0:0 offset1:18
    ds_write2st64_b32 v209, v150, v151 offset0:36 offset1:54
    s_waitcnt vmcnt(2)
    v_pk_fma_f32 v[192:193], v[228:229], v[40:41], v[42:43] neg_lo:[0,0,1] neg_hi:[0,0,1]
    v_pk_fma_f32 v[194:195], v[230:231], v[40:41], v[42:43] neg_lo:[0,0,1] neg_hi:[0,0,1]
    v_pk_fma_f32 v[196:197], v[232:233], v[40:41], v[42:43] neg_lo:[0,0,1] neg_hi:[0,0,1]
    v_pk_fma_f32 v[198:199], v[234:235], v[40:41], v[42:43] neg_lo:[0,0,1] neg_hi:[0,0,1]
    v_cvt_pk_bf16_f32 v152, v192, v193
    v_cvt_pk_bf16_f32 v153, v194, v195
    v_cvt_pk_bf16_f32 v154, v196, v197
    v_cvt_pk_bf16_f32 v155, v198, v199
    s_waitcnt vmcnt(1)
    v_pk_fma_f32 v[200:201], v[236:237], v[44:45], v[46:47] neg_lo:[0,0,1] neg_hi:[0,0,1]
    v_pk_fma_f32 v[202:203], v[238:239], v[44:45], v[46:47] neg_lo:[0,0,1] neg_hi:[0,0,1]
    v_pk_fma_f32 v[204:205], v[240:241], v[44:45], v[46:47] neg_lo:[0,0,1] neg_hi:[0,0,1]
    v_pk_fma_f32 v[206:207], v[242:243], v[44:45], v[46:47] neg_lo:[0,0,1] neg_hi:[0,0,1]
    v_cvt_pk_bf16_f32 v156, v200, v201
    v_cvt_pk_bf16_f32 v157, v202, v203
    v_cvt_pk_bf16_f32 v158, v204, v205
    v_cvt_pk_bf16_f32 v159, v206, v207
    ds_write2st64_b32 v210, v152, v153 offset0:0 offset1:18
    ds_write2st64_b32 v210, v154, v155 offset0:36 offset1:54
    ds_write2st64_b32 v211, v156, v157 offset0:0 offset1:18
    ds_write2st64_b32 v211, v158, v159 offset0:36 offset1:54
    s_waitcnt lgkmcnt(0)
    s_barrier
    ds_read_b128 v[80:83], v248 offset:448
    ds_read_b128 v[84:87], v248 offset:960
    ds_read_b128 v[88:91], v248 offset:1472
    ds_read_b128 v[92:95], v248 offset:1984
    ds_read_b128 v[96:99], v248 offset:2496
    ds_read_b128 v[100:103], v248 offset:3008
    ds_read_b128 v[104:107], v248 offset:3520
    ds_read_b128 v[108:111], v248 offset:4032
    s_and_b32 s33, s31, 0xffff0000
    s_lshl_b32 s32, s31, 16
    s_and_b32 s31, s30, 0xffff0000
    s_lshl_b32 s30, s30, 16
    s_waitcnt lgkmcnt(7)
    v_mfma_f32_16x16x32_bf16 v[16:19], v[48:51], v[80:83], 0
    v_fmac_f32 v212, s30, v176
    v_mfma_f32_16x16x32_bf16 v[20:23], v[52:55], v[80:83], 0
    v_fmac_f32 v213, s30, v177
    v_mfma_f32_16x16x32_bf16 v[24:27], v[56:59], v[80:83], 0
    v_fmac_f32 v214, s31, v178
    v_mfma_f32_16x16x32_bf16 v[28:31], v[60:63], v[80:83], 0
    v_fmac_f32_e64 v215, s31, v179
    v_mfma_f32_16x16x32_bf16 v[32:35], v[64:67], v[80:83], 0
    v_fmac_f32_e64 v216, s32, v180
    s_waitcnt lgkmcnt(6)
    v_mfma_f32_16x16x32_bf16 v[20:23], v[48:51], v[84:87], v[20:23]
    v_fmac_f32 v217, s32, v181
    v_mfma_f32_16x16x32_bf16 v[24:27], v[52:55], v[84:87], v[24:27]
    v_fmac_f32_e64 v218, s33, v182
    ds_read2_b32 v[112:113], v244 offset0:224 offset1:225
    v_mfma_f32_16x16x32_bf16 v[28:31], v[56:59], v[84:87], v[28:31]
    v_fmac_f32_e64 v219, s33, v183
    ds_read2_b32 v[114:115], v244 offset0:226 offset1:227
    v_mfma_f32_16x16x32_bf16 v[32:35], v[60:63], v[84:87], v[32:35]
    v_fmac_f32_e64 v220, s30, v184
    ds_read2_b32 v[116:117], v244 offset0:96 offset1:97
    v_mfma_f32_16x16x32_bf16 v[36:39], v[64:67], v[84:87], 0
    v_fmac_f32_e64 v221, s30, v185
    ds_read2_b32 v[118:119], v244 offset0:98 offset1:99
    s_waitcnt lgkmcnt(9)
    v_mfma_f32_16x16x32_bf16 v[24:27], v[48:51], v[88:91], v[24:27]
    s_add_u32 m0, s75, 0
    ds_read2_b32 v[120:121], v245 offset0:224 offset1:225
    v_mfma_f32_16x16x32_bf16 v[28:31], v[52:55], v[88:91], v[28:31]
    v_fmac_f32_e64 v222, s31, v186
    ds_read2_b32 v[122:123], v245 offset0:226 offset1:227
    v_mfma_f32_16x16x32_bf16 v[32:35], v[56:59], v[88:91], v[32:35]
    buffer_load_dwordx4 v8, s[12:15], 0 offen offset:0 lds
    ds_read2_b32 v[124:125], v245 offset0:96 offset1:97
    v_mfma_f32_16x16x32_bf16 v[36:39], v[60:63], v[88:91], v[36:39]
    v_fmac_f32_e64 v223, s31, v187
    ds_read2_b32 v[126:127], v245 offset0:98 offset1:99
    v_mfma_f32_16x16x32_bf16 v[40:43], v[64:67], v[88:91], 0
    v_fmac_f32 v224, s32, v188
    ds_read_b128 v[144:147], v248 offset:384
    s_waitcnt lgkmcnt(13)
    v_mfma_f32_16x16x32_bf16 v[28:31], v[48:51], v[92:95], v[28:31]
    v_fmac_f32_e64 v225, s32, v189
    ds_read_b128 v[148:151], v248 offset:896
    v_mfma_f32_16x16x32_bf16 v[32:35], v[52:55], v[92:95], v[32:35]
    buffer_load_dwordx4 v9, s[12:15], 0 offen offset:1024 lds
    ds_read_b128 v[152:155], v248 offset:1408
    v_mfma_f32_16x16x32_bf16 v[36:39], v[56:59], v[92:95], v[36:39]
    v_fmac_f32_e64 v226, s33, v190
    ds_read_b128 v[156:159], v248 offset:1920
    v_mfma_f32_16x16x32_bf16 v[40:43], v[60:63], v[92:95], v[40:43]
    v_fmac_f32_e64 v227, s33, v191
    ds_read_b128 v[160:163], v248 offset:2432
    v_mfma_f32_16x16x32_bf16 v[44:47], v[64:67], v[92:95], 0
    v_fmac_f32_e64 v228, s30, v192
    ds_read_b128 v[164:167], v248 offset:2944
    s_waitcnt lgkmcnt(15)
    v_mfma_f32_16x16x32_bf16 v[32:35], v[48:51], v[96:99], v[32:35]
    v_fmac_f32 v229, s30, v193
    ds_read_b128 v[168:171], v248 offset:3456
    v_mfma_f32_16x16x32_bf16 v[36:39], v[52:55], v[96:99], v[36:39]
    buffer_load_dwordx4 v10, s[12:15], 0 offen offset:2048 lds
    ds_read_b128 v[172:175], v248 offset:3968
    v_mfma_f32_16x16x32_bf16 v[40:43], v[56:59], v[96:99], v[40:43]
    v_fmac_f32 v230, s31, v194
    v_mfma_f32_16x16x32_bf16 v[44:47], v[60:63], v[96:99], v[44:47]
    v_fmac_f32 v231, s31, v195
    v_mfma_f32_16x16x32_bf16 v[36:39], v[48:51], v[100:103], v[36:39]
    v_fmac_f32 v232, s32, v196
    v_mfma_f32_16x16x32_bf16 v[40:43], v[52:55], v[100:103], v[40:43]
    v_fmac_f32 v233, s32, v197
    v_mfma_f32_16x16x32_bf16 v[44:47], v[56:59], v[100:103], v[44:47]
    buffer_load_dwordx4 v11, s[12:15], 0 offen offset:3072 lds
    v_mfma_f32_16x16x32_bf16 v[40:43], v[48:51], v[104:107], v[40:43]
L_pg2:
    s_cbranch_execz L_w0
    v_fmac_f32 v234, s33, v198
    v_mfma_f32_16x16x32_bf16 v[44:47], v[52:55], v[104:107], v[44:47]
    s_add_u32 m0, s75, 3968
    s_waitcnt lgkmcnt(15)
    v_mfma_f32_16x16x32_bf16 v[44:47], v[48:51], v[108:111], v[44:47]
    s_waitcnt lgkmcnt(6)
    v_mfma_f32_16x16x32_bf16 v[16:19], v[112:115], v[144:147], v[16:19]
    buffer_load_dwordx4 v8, s[12:15], 0 offen offset:128 lds
    ds_read2_b32 v[48:49], v244 offset0:208 offset1:209
    v_mfma_f32_16x16x32_bf16 v[20:23], v[116:119], v[144:147], v[20:23]
    v_fmac_f32_e64 v235, s33, v199
    ds_read2_b32 v[50:51], v244 offset0:210 offset1:211
    v_mfma_f32_16x16x32_bf16 v[24:27], v[120:123], v[144:147], v[24:27]
    v_fmac_f32_e64 v236, s30, v200
    ds_read2_b32 v[52:53], v244 offset0:80 offset1:81
    v_mfma_f32_16x16x32_bf16 v[28:31], v[124:127], v[144:147], v[28:31]
    v_fmac_f32_e64 v237, s30, v201
    ds_read2_b32 v[54:55], v244 offset0:82 offset1:83
    v_mfma_f32_16x16x32_bf16 v[20:23], v[112:115], v[148:151], v[20:23]
    buffer_load_dwordx4 v9, s[12:15], 0 offen offset:1152 lds
    ds_read2_b32 v[56:57], v245 offset0:208 offset1:209
    v_mfma_f32_16x16x32_bf16 v[24:27], v[116:119], v[148:151], v[24:27]
    v_fmac_f32_e64 v238, s31, v202
    ds_read2_b32 v[58:59], v245 offset0:210 offset1:211
    v_mfma_f32_16x16x32_bf16 v[28:31], v[120:123], v[148:151], v[28:31]
    v_fmac_f32_e64 v239, s31, v203
    ds_read2_b32 v[60:61], v245 offset0:80 offset1:81
    v_mfma_f32_16x16x32_bf16 v[32:35], v[124:127], v[148:151], v[32:35]
    ds_read2_b32 v[62:63], v245 offset0:82 offset1:83
    s_waitcnt lgkmcnt(8)
    v_mfma_f32_16x16x32_bf16 v[24:27], v[112:115], v[152:155], v[24:27]
    v_fmac_f32 v240, s32, v204
    ds_read_b128 v[80:83], v248 offset:320
    v_mfma_f32_16x16x32_bf16 v[28:31], v[116:119], v[152:155], v[28:31]
    buffer_load_dwordx4 v10, s[12:15], 0 offen offset:2176 lds
    ds_read_b128 v[84:87], v248 offset:832
    v_mfma_f32_16x16x32_bf16 v[32:35], v[120:123], v[152:155], v[32:35]
    v_fmac_f32_e64 v241, s32, v205
    ds_read_b128 v[88:91], v248 offset:1344
    v_mfma_f32_16x16x32_bf16 v[36:39], v[124:127], v[152:155], v[36:39]
    v_fmac_f32_e64 v242, s33, v206
    ds_read_b128 v[92:95], v248 offset:1856
    v_mfma_f32_16x16x32_bf16 v[28:31], v[112:115], v[156:159], v[28:31]
    v_fmac_f32_e64 v243, s33, v207
    ds_read_b128 v[96:99], v248 offset:2368
    v_mfma_f32_16x16x32_bf16 v[32:35], v[116:119], v[156:159], v[32:35]
    v_lshl_add_u32 v208, s4, 11, v250
    ds_read_b128 v[100:103], v248 offset:2880
    v_mfma_f32_16x16x32_bf16 v[36:39], v[120:123], v[156:159], v[36:39]
    buffer_load_dwordx4 v11, s[12:15], 0 offen offset:3200 lds
    ds_read_b128 v[104:107], v248 offset:3392
    v_mfma_f32_16x16x32_bf16 v[40:43], v[124:127], v[156:159], v[40:43]
    v_lshl_add_u32 v209, s5, 11, v250
    ds_read_b128 v[108:111], v248 offset:3904
    v_mfma_f32_16x16x32_bf16 v[32:35], v[112:115], v[160:163], v[32:35]
    s_add_u32 m0, s75, 7936
    v_mfma_f32_16x16x32_bf16 v[36:39], v[116:119], v[160:163], v[36:39]
    v_lshl_add_u32 v210, s6, 11, v250
    v_mfma_f32_16x16x32_bf16 v[40:43], v[120:123], v[160:163], v[40:43]
    buffer_load_dwordx4 v8, s[12:15], 0 offen offset:256 lds
    v_mfma_f32_16x16x32_bf16 v[44:47], v[124:127], v[160:163], v[44:47]
    v_lshl_add_u32 v211, s7, 11, v250
    v_mfma_f32_16x16x32_bf16 v[36:39], v[112:115], v[164:167], v[36:39]
    v_lshl_add_u32 v4, s23, 14, v4
    v_mfma_f32_16x16x32_bf16 v[40:43], v[116:119], v[164:167], v[40:43]
    v_mfma_f32_16x16x32_bf16 v[44:47], v[120:123], v[164:167], v[44:47]
    buffer_load_dwordx4 v9, s[12:15], 0 offen offset:1280 lds
    v_mfma_f32_16x16x32_bf16 v[40:43], v[112:115], v[168:171], v[40:43]
    v_mfma_f32_16x16x32_bf16 v[44:47], v[116:119], v[168:171], v[44:47]
    v_mfma_f32_16x16x32_bf16 v[44:47], v[112:115], v[172:175], v[44:47]
    s_waitcnt lgkmcnt(6)
    s_nop 0
    v_mfma_f32_16x16x32_bf16 v[16:19], v[48:51], v[80:83], v[16:19]
    ds_read2_b32 v[112:113], v244 offset0:192 offset1:193
    v_mfma_f32_16x16x32_bf16 v[20:23], v[52:55], v[80:83], v[20:23]
    buffer_load_dwordx4 v10, s[12:15], 0 offen offset:2304 lds
    ds_read2_b32 v[114:115], v244 offset0:194 offset1:195
    v_mfma_f32_16x16x32_bf16 v[24:27], v[56:59], v[80:83], v[24:27]
    ds_read2_b32 v[116:117], v244 offset0:64 offset1:65
    v_mfma_f32_16x16x32_bf16 v[28:31], v[60:63], v[80:83], v[28:31]
    ds_read2_b32 v[118:119], v244 offset0:66 offset1:67
    v_mfma_f32_16x16x32_bf16 v[20:23], v[48:51], v[84:87], v[20:23]
    ds_read2_b32 v[120:121], v245 offset0:192 offset1:193
    v_mfma_f32_16x16x32_bf16 v[24:27], v[52:55], v[84:87], v[24:27]
    ds_read2_b32 v[122:123], v245 offset0:194 offset1:195
    v_mfma_f32_16x16x32_bf16 v[28:31], v[56:59], v[84:87], v[28:31]
    buffer_load_dwordx4 v11, s[12:15], 0 offen offset:3328 lds
    ds_read2_b32 v[124:125], v245 offset0:64 offset1:65
    v_mfma_f32_16x16x32_bf16 v[32:35], v[60:63], v[84:87], v[32:35]
    ds_read2_b32 v[126:127], v245 offset0:66 offset1:67
    s_nop 0
    s_waitcnt lgkmcnt(8)
    v_mfma_f32_16x16x32_bf16 v[24:27], v[48:51], v[88:91], v[24:27]
    s_add_u32 m0, s75, 11904
    ds_read_b128 v[144:147], v248 offset:256
    v_mfma_f32_16x16x32_bf16 v[28:31], v[52:55], v[88:91], v[28:31]
    ds_read_b128 v[148:151], v248 offset:768
    v_mfma_f32_16x16x32_bf16 v[32:35], v[56:59], v[88:91], v[32:35]
    buffer_load_dwordx4 v8, s[12:15], 0 offen offset:384 lds
    ds_read_b128 v[128:131], v248 offset:432
    v_mfma_f32_16x16x32_bf16 v[36:39], v[60:63], v[88:91], v[36:39]
    ds_read_b128 v[132:135], v248 offset:448
    v_mfma_f32_16x16x32_bf16 v[28:31], v[48:51], v[92:95], v[28:31]
    ds_read_b128 v[152:155], v248 offset:1280
    v_mfma_f32_16x16x32_bf16 v[32:35], v[52:55], v[92:95], v[32:35]
    ds_read_b128 v[156:159], v248 offset:1792
    v_mfma_f32_16x16x32_bf16 v[36:39], v[56:59], v[92:95], v[36:39]
    buffer_load_dwordx4 v9, s[12:15], 0 offen offset:1408 lds
    ds_read_b128 v[160:163], v248 offset:2304
    v_mfma_f32_16x16x32_bf16 v[40:43], v[60:63], v[92:95], v[40:43]
    s_waitcnt vmcnt(10)
    ds_read_b128 v[164:167], v248 offset:2816
    v_mfma_f32_16x16x32_bf16 v[32:35], v[48:51], v[96:99], v[32:35]
    ds_read_b128 a[0:3], v12 offset:0
    v_mfma_f32_16x16x32_bf16 v[36:39], v[52:55], v[96:99], v[36:39]
    ds_read_b128 a[4:7], v12 offset:2048
    v_mfma_f32_16x16x32_bf16 v[40:43], v[56:59], v[96:99], v[40:43]
    s_nop 0
    ds_read_b128 v[168:171], v248 offset:3328
    v_mfma_f32_16x16x32_bf16 v[44:47], v[60:63], v[96:99], v[44:47]
    buffer_load_dwordx4 v10, s[12:15], 0 offen offset:2432 lds
    ds_read_b128 v[172:175], v248 offset:3840
    v_mfma_f32_16x16x32_bf16 v[36:39], v[48:51], v[100:103], v[36:39]
    ds_read_b128 a[8:11], v13 offset:0
    v_mfma_f32_16x16x32_bf16 v[40:43], v[52:55], v[100:103], v[40:43]
    ds_read_b128 a[12:15], v13 offset:2048
    v_mfma_f32_16x16x32_bf16 v[44:47], v[56:59], v[100:103], v[44:47]
    v_mfma_f32_16x16x32_bf16 v[40:43], v[48:51], v[104:107], v[40:43]
    v_mfma_f32_16x16x32_bf16 v[44:47], v[52:55], v[104:107], v[44:47]
    buffer_load_dwordx4 v11, s[12:15], 0 offen offset:3456 lds
    v_mfma_f32_16x16x32_bf16 v[44:47], v[48:51], v[108:111], v[44:47]
    s_waitcnt lgkmcnt(10)
    v_mfma_f32_16x16x32_bf16 v[136:139], v[128:131], a[248:251], 0
    s_add_u32 m0, s75, -512
    v_mfma_f32_16x16x32_bf16 v[140:143], v[132:135], a[252:255], 0
    s_waitcnt lgkmcnt(0)
    v_mfma_f32_16x16x32_bf16 v[16:19], v[112:115], v[144:147], v[16:19]
    buffer_load_dwordx4 v8, s[12:15], 0 offen offset:512 lds
    ds_read2_b32 v[48:49], v244 offset0:176 offset1:177
    v_mfma_f32_16x16x32_bf16 v[20:23], v[116:119], v[144:147], v[20:23]
    ds_read2_b32 v[50:51], v244 offset0:178 offset1:179
    v_mfma_f32_16x16x32_bf16 v[24:27], v[120:123], v[144:147], v[24:27]
    ds_read2_b32 v[52:53], v244 offset0:48 offset1:49
    v_mfma_f32_16x16x32_bf16 v[28:31], v[124:127], v[144:147], v[28:31]
    ds_read2_b32 v[54:55], v244 offset0:50 offset1:51
    v_mfma_f32_16x16x32_bf16 v[20:23], v[112:115], v[148:151], v[20:23]
    buffer_load_dwordx4 v9, s[12:15], 0 offen offset:1536 lds
    ds_read2_b32 v[56:57], v245 offset0:176 offset1:177
    v_mfma_f32_16x16x32_bf16 v[24:27], v[116:119], v[148:151], v[24:27]
    s_waitcnt vmcnt(10)
    ds_read2_b32 v[58:59], v245 offset0:178 offset1:179
    v_mfma_f32_16x16x32_bf16 v[28:31], v[120:123], v[148:151], v[28:31]
    s_nop 0
    ds_read_b128 a[16:19], v12 offset:4096
    v_mfma_f32_16x16x32_bf16 v[32:35], v[124:127], v[148:151], v[32:35]
    ds_read_b128 a[20:23], v12 offset:6144
    v_mfma_f32_16x16x32_bf16 v[24:27], v[112:115], v[152:155], v[24:27]
    v_cvt_pk_bf16_f32 v176, v136, v140
    ds_read2_b32 v[60:61], v245 offset0:48 offset1:49
    v_mfma_f32_16x16x32_bf16 v[28:31], v[116:119], v[152:155], v[28:31]
    buffer_load_dwordx4 v10, s[12:15], 0 offen offset:2560 lds
    ds_read2_b32 v[62:63], v245 offset0:50 offset1:51
    v_mfma_f32_16x16x32_bf16 v[32:35], v[120:123], v[152:155], v[32:35]
    ds_read_b128 a[24:27], v13 offset:4096
    v_mfma_f32_16x16x32_bf16 v[36:39], v[124:127], v[152:155], v[36:39]
    ds_read_b128 a[28:31], v13 offset:6144
    v_mfma_f32_16x16x32_bf16 v[28:31], v[112:115], v[156:159], v[28:31]
    v_cvt_pk_bf16_f32 v177, v137, v141
    ds_read_b128 v[80:83], v248 offset:192
    v_mfma_f32_16x16x32_bf16 v[32:35], v[116:119], v[156:159], v[32:35]
    v_cvt_pk_bf16_f32 v178, v138, v142
    ds_read_b128 v[84:87], v248 offset:704
    v_mfma_f32_16x16x32_bf16 v[36:39], v[120:123], v[156:159], v[36:39]
    buffer_load_dwordx4 v11, s[12:15], 0 offen offset:3584 lds
    ds_read_b128 v[128:131], v248 offset:944
    v_mfma_f32_16x16x32_bf16 v[40:43], v[124:127], v[156:159], v[40:43]
    v_cvt_pk_bf16_f32 v179, v139, v143
    ds_read_b128 v[132:135], v248 offset:960
    v_mfma_f32_16x16x32_bf16 v[32:35], v[112:115], v[160:163], v[32:35]
    s_add_u32 m0, s75, 3456
    ds_read_b128 v[88:91], v248 offset:1216
    v_mfma_f32_16x16x32_bf16 v[36:39], v[116:119], v[160:163], v[36:39]
    s_waitcnt lgkmcnt(5)
    s_nop 0
    ds_read_b128 v[92:95], v248 offset:1728
    v_mfma_f32_16x16x32_bf16 v[40:43], v[120:123], v[160:163], v[40:43]
    buffer_load_dwordx4 v8, s[12:15], 0 offen offset:640 lds
    ds_read_b128 v[96:99], v248 offset:2240
    v_mfma_f32_16x16x32_bf16 v[44:47], v[124:127], v[160:163], v[44:47]
    ds_read_b128 v[100:103], v248 offset:2752
    ds_read_b128 v[104:107], v248 offset:3264
    v_mfma_f32_16x16x32_bf16 v[36:39], v[112:115], v[164:167], v[36:39]
    ds_read_b128 v[108:111], v248 offset:3776
    s_nop 0
    v_mfma_f32_16x16x32_bf16 v[40:43], v[116:119], v[164:167], v[40:43]
    v_mfma_f32_16x16x32_bf16 v[44:47], v[120:123], v[164:167], v[44:47]
    buffer_load_dwordx4 v9, s[12:15], 0 offen offset:1664 lds
    v_mfma_f32_16x16x32_bf16 v[40:43], v[112:115], v[168:171], v[40:43]
    s_waitcnt vmcnt(10)
    v_mfma_f32_16x16x32_bf16 v[44:47], v[116:119], v[168:171], v[44:47]
    ds_read_b128 a[32:35], v12 offset:8192
    v_mfma_f32_16x16x32_bf16 v[44:47], v[112:115], v[172:175], v[44:47]
    ds_read_b128 a[36:39], v12 offset:10240
    s_waitcnt lgkmcnt(8)
    v_mfma_f32_16x16x32_bf16 v[136:139], v[128:131], a[248:251], 0
    s_nop 0
    v_mfma_f32_16x16x32_bf16 v[140:143], v[132:135], a[252:255], 0
    buffer_load_dwordx4 v10, s[12:15], 0 offen offset:2688 lds
    v_mfma_f32_16x16x32_bf16 v[16:19], v[48:51], v[80:83], v[16:19]
    ds_read_b128 a[40:43], v13 offset:8192
    v_mfma_f32_16x16x32_bf16 v[20:23], v[52:55], v[80:83], v[20:23]
    ds_read_b128 a[44:47], v13 offset:10240
    v_mfma_f32_16x16x32_bf16 v[24:27], v[56:59], v[80:83], v[24:27]
    ds_read2_b32 v[112:113], v244 offset0:160 offset1:161
    v_mfma_f32_16x16x32_bf16 v[28:31], v[60:63], v[80:83], v[28:31]
    ds_read2_b32 v[114:115], v244 offset0:162 offset1:163
    v_mfma_f32_16x16x32_bf16 v[20:23], v[48:51], v[84:87], v[20:23]
    buffer_load_dwordx4 v11, s[12:15], 0 offen offset:3712 lds
    ds_read2_b32 v[116:117], v244 offset0:32 offset1:33
    v_mfma_f32_16x16x32_bf16 v[24:27], v[52:55], v[84:87], v[24:27]
    v_cvt_pk_bf16_f32 v180, v136, v140
    ds_read2_b32 v[118:119], v244 offset0:34 offset1:35
    v_mfma_f32_16x16x32_bf16 v[28:31], v[56:59], v[84:87], v[28:31]
    s_add_u32 m0, s75, 7424
    ds_read2_b32 v[120:121], v245 offset0:160 offset1:161
    v_mfma_f32_16x16x32_bf16 v[32:35], v[60:63], v[84:87], v[32:35]
    s_waitcnt lgkmcnt(5)
    s_nop 0
    ds_read2_b32 v[122:123], v245 offset0:162 offset1:163
    v_mfma_f32_16x16x32_bf16 v[24:27], v[48:51], v[88:91], v[24:27]
    buffer_load_dwordx4 v8, s[12:15], 0 offen offset:768 lds
    ds_read2_b32 v[124:125], v245 offset0:32 offset1:33
    v_mfma_f32_16x16x32_bf16 v[28:31], v[52:55], v[88:91], v[28:31]
    v_cvt_pk_bf16_f32 v181, v137, v141
    ds_read2_b32 v[126:127], v245 offset0:34 offset1:35
    v_mfma_f32_16x16x32_bf16 v[32:35], v[56:59], v[88:91], v[32:35]
    v_cvt_pk_bf16_f32 v182, v138, v142
    ds_read_b128 v[144:147], v248 offset:128
    v_mfma_f32_16x16x32_bf16 v[36:39], v[60:63], v[88:91], v[36:39]
    v_cvt_pk_bf16_f32 v183, v139, v143
    ds_read_b128 v[148:151], v248 offset:640
    v_mfma_f32_16x16x32_bf16 v[28:31], v[48:51], v[92:95], v[28:31]
    buffer_load_dwordx4 v9, s[12:15], 0 offen offset:1792 lds
    ds_read_b128 v[128:131], v248 offset:1456
    v_mfma_f32_16x16x32_bf16 v[32:35], v[52:55], v[92:95], v[32:35]
    s_waitcnt vmcnt(10)
    ds_read_b128 v[132:135], v248 offset:1472
    v_mfma_f32_16x16x32_bf16 v[36:39], v[56:59], v[92:95], v[36:39]
    ds_read_b128 a[48:51], v12 offset:12288
    v_mfma_f32_16x16x32_bf16 v[40:43], v[60:63], v[92:95], v[40:43]
    s_nop 0
    ds_read_b128 a[52:55], v12 offset:14336
    v_mfma_f32_16x16x32_bf16 v[32:35], v[48:51], v[96:99], v[32:35]
    ds_read_b128 v[152:155], v248 offset:1152
    ds_read_b128 v[156:159], v248 offset:1664
    v_mfma_f32_16x16x32_bf16 v[36:39], v[52:55], v[96:99], v[36:39]
    buffer_load_dwordx4 v10, s[12:15], 0 offen offset:2816 lds
    ds_read_b128 v[160:163], v248 offset:2176
    v_mfma_f32_16x16x32_bf16 v[40:43], v[56:59], v[96:99], v[40:43]
    ds_read_b128 a[56:59], v13 offset:12288
    v_mfma_f32_16x16x32_bf16 v[44:47], v[60:63], v[96:99], v[44:47]
    ds_read_b128 a[60:63], v13 offset:14336
    ds_read_b128 v[164:167], v248 offset:2688
    v_mfma_f32_16x16x32_bf16 v[36:39], v[48:51], v[100:103], v[36:39]
    ds_read_b128 v[168:171], v248 offset:3200
    ds_read_b128 v[172:175], v248 offset:3712
    v_mfma_f32_16x16x32_bf16 v[40:43], v[52:55], v[100:103], v[40:43]
    s_nop 0
    v_mfma_f32_16x16x32_bf16 v[44:47], v[56:59], v[100:103], v[44:47]
    buffer_load_dwordx4 v11, s[12:15], 0 offen offset:3840 lds
    v_mfma_f32_16x16x32_bf16 v[40:43], v[48:51], v[104:107], v[40:43]
    v_mfma_f32_16x16x32_bf16 v[44:47], v[52:55], v[104:107], v[44:47]
    s_add_u32 m0, s75, 11392
    v_mfma_f32_16x16x32_bf16 v[44:47], v[48:51], v[108:111], v[44:47]
    s_waitcnt lgkmcnt(3)
    v_mfma_f32_16x16x32_bf16 v[136:139], v[128:131], a[248:251], 0
    buffer_load_dwordx4 v8, s[12:15], 0 offen offset:896 lds
    v_mfma_f32_16x16x32_bf16 v[140:143], v[132:135], a[252:255], 0
    v_mfma_f32_16x16x32_bf16 v[16:19], v[112:115], v[144:147], v[16:19]
    ds_read2_b32 v[48:49], v244 offset0:144 offset1:145
    v_mfma_f32_16x16x32_bf16 v[20:23], v[116:119], v[144:147], v[20:23]
    ds_read2_b32 v[50:51], v244 offset0:146 offset1:147
    v_mfma_f32_16x16x32_bf16 v[24:27], v[120:123], v[144:147], v[24:27]
    buffer_load_dwordx4 v9, s[12:15], 0 offen offset:1920 lds
    ds_read2_b32 v[52:53], v244 offset0:16 offset1:17
    v_mfma_f32_16x16x32_bf16 v[28:31], v[124:127], v[144:147], v[28:31]
    s_waitcnt vmcnt(10)
    ds_read2_b32 v[54:55], v244 offset0:18 offset1:19
    v_mfma_f32_16x16x32_bf16 v[20:23], v[112:115], v[148:151], v[20:23]
    ds_read_b128 a[64:67], v12 offset:0
    v_mfma_f32_16x16x32_bf16 v[24:27], v[116:119], v[148:151], v[24:27]
    s_nop 0
    ds_read_b128 a[68:71], v12 offset:2048
    v_mfma_f32_16x16x32_bf16 v[28:31], v[120:123], v[148:151], v[28:31]
    v_cvt_pk_bf16_f32 v184, v136, v140
    ds_read2_b32 v[56:57], v245 offset0:144 offset1:145
    v_mfma_f32_16x16x32_bf16 v[32:35], v[124:127], v[148:151], v[32:35]
    buffer_load_dwordx4 v10, s[12:15], 0 offen offset:2944 lds
    ds_read2_b32 v[58:59], v245 offset0:146 offset1:147
    s_waitcnt lgkmcnt(8)
    v_mfma_f32_16x16x32_bf16 v[24:27], v[112:115], v[152:155], v[24:27]
    s_nop 0
    ds_read_b128 a[72:75], v13 offset:0
    v_mfma_f32_16x16x32_bf16 v[28:31], v[116:119], v[152:155], v[28:31]
    ds_read_b128 a[76:79], v13 offset:2048
    v_mfma_f32_16x16x32_bf16 v[32:35], v[120:123], v[152:155], v[32:35]
    v_cvt_pk_bf16_f32 v185, v137, v141
    ds_read2_b32 v[60:61], v245 offset0:16 offset1:17
    v_mfma_f32_16x16x32_bf16 v[36:39], v[124:127], v[152:155], v[36:39]
    v_cvt_pk_bf16_f32 v186, v138, v142
    ds_read2_b32 v[62:63], v245 offset0:18 offset1:19
    v_mfma_f32_16x16x32_bf16 v[28:31], v[112:115], v[156:159], v[28:31]
    buffer_load_dwordx4 v11, s[12:15], 0 offen offset:3968 lds
    ds_read_b128 v[80:83], v248 offset:64
    v_mfma_f32_16x16x32_bf16 v[32:35], v[116:119], v[156:159], v[32:35]
    v_add_u32 v8, 1024, v8
    v_add_u32 v9, 1024, v9
    v_mfma_f32_16x16x32_bf16 v[36:39], v[120:123], v[156:159], v[36:39]
    v_add_u32 v10, 1024, v10
    v_add_u32 v11, 1024, v11
    s_add_u32 m0, s75, 0
    v_mfma_f32_16x16x32_bf16 v[40:43], v[124:127], v[156:159], v[40:43]
    s_waitcnt lgkmcnt(3)
    ds_read_b128 v[84:87], v248 offset:576
    v_mfma_f32_16x16x32_bf16 v[32:35], v[112:115], v[160:163], v[32:35]
    buffer_load_dwordx4 v8, s[12:15], 0 offen offset:0 lds
    ds_read_b128 v[128:131], v248 offset:1968
    v_mfma_f32_16x16x32_bf16 v[36:39], v[116:119], v[160:163], v[36:39]
    v_cvt_pk_bf16_f32 v187, v139, v143
    ds_read_b128 v[132:135], v248 offset:1984
    v_mfma_f32_16x16x32_bf16 v[40:43], v[120:123], v[160:163], v[40:43]
    ds_read_b128 v[88:91], v248 offset:1088
    ds_read_b128 v[92:95], v248 offset:1600
    v_mfma_f32_16x16x32_bf16 v[44:47], v[124:127], v[160:163], v[44:47]
    ds_read_b128 v[96:99], v248 offset:2112
    ds_read_b128 v[100:103], v248 offset:2624
    v_mfma_f32_16x16x32_bf16 v[36:39], v[112:115], v[164:167], v[36:39]
    buffer_load_dwordx4 v9, s[12:15], 0 offen offset:1024 lds
    ds_read_b128 v[104:107], v248 offset:3136
    v_mfma_f32_16x16x32_bf16 v[40:43], v[116:119], v[164:167], v[40:43]
    s_waitcnt vmcnt(10)
    ds_read_b128 v[108:111], v248 offset:3648
    v_mfma_f32_16x16x32_bf16 v[44:47], v[120:123], v[164:167], v[44:47]
    ds_read_b128 a[80:83], v12 offset:4096
    v_mfma_f32_16x16x32_bf16 v[40:43], v[112:115], v[168:171], v[40:43]
    ds_read_b128 a[84:87], v12 offset:6144
    v_mfma_f32_16x16x32_bf16 v[44:47], v[116:119], v[168:171], v[44:47]
    s_nop 0
    v_mfma_f32_16x16x32_bf16 v[44:47], v[112:115], v[172:175], v[44:47]
    buffer_load_dwordx4 v10, s[12:15], 0 offen offset:2048 lds
    s_waitcnt lgkmcnt(8)
    v_mfma_f32_16x16x32_bf16 v[136:139], v[128:131], a[248:251], 0
    s_nop 0
    ds_read_b128 a[88:91], v13 offset:4096
    v_mfma_f32_16x16x32_bf16 v[140:143], v[132:135], a[252:255], 0
    ds_read_b128 a[92:95], v13 offset:6144
    v_mfma_f32_16x16x32_bf16 v[16:19], v[48:51], v[80:83], v[16:19]
    buffer_load_dword v14, v15, s[8:11], s29 offen sc1
    v_mfma_f32_16x16x32_bf16 v[20:23], v[52:55], v[80:83], v[20:23]
    ds_read2_b32 v[192:193], v247 offset0:48 offset1:49
    v_mfma_f32_16x16x32_bf16 v[24:27], v[56:59], v[80:83], v[24:27]
    buffer_load_dwordx4 v11, s[12:15], 0 offen offset:3072 lds
    ds_read2_b32 v[194:195], v247 offset0:50 offset1:51
    v_mfma_f32_16x16x32_bf16 v[28:31], v[60:63], v[80:83], v[28:31]
    ds_read2_b32 v[196:197], v247 offset0:32 offset1:33
    v_mfma_f32_16x16x32_bf16 v[20:23], v[48:51], v[84:87], v[20:23]
    s_add_u32 m0, s75, 3968
    ds_read2_b32 v[198:199], v247 offset0:34 offset1:35
    v_mfma_f32_16x16x32_bf16 v[24:27], v[52:55], v[84:87], v[24:27]
    s_waitcnt lgkmcnt(4)
    s_nop 0
    ds_read2_b32 v[200:201], v247 offset0:16 offset1:17
    v_mfma_f32_16x16x32_bf16 v[28:31], v[56:59], v[84:87], v[28:31]
    buffer_load_dwordx4 v8, s[12:15], 0 offen offset:128 lds
    ds_read2_b32 v[202:203], v247 offset0:18 offset1:19
    v_mfma_f32_16x16x32_bf16 v[32:35], v[60:63], v[84:87], v[32:35]
    ds_read2_b32 v[204:205], v247 offset0:0 offset1:1
    v_mfma_f32_16x16x32_bf16 v[24:27], v[48:51], v[88:91], v[24:27]
    v_cvt_pk_bf16_f32 v188, v136, v140
    ds_read2_b32 v[206:207], v247 offset0:2 offset1:3
    v_mfma_f32_16x16x32_bf16 v[28:31], v[52:55], v[88:91], v[28:31]
    v_cvt_pk_bf16_f32 v189, v137, v141
    ds_read2_b32 v[112:113], v244 offset0:128 offset1:129
    v_mfma_f32_16x16x32_bf16 v[32:35], v[56:59], v[88:91], v[32:35]
    buffer_load_dwordx4 v9, s[12:15], 0 offen offset:1152 lds
    ds_read2_b32 v[114:115], v244 offset0:130 offset1:131
    v_mfma_f32_16x16x32_bf16 v[36:39], v[60:63], v[88:91], v[36:39]
    s_waitcnt vmcnt(11)
    ds_read2_b32 v[116:117], v244 offset0:0 offset1:1
    v_mfma_f32_16x16x32_bf16 v[28:31], v[48:51], v[92:95], v[28:31]
    s_nop 0
    ds_read_b128 a[96:99], v12 offset:8192
    v_mfma_f32_16x16x32_bf16 v[32:35], v[52:55], v[92:95], v[32:35]
    ds_read_b128 a[100:103], v12 offset:10240
    v_mfma_f32_16x16x32_bf16 v[36:39], v[56:59], v[92:95], v[36:39]
    v_cvt_pk_bf16_f32 v190, v138, v142
    ds_read2_b32 v[118:119], v244 offset0:2 offset1:3
    v_mfma_f32_16x16x32_bf16 v[40:43], v[60:63], v[92:95], v[40:43]
    buffer_load_dwordx4 v10, s[12:15], 0 offen offset:2176 lds
    ds_read2_b32 v[120:121], v245 offset0:128 offset1:129
    v_mfma_f32_16x16x32_bf16 v[32:35], v[48:51], v[96:99], v[32:35]
    ds_read_b128 a[104:107], v13 offset:8192
    v_mfma_f32_16x16x32_bf16 v[36:39], v[52:55], v[96:99], v[36:39]
    ds_read_b128 a[108:111], v13 offset:10240
    v_mfma_f32_16x16x32_bf16 v[40:43], v[56:59], v[96:99], v[40:43]
    v_cvt_pk_bf16_f32 v191, v139, v143
    ds_read2_b32 v[122:123], v245 offset0:130 offset1:131
    v_mfma_f32_16x16x32_bf16 v[44:47], v[60:63], v[96:99], v[44:47]
    ds_read2_b32 v[124:125], v245 offset0:0 offset1:1
    v_mfma_f32_16x16x32_bf16 v[36:39], v[48:51], v[100:103], v[36:39]
    buffer_load_dwordx4 v11, s[12:15], 0 offen offset:3200 lds
    ds_read2_b32 v[126:127], v245 offset0:2 offset1:3
    v_mfma_f32_16x16x32_bf16 v[40:43], v[52:55], v[100:103], v[40:43]
    ds_read_b128 v[144:147], v248 offset:0
    v_mfma_f32_16x16x32_bf16 v[44:47], v[56:59], v[100:103], v[44:47]
    s_add_u32 m0, s75, 7936
    ds_read_b128 v[148:151], v248 offset:512
    v_mfma_f32_16x16x32_bf16 v[40:43], v[48:51], v[104:107], v[40:43]
    s_waitcnt lgkmcnt(5)
    s_nop 0
    ds_read_b128 v[152:155], v248 offset:1024
    v_mfma_f32_16x16x32_bf16 v[44:47], v[52:55], v[104:107], v[44:47]
    buffer_load_dwordx4 v8, s[12:15], 0 offen offset:256 lds
    ds_read_b128 v[156:159], v248 offset:1536
    v_mfma_f32_16x16x32_bf16 v[44:47], v[48:51], v[108:111], v[44:47]
    ds_read_b128 v[160:163], v248 offset:2048
    v_mfma_f32_16x16x32_bf16 v[32:35], v[176:179], v[192:195], v[32:35]
    ds_read_b128 v[164:167], v248 offset:2560
    v_mfma_f32_16x16x32_bf16 v[36:39], v[176:179], v[196:199], v[36:39]
    ds_read_b128 v[168:171], v248 offset:3072
    v_mfma_f32_16x16x32_bf16 v[40:43], v[176:179], v[200:203], v[40:43]
    buffer_load_dwordx4 v9, s[12:15], 0 offen offset:1280 lds
    ds_read_b128 v[172:175], v248 offset:3584
    v_mfma_f32_16x16x32_bf16 v[44:47], v[176:179], v[204:207], v[44:47]
    s_waitcnt vmcnt(11)
    s_nop 0
    v_mfma_f32_16x16x32_bf16 v[36:39], v[180:183], v[192:195], v[36:39]
    ds_read_b128 a[112:115], v12 offset:12288
    v_mfma_f32_16x16x32_bf16 v[40:43], v[180:183], v[196:199], v[40:43]
    ds_read_b128 a[116:119], v12 offset:14336
    v_mfma_f32_16x16x32_bf16 v[44:47], v[180:183], v[200:203], v[44:47]
    v_mfma_f32_16x16x32_bf16 v[40:43], v[184:187], v[192:195], v[40:43]
    buffer_load_dwordx4 v10, s[12:15], 0 offen offset:2304 lds
    v_mfma_f32_16x16x32_bf16 v[44:47], v[184:187], v[196:199], v[44:47]
    ds_read_b128 a[120:123], v13 offset:12288
    v_mfma_f32_16x16x32_bf16 v[44:47], v[188:191], v[192:195], v[44:47]
    ds_read_b128 a[124:127], v13 offset:14336
    s_waitcnt lgkmcnt(10)
    v_mfma_f32_16x16x32_bf16 v[16:19], v[112:115], v[144:147], v[16:19]
    v_mfma_f32_16x16x32_bf16 v[20:23], v[116:119], v[144:147], v[20:23]
    v_mfma_f32_16x16x32_bf16 v[24:27], v[120:123], v[144:147], v[24:27]
    buffer_load_dwordx4 v11, s[12:15], 0 offen offset:3328 lds
    v_mfma_f32_16x16x32_bf16 v[28:31], v[124:127], v[144:147], v[28:31]
    v_mfma_f32_16x16x32_bf16 v[20:23], v[112:115], v[148:151], v[20:23]
    s_add_u32 m0, s75, 11904
    v_mfma_f32_16x16x32_bf16 v[24:27], v[116:119], v[148:151], v[24:27]
    s_nop 0
    ds_write_b128 v249, v[16:19] offset:0
    s_waitcnt lgkmcnt(1)
    v_mfma_f32_16x16x32_bf16 v[28:31], v[120:123], v[148:151], v[28:31]
    buffer_load_dwordx4 v8, s[12:15], 0 offen offset:384 lds
    v_mfma_f32_16x16x32_bf16 v[32:35], v[124:127], v[148:151], v[32:35]
    v_mfma_f32_16x16x32_bf16 v[24:27], v[112:115], v[152:155], v[24:27]
    s_nop 0
    v_mfma_f32_16x16x32_bf16 v[28:31], v[116:119], v[152:155], v[28:31]
    ds_write_b128 v249, v[20:23] offset:1024
    v_mfma_f32_16x16x32_bf16 v[32:35], v[120:123], v[152:155], v[32:35]
    buffer_load_dwordx4 v9, s[12:15], 0 offen offset:1408 lds
    s_nop 0
    v_mfma_f32_16x16x32_bf16 v[36:39], v[124:127], v[152:155], v[36:39]
    v_mfma_f32_16x16x32_bf16 v[28:31], v[112:115], v[156:159], v[28:31]
    v_mfma_f32_16x16x32_bf16 v[32:35], v[116:119], v[156:159], v[32:35]
    s_nop 0
    ds_write_b128 v249, v[24:27] offset:2048
    v_mfma_f32_16x16x32_bf16 v[36:39], v[120:123], v[156:159], v[36:39]
    v_mfma_f32_16x16x32_bf16 v[40:43], v[124:127], v[156:159], v[40:43]
    buffer_load_dwordx4 v10, s[12:15], 0 offen offset:2432 lds
    v_mfma_f32_16x16x32_bf16 v[32:35], v[112:115], v[160:163], v[32:35]
    v_mfma_f32_16x16x32_bf16 v[36:39], v[116:119], v[160:163], v[36:39]
    ds_write_b128 v249, v[28:31] offset:3072
    v_mfma_f32_16x16x32_bf16 v[40:43], v[120:123], v[160:163], v[40:43]
    v_mfma_f32_16x16x32_bf16 v[44:47], v[124:127], v[160:163], v[44:47]
    v_mfma_f32_16x16x32_bf16 v[36:39], v[112:115], v[164:167], v[36:39]
    buffer_load_dwordx4 v11, s[12:15], 0 offen offset:3456 lds
    v_mfma_f32_16x16x32_bf16 v[40:43], v[116:119], v[164:167], v[40:43]
    s_nop 0
    ds_write_b128 v249, v[32:35] offset:4096
    v_mfma_f32_16x16x32_bf16 v[44:47], v[120:123], v[164:167], v[44:47]
    v_mfma_f32_16x16x32_bf16 v[40:43], v[112:115], v[168:171], v[40:43]
    v_mfma_f32_16x16x32_bf16 v[44:47], v[116:119], v[168:171], v[44:47]
    s_nop 0
    ds_write_b128 v249, v[36:39] offset:5120
    v_mfma_f32_16x16x32_bf16 v[44:47], v[112:115], v[172:175], v[44:47]
    s_waitcnt vmcnt(13)
    v_cmp_eq_u32_e64 vcc, -1, v14
    s_cbranch_vccnz S1b_r
S1b_d:
    s_nop 0
    ds_write_b128 v249, v[40:43] offset:6144
    s_nop 2
    ds_write_b128 v249, v[44:47] offset:7168
    s_waitcnt lgkmcnt(0)
    s_barrier
    ds_read_b64 v[48:49], v208 offset:0
    ds_read_b64 v[50:51], v208 offset:17408
    ds_read_b64 v[52:53], v208 offset:34816
    ds_read_b64 v[54:55], v208 offset:52224
    ds_read_b64 v[56:57], v209 offset:0
    ds_read_b64 v[58:59], v209 offset:17408
    ds_read_b64 v[60:61], v209 offset:34816
    ds_read_b64 v[62:63], v209 offset:52224
    ds_read_b64 v[64:65], v210 offset:0
    ds_read_b64 v[66:67], v210 offset:17408
    ds_read_b64 v[68:69], v210 offset:34816
    ds_read_b64 v[70:71], v210 offset:52224
    ds_read_b64 v[72:73], v211 offset:0
    ds_read_b64 v[74:75], v211 offset:17408
    ds_read_b64 v[76:77], v211 offset:34816
    ds_read_b64 v[78:79], v211 offset:52224
    s_nop 0
    s_waitcnt lgkmcnt(12)
    v_pk_add_f32 v[48:49], v[48:49], v[212:213]
    v_pk_add_f32 v[50:51], v[50:51], v[214:215]
    v_pk_add_f32 v[52:53], v[52:53], v[216:217]
    v_pk_add_f32 v[54:55], v[54:55], v[218:219]
    v_cvt_pk_bf16_f32 v80, v48, v50
    v_cvt_pk_bf16_f32 v81, v52, v54
    v_cvt_pk_bf16_f32 v82, v49, v51
    v_cvt_pk_bf16_f32 v83, v53, v55
    buffer_store_dwordx4 v[80:83], v4, s[8:11], s16 offen sc1
    s_waitcnt lgkmcnt(8)
    s_nop 0
    v_pk_add_f32 v[56:57], v[56:57], v[220:221]
    v_pk_add_f32 v[58:59], v[58:59], v[222:223]
    v_pk_add_f32 v[60:61], v[60:61], v[224:225]
    v_pk_add_f32 v[62:63], v[62:63], v[226:227]
    v_cvt_pk_bf16_f32 v84, v56, v58
    v_cvt_pk_bf16_f32 v85, v60, v62
    v_cvt_pk_bf16_f32 v86, v57, v59
    v_cvt_pk_bf16_f32 v87, v61, v63
    buffer_store_dwordx4 v[84:87], v4, s[8:11], s17 offen sc1
    s_waitcnt lgkmcnt(4)
    v_pk_add_f32 v[64:65], v[64:65], v[228:229]
    v_pk_add_f32 v[66:67], v[66:67], v[230:231]
L_pg3:
    s_cbranch_execz L_w0
    v_pk_add_f32 v[68:69], v[68:69], v[232:233]
    v_pk_add_f32 v[70:71], v[70:71], v[234:235]
    v_cvt_pk_bf16_f32 v88, v64, v66
    v_cvt_pk_bf16_f32 v89, v68, v70
    v_cvt_pk_bf16_f32 v90, v65, v67
    v_cvt_pk_bf16_f32 v91, v69, v71
    buffer_store_dwordx4 v[88:91], v4, s[8:11], s18 offen sc1
    s_nop 0
    s_waitcnt lgkmcnt(0)
    v_pk_add_f32 v[72:73], v[72:73], v[236:237]
    v_pk_add_f32 v[74:75], v[74:75], v[238:239]
    v_pk_add_f32 v[76:77], v[76:77], v[240:241]
    v_pk_add_f32 v[78:79], v[78:79], v[242:243]
    v_cvt_pk_bf16_f32 v92, v72, v74
    v_cvt_pk_bf16_f32 v93, v76, v78
    v_cvt_pk_bf16_f32 v94, v73, v75
    v_cvt_pk_bf16_f32 v95, v77, v79
    buffer_store_dwordx4 v[92:95], v4, s[8:11], s19 offen sc1
    s_waitcnt vmcnt(16)
    ds_read_b128 a[128:131], v12 offset:0
    ds_read_b128 a[132:135], v12 offset:2048
    ds_read_b128 a[136:139], v13 offset:0
    ds_read_b128 a[140:143], v13 offset:2048
    s_waitcnt vmcnt(12)
    ds_read_b128 a[144:147], v12 offset:4096
    ds_read_b128 a[148:151], v12 offset:6144
    ds_read_b128 a[152:155], v13 offset:4096
    ds_read_b128 a[156:159], v13 offset:6144
    s_waitcnt vmcnt(8)
    ds_read_b128 a[160:163], v12 offset:8192
    ds_read_b128 a[164:167], v12 offset:10240
    ds_read_b128 a[168:171], v13 offset:8192
    ds_read_b128 a[172:175], v13 offset:10240
    s_waitcnt vmcnt(4)
    ds_read_b128 a[176:179], v12 offset:12288
    ds_read_b128 a[180:183], v12 offset:14336
    ds_read_b128 a[184:187], v13 offset:12288
    ds_read_b128 a[188:191], v13 offset:14336
    s_mul_i32 s27, s71, 122880
    s_mul_i32 s25, s20, 15360
    s_add_u32 s27, s27, s25
    s_nop 0
    s_add_u32 s27, s27, 2621440
    s_mul_i32 s26, s20, 17408
    s_mov_b32 m0, s26
    s_lshl_b32 s24, s20, 12
    buffer_load_dwordx4 v2, s[8:11], s27 offen offset:0 sc1 lds
    buffer_load_dwordx4 v2, s[8:11], s27 offen offset:1024 sc1 lds
    buffer_load_dwordx4 v2, s[8:11], s27 offen offset:2048 sc1 lds
    buffer_load_dwordx4 v2, s[8:11], s27 offen offset:3072 sc1 lds
    s_add_u32 m0, m0, 4096
    s_add_u32 s27, s27, 4096
    buffer_load_dwordx4 v2, s[8:11], s27 offen offset:0 sc1 lds
    buffer_load_dwordx4 v2, s[8:11], s27 offen offset:1024 sc1 lds
    buffer_load_dwordx4 v2, s[8:11], s27 offen offset:2048 sc1 lds
    buffer_load_dwordx4 v2, s[8:11], s27 offen offset:3072 sc1 lds
    s_lshl_b32 s28, s2, 4
    s_add_u32 s28, s28, 6078464
    s_lshl_b32 s29, s2, 7
    s_add_u32 s29, s29, 5988352
    v_mul_u32_u24 v14, 10240, v0
    v_add_u32_e64 v14, s28, v14
    v_mov_b32 v15, 1
    v_writelane_b32 v14, s29, 8
    s_mov_b64 exec, 0
    s_cmp_eq_u32 s20, 1
    s_cbranch_scc1 L_pg4
    s_cmp_eq_u32 s20, 2
    s_cbranch_scc1 L_pg5
    s_cmp_eq_u32 s20, 3
    s_cbranch_scc1 L_pg8
L_wr:
    s_cmp_ge_u32 s2, 160
    s_cbranch_scc1 L_w2
    s_mov_b64 exec, -1
    s_waitcnt vmcnt(8)
    s_waitcnt lgkmcnt(0)
    s_barrier
    s_cmp_lg_u32 s20, 0
    s_cbranch_scc1 L_cf
    s_mov_b64 exec, 511
    buffer_store_dword v15, v14, s[8:11], 0 offen sc1
    s_mov_b64 exec, -1
L_cf:
    s_add_u32 m0, s24, 69632
    s_add_u32 s27, s27, 4096
    buffer_load_dwordx4 v2, s[8:11], s27 offen offset:0 sc1 lds
    buffer_load_dwordx4 v2, s[8:11], s27 offen offset:1024 sc1 lds
    buffer_load_dwordx4 v2, s[8:11], s27 offen offset:2048 sc1 lds
    buffer_load_dwordx4 v2, s[8:11], s27 offen offset:3072 sc1 lds
L_common:
    s_add_u32 m0, s26, 8448
    s_add_u32 s27, s27, 4096
    buffer_load_dwordx4 v2, s[8:11], s27 offen offset:0 sc1 lds
    s_mul_i32 s79, s71, 768
    s_add_u32 s79, s79, 5570560
    v_lshlrev_b32 v88, 2, v5
    v_lshlrev_b32 v89, 4, v6
    v_and_b32 v7, 12, v0
    v_mul_u32_u24 v7, 12, v7
    v_add3_u32 v7, v7, v88, v89
    buffer_load_dwordx4 v2, s[8:11], s27 offen offset:1024 sc1 lds
    v_add_u32 v7, 12288, v7
    buffer_load_dword v80, v7, s[8:11], s79 offen offset:0 sc1
    buffer_load_dword v81, v7, s[8:11], s79 offen offset:256 sc1
    buffer_load_dword v82, v7, s[8:11], s79 offen offset:512 sc1
    s_mul_i32 s75, s20, 18432
    s_add_u32 s75, s75, 1024
    v_lshrrev_b32 v12, 1, v5
    v_xor_b32 v12, v12, v6
    buffer_load_dwordx4 v2, s[8:11], s27 offen offset:2048 sc1 lds
    v_lshlrev_b32_e64 v12, 4, v12
    v_lshl_add_u32 v12, v5, 7, v12
    v_add_u32 v12, s75, v12
    v_xor_b32 v13, 64, v12
    s_mul_i32 s84, s73, 122880
    s_mul_i32 s3, s20, 30720
    s_add_u32 s84, s84, s3
    s_add_u32 s84, s84, 4587520
    s_add_u32 s27, s27, 49152
    s_add_u32 m0, s25, 98304
    s_add_u32 s76, s27, 0
    buffer_load_dwordx4 v2, s[8:11], s76 offen offset:0 sc1 lds
    v_subrev_u32 v41, 40, v0
    v_min_u32 v41, 5, v41
    v_lshl_add_u32 v41, v41, 3, s73
    v_lshlrev_b32_e64 v41, 4, v41
    v_add_u32 v41, 5963776, v41
    v_cmp_gt_u32_e64 vcc, 40, v0
    s_mul_i32 s28, s20, 640
    s_add_u32 s28, s28, 6078464
    buffer_load_dwordx4 v2, s[8:11], s76 offen offset:1024 sc1 lds
    s_mul_i32 s30, s21, 10240
    s_add_u32 s28, s28, s30
    v_lshl_add_u32 v40, v0, 4, s28
    v_cndmask_b32 v40, v41, v40, vcc
    v_lshlrev_b32 v14, 15, v6
    v_lshl_add_u32 v14, v5, 4, v14
    s_lshl_b32 s26, s78, 8
    s_mov_b32 s4, 131072
    buffer_load_dwordx4 v2, s[8:11], s76 offen offset:2048 sc1 lds
    v_add_u32_e64 v14, s26, v14
    v_add_u32 v15, 16384, v14
    v_lshrrev_b32 v7, 2, v0
    v_lshlrev_b32 v7, 14, v7
    v_and_b32_e64 v4, 3, v0
    v_lshl_add_u32 v7, v4, 4, v7
    v_lshlrev_b32_e64 v92, 4, v4
    buffer_load_dwordx4 v2, s[8:11], s76 offen offset:3072 sc1 lds
    v_cmp_eq_u32 s[80:81], 1, v4
    v_cmp_eq_u32 s[82:83], 2, v4
    v_cmp_eq_u32 s[18:19], 3, v4
    v_lshlrev_b32_e64 v1, 4, v4
    v_lshl_add_u32 v1, v6, 6, v1
    v_bfe_u32 v4, v0, 2, 1
    v_lshl_add_u32 v1, v4, 3, v1
    v_bfe_u32 v4, v0, 3, 1
    s_add_u32 m0, s25, 102400
    s_add_u32 s76, s27, 4096
    buffer_load_dwordx4 v2, s[8:11], s76 offen offset:0 sc1 lds
    v_lshl_add_u32 v1, v4, 2, v1
    v_and_b32 v4, 12, v0
    v_add_u32 v92, v92, v4
    v_add_u32 v3, 65536, v2
    v_add_u32 v4, 131072, v2
    v_mov_b32 v93, 0x3f803f80
    s_lshl_b32 s29, s70, 1
    s_and_b32 s30, s71, 1
    buffer_load_dwordx4 v2, s[8:11], s76 offen offset:1024 sc1 lds
    s_add_u32 s29, s29, s30
    s_lshl_b32 s29, s29, 3
    s_lshr_b32 s30, s71, 1
    s_add_u32 s29, s29, s30
    s_lshl_b32 s30, s29, 6
    s_mul_i32 s31, s20, 655360
    s_add_u32 s30, s30, s31
    s_add_u32 s31, s30, 262144
    buffer_load_dwordx4 v2, s[8:11], s76 offen offset:2048 sc1 lds
    s_add_u32 s32, s30, 524288
    s_and_b32 s33, s29, 3
    s_lshl_b32 s33, s33, 6
    s_and_b32 s29, s29, -4
    s_add_u32 s29, s29, s20
    s_lshl_b32 s29, s29, 8
    s_add_u32 s29, s29, s33
    s_add_u32 s29, s29, 5898240
    buffer_load_dwordx4 v2, s[8:11], s76 offen offset:3072 sc1 lds
    s_lshl_b32 s33, s78, 10
    s_add_u32 s33, s33, 5898240
    s_lshl_b32 s24, s20, 8
    s_add_u32 s24, s24, 159744
    v_mov_b32 v72, 0
    v_mov_b32 v73, 0
    v_mov_b32 v74, 0
    v_mov_b32 v75, 0
    s_cmp_lt_u32 s2, 160
    s_cbranch_scc1 L_s2
    buffer_load_dword v41, off, s[8:11], s34 sc1
    s_waitcnt vmcnt(0)
    v_cmp_eq_u32 vcc, -1, v41
    s_cbranch_vccnz H2p_r
H2p_d:
L_s2:
    buffer_load_dword v41, v40, s[8:11], 0 offen sc1
    s_waitcnt vmcnt(0)
    v_cmp_eq_u32 vcc, -1, v41
    s_cbranch_vccnz S2_r
S2_d:
    s_barrier
    buffer_load_dwordx4 v[94:97], v14, s[8:11], 0 offen sc1
    v_add_u32_e64 v14, s4, v14
    buffer_load_dwordx4 v[98:101], v15, s[8:11], 0 offen sc1
    v_add_u32_e64 v15, s4, v15
    buffer_load_dwordx4 v[102:105], v14, s[8:11], 0 offen sc1
    v_add_u32_e64 v14, s4, v14
    buffer_load_dwordx4 v[106:109], v15, s[8:11], 0 offen sc1
    v_add_u32_e64 v15, s4, v15
    buffer_load_dwordx4 v[110:113], v14, s[8:11], 0 offen sc1
    v_add_u32_e64 v14, s4, v14
    buffer_load_dwordx4 v[114:117], v15, s[8:11], 0 offen sc1
    v_add_u32_e64 v15, s4, v15
    buffer_load_dwordx4 v[64:67], v7, s[8:11], s30 offen sc1
    buffer_load_dwordx4 v[68:71], v7, s[8:11], s31 offen sc1
    s_mov_b32 exec_hi, 0
    buffer_load_dwordx4 v[72:75], v7, s[8:11], s32 offen sc1
    s_mov_b32 exec_hi, -1
    ds_read_b128 v[40:43], v2 offset:0
    ds_read_b128 v[44:47], v2 offset:1024
    ds_read_b128 v[48:51], v2 offset:2048
    ds_read_b128 v[52:55], v2 offset:3072
    ds_read_b128 v[56:59], v2 offset:4096
    ds_read_b128 v[60:63], v2 offset:5120
    v_add_u32_e64 v88, s24, v88
    v_add_u32 v89, s24, v89
    v_and_b32 v90, 1, v6
    v_lshl_add_u32 v90, v90, 6, v88
    v_mov_b32 v83, v80
    s_nop 1
    v_permlane16_swap_b32 v80, v83
    v_add_f32 v80, v80, v83
    v_mov_b32 v83, v80
    s_nop 1
    v_permlane32_swap_b32 v80, v83
    v_add_f32 v80, v80, v83
    v_mov_b32 v83, v81
    s_nop 1
    v_permlane16_swap_b32 v81, v83
    v_add_f32 v81, v81, v83
    v_mov_b32 v83, v81
    s_nop 1
    v_permlane32_swap_b32 v81, v83
    v_add_f32 v81, v81, v83
    v_mov_b32 v83, v82
    s_nop 1
    v_permlane16_swap_b32 v82, v83
    v_add_f32 v82, v82, v83
    v_mov_b32_e64 v83, v82
    s_nop 1
    v_permlane32_swap_b32 v82, v83
    v_add_f32 v82, v82, v83
    s_waitcnt vmcnt(7)
    v_swap_b32 v96, v98
    v_swap_b32 v97, v99
    s_waitcnt lgkmcnt(3)
    s_nop 0
    v_mfma_f32_16x16x32_bf16 v[16:19], v[94:97], v[40:43], 0
    buffer_load_dwordx4 v[118:121], v14, s[8:11], 0 offen sc1
    v_add_u32_e64 v14, s4, v14
    v_mfma_f32_16x16x32_bf16 v[20:23], v[98:101], v[40:43], 0
    buffer_load_dwordx4 v[126:129], v14, s[8:11], 0 offen sc1
    v_add_u32_e64 v14, s4, v14
    ds_read_b128 v[40:43], v2 offset:6144
    v_mfma_f32_16x16x32_bf16 v[24:27], v[94:97], v[44:47], 0
    buffer_load_dwordx4 v[122:125], v15, s[8:11], 0 offen sc1
    v_add_u32_e64 v15, s4, v15
    v_mfma_f32_16x16x32_bf16 v[28:31], v[98:101], v[44:47], 0
    buffer_load_dwordx4 v[130:133], v15, s[8:11], 0 offen sc1
    v_add_u32_e64 v15, s4, v15
    ds_read_b128 v[44:47], v2 offset:7168
    v_mfma_f32_16x16x32_bf16 v[32:35], v[94:97], v[48:51], 0
    s_waitcnt vmcnt(9)
    v_swap_b32 v104, v106
    v_swap_b32 v105, v107
    v_mfma_f32_16x16x32_bf16 v[36:39], v[98:101], v[48:51], 0
    ds_read_b128 v[48:51], v3 offset:4096
    s_waitcnt lgkmcnt(3)
    v_mfma_f32_16x16x32_bf16 v[16:19], v[102:105], v[52:55], v[16:19]
    buffer_load_dwordx4 v[134:137], v14, s[8:11], 0 offen sc1
    v_add_u32_e64 v14, s4, v14
    v_mfma_f32_16x16x32_bf16 v[20:23], v[106:109], v[52:55], v[20:23]
    buffer_load_dwordx4 v[142:145], v14, s[8:11], 0 offen sc1
    v_add_u32_e64 v14, s4, v14
    ds_read_b128 v[52:55], v3 offset:5120
    v_mfma_f32_16x16x32_bf16 v[24:27], v[102:105], v[56:59], v[24:27]
    buffer_load_dwordx4 v[138:141], v15, s[8:11], 0 offen sc1
    v_add_u32_e64 v15, s4, v15
    v_mfma_f32_16x16x32_bf16 v[28:31], v[106:109], v[56:59], v[28:31]
    buffer_load_dwordx4 v[146:149], v15, s[8:11], 0 offen sc1
    v_add_u32_e64 v15, s4, v15
    ds_read_b128 v[56:59], v3 offset:6144
    v_mfma_f32_16x16x32_bf16 v[32:35], v[102:105], v[60:63], v[32:35]
    s_waitcnt vmcnt(11)
    v_swap_b32 v112, v114
    v_swap_b32 v113, v115
    v_mfma_f32_16x16x32_bf16 v[36:39], v[106:109], v[60:63], v[36:39]
    ds_read_b128 v[60:63], v3 offset:7168
    s_waitcnt lgkmcnt(3)
    v_mfma_f32_16x16x32_bf16 v[16:19], v[110:113], v[40:43], v[16:19]
    buffer_load_dwordx4 v[150:153], v14, s[8:11], 0 offen sc1
    v_add_u32_e64 v14, s4, v14
    v_mfma_f32_16x16x32_bf16 v[20:23], v[114:117], v[40:43], v[20:23]
    buffer_load_dwordx4 v[158:161], v14, s[8:11], 0 offen sc1
    v_add_u32_e64 v14, s4, v14
    ds_read_b128 v[40:43], v2 offset:8448
    v_mfma_f32_16x16x32_bf16 v[24:27], v[110:113], v[44:47], v[24:27]
    buffer_load_dwordx4 v[154:157], v15, s[8:11], 0 offen sc1
    v_add_u32_e64 v15, s4, v15
    v_mfma_f32_16x16x32_bf16 v[28:31], v[114:117], v[44:47], v[28:31]
    buffer_load_dwordx4 v[162:165], v15, s[8:11], 0 offen sc1
    v_add_u32_e64 v15, s4, v15
    ds_read_b128 v[44:47], v2 offset:9472
    v_mfma_f32_16x16x32_bf16 v[32:35], v[110:113], v[48:51], v[32:35]
    s_waitcnt vmcnt(9)
    v_swap_b32 v120, v122
    v_swap_b32 v121, v123
    v_mfma_f32_16x16x32_bf16 v[36:39], v[114:117], v[48:51], v[36:39]
    s_nop 0
    ds_read_b128 v[48:51], v2 offset:10496
    v_dot2_f32_bf16 v84, v64, v93, 0
    v_dot2_f32_bf16 v85, v64, v64, 0
    v_dot2_f32_bf16 v86, v66, v93, 0
    v_dot2_f32_bf16 v87, v66, v66, 0
    v_dot2_f32_bf16 v84, v65, v93, v84
    v_dot2_f32_bf16 v85, v65, v65, v85
    v_dot2_f32_bf16 v86, v67, v93, v86
    v_dot2_f32_bf16 v87, v67, v67, v87
    v_dot2_f32_bf16 v84, v68, v93, v84
    v_dot2_f32_bf16 v85, v68, v68, v85
    v_dot2_f32_bf16 v86, v70, v93, v86
    v_dot2_f32_bf16 v87, v70, v70, v87
    v_dot2_f32_bf16 v84, v69, v93, v84
    v_dot2_f32_bf16 v85, v69, v69, v85
    v_dot2_f32_bf16 v86, v71, v93, v86
    v_dot2_f32_bf16 v87, v71, v71, v87
    v_dot2_f32_bf16 v84, v72, v93, v84
    v_dot2_f32_bf16 v85, v72, v72, v85
    v_dot2_f32_bf16 v86, v74, v93, v86
    v_dot2_f32_bf16 v87, v74, v74, v87
    v_dot2_f32_bf16 v84, v73, v93, v84
    v_dot2_f32_bf16 v85, v73, v73, v85
    v_dot2_f32_bf16 v86, v75, v93, v86
    v_dot2_f32_bf16 v87, v75, v75, v87
    v_add_f32_dpp v84, v84, v84 row_ror:8 row_mask:0xf bank_mask:0x3
    v_add_f32_dpp v85, v85, v85 row_ror:8 row_mask:0xf bank_mask:0x3
    s_nop 0
    v_add_f32_dpp v84, v86, v86 row_ror:8 row_mask:0xf bank_mask:0xc
    v_add_f32_dpp v85, v87, v87 row_ror:8 row_mask:0xf bank_mask:0xc
    s_nop 0
    v_add_f32_dpp v84, v84, v84 row_shl:4 row_mask:0xf bank_mask:0x5
    s_nop 1
    v_add_f32_dpp v84, v85, v85 row_shr:4 row_mask:0xf bank_mask:0xa
    v_mov_b32 v85, v84
    s_nop 1
    v_permlane16_swap_b32 v84, v85
    v_add_f32 v84, v84, v85
    v_mov_b32 v85, v84
    s_nop 1
    v_permlane32_swap_b32 v84, v85
    v_add_f32 v84, v84, v85
    buffer_store_dword v84, v92, s[8:11], s29 offen sc1
    s_waitcnt lgkmcnt(3)
    v_mfma_f32_16x16x32_bf16 v[16:19], v[118:121], v[52:55], v[16:19]
    buffer_load_dwordx4 v[166:169], v14, s[8:11], 0 offen sc1
    v_add_u32_e64 v14, s4, v14
    v_mfma_f32_16x16x32_bf16 v[20:23], v[122:125], v[52:55], v[20:23]
    ds_read_b128 v[52:55], v2 offset:17408
    v_mfma_f32_16x16x32_bf16 v[24:27], v[118:121], v[56:59], v[24:27]
    buffer_load_dwordx4 v[170:173], v15, s[8:11], 0 offen sc1
    v_add_u32_e64 v15, s4, v15
    v_mfma_f32_16x16x32_bf16 v[28:31], v[122:125], v[56:59], v[28:31]
    ds_read_b128 v[56:59], v2 offset:18432
    v_mfma_f32_16x16x32_bf16 v[32:35], v[118:121], v[60:63], v[32:35]
    s_waitcnt vmcnt(11)
    v_swap_b32 v128, v130
    v_swap_b32 v129, v131
    v_mfma_f32_16x16x32_bf16 v[36:39], v[122:125], v[60:63], v[36:39]
    ds_read_b128 v[60:63], v2 offset:19456
    s_waitcnt lgkmcnt(3)
    v_mfma_f32_16x16x32_bf16 v[16:19], v[126:129], v[40:43], v[16:19]
    buffer_load_dwordx4 v[174:177], v14, s[8:11], 0 offen sc1
    v_add_u32_e64 v14, s4, v14
    v_mfma_f32_16x16x32_bf16 v[20:23], v[130:133], v[40:43], v[20:23]
    ds_read_b128 v[40:43], v2 offset:20480
    v_mfma_f32_16x16x32_bf16 v[24:27], v[126:129], v[44:47], v[24:27]
    buffer_load_dwordx4 v[178:181], v15, s[8:11], 0 offen sc1
    v_add_u32_e64 v15, s4, v15
    v_mfma_f32_16x16x32_bf16 v[28:31], v[130:133], v[44:47], v[28:31]
    ds_read_b128 v[44:47], v2 offset:21504
    v_mfma_f32_16x16x32_bf16 v[32:35], v[126:129], v[48:51], v[32:35]
    s_waitcnt vmcnt(10)
    v_swap_b32 v136, v138
    v_swap_b32 v137, v139
    v_mfma_f32_16x16x32_bf16 v[36:39], v[130:133], v[48:51], v[36:39]
    ds_read_b128 v[48:51], v2 offset:22528
    s_waitcnt lgkmcnt(3)
    v_mfma_f32_16x16x32_bf16 v[16:19], v[134:137], v[52:55], v[16:19]
    buffer_load_dwordx4 v[182:185], v14, s[8:11], 0 offen sc1
    v_add_u32_e64 v14, s4, v14
    v_mfma_f32_16x16x32_bf16 v[20:23], v[138:141], v[52:55], v[20:23]
    ds_read_b128 v[52:55], v2 offset:23552
    v_mfma_f32_16x16x32_bf16 v[24:27], v[134:137], v[56:59], v[24:27]
    buffer_load_dwordx4 v[186:189], v15, s[8:11], 0 offen sc1
    v_add_u32_e64 v15, s4, v15
    v_mfma_f32_16x16x32_bf16 v[28:31], v[138:141], v[56:59], v[28:31]
    ds_read_b128 v[56:59], v2 offset:24576
    v_mfma_f32_16x16x32_bf16 v[32:35], v[134:137], v[60:63], v[32:35]
    s_waitcnt vmcnt(11)
    v_swap_b32 v144, v146
    v_swap_b32 v145, v147
    v_mfma_f32_16x16x32_bf16 v[36:39], v[138:141], v[60:63], v[36:39]
    ds_read_b128 v[60:63], v3 offset:8192
    s_waitcnt lgkmcnt(3)
    v_mfma_f32_16x16x32_bf16 v[16:19], v[142:145], v[40:43], v[16:19]
    buffer_load_dwordx4 v[190:193], v14, s[8:11], 0 offen sc1
    v_add_u32_e64 v14, s4, v14
    v_mfma_f32_16x16x32_bf16 v[20:23], v[146:149], v[40:43], v[20:23]
    ds_read_b128 v[40:43], v3 offset:9216
    v_mfma_f32_16x16x32_bf16 v[24:27], v[142:145], v[44:47], v[24:27]
    buffer_load_dwordx4 v[194:197], v15, s[8:11], 0 offen sc1
    v_add_u32_e64 v15, s4, v15
    v_mfma_f32_16x16x32_bf16 v[28:31], v[146:149], v[44:47], v[28:31]
    ds_read_b128 v[44:47], v3 offset:10240
    v_mfma_f32_16x16x32_bf16 v[32:35], v[142:145], v[48:51], v[32:35]
    s_waitcnt vmcnt(10)
    v_swap_b32 v152, v154
    v_swap_b32 v153, v155
    v_mfma_f32_16x16x32_bf16 v[36:39], v[146:149], v[48:51], v[36:39]
    ds_read_b128 v[48:51], v3 offset:11264
    s_waitcnt lgkmcnt(3)
    v_mfma_f32_16x16x32_bf16 v[16:19], v[150:153], v[52:55], v[16:19]
    buffer_load_dwordx4 v[198:201], v14, s[8:11], 0 offen sc1
    v_add_u32_e64 v14, s4, v14
    v_mfma_f32_16x16x32_bf16 v[20:23], v[154:157], v[52:55], v[20:23]
    ds_read_b128 v[52:55], v2 offset:25856
    v_mfma_f32_16x16x32_bf16 v[24:27], v[150:153], v[56:59], v[24:27]
    buffer_load_dwordx4 v[202:205], v15, s[8:11], 0 offen sc1
    v_add_u32_e64 v15, s4, v15
    v_mfma_f32_16x16x32_bf16 v[28:31], v[154:157], v[56:59], v[28:31]
    ds_read_b128 v[56:59], v2 offset:26880
    v_mfma_f32_16x16x32_bf16 v[32:35], v[150:153], v[60:63], v[32:35]
    s_waitcnt vmcnt(11)
    v_swap_b32 v160, v162
    v_swap_b32 v161, v163
    v_mfma_f32_16x16x32_bf16 v[36:39], v[154:157], v[60:63], v[36:39]
    ds_read_b128 v[60:63], v2 offset:27904
    s_waitcnt lgkmcnt(3)
    v_mfma_f32_16x16x32_bf16 v[16:19], v[158:161], v[40:43], v[16:19]
    buffer_load_dwordx4 v[206:209], v14, s[8:11], 0 offen sc1
    v_add_u32_e64 v14, s4, v14
    v_mfma_f32_16x16x32_bf16 v[20:23], v[162:165], v[40:43], v[20:23]
    ds_read_b128 v[40:43], v2 offset:34816
    v_mfma_f32_16x16x32_bf16 v[24:27], v[158:161], v[44:47], v[24:27]
    buffer_load_dwordx4 v[210:213], v15, s[8:11], 0 offen sc1
    v_add_u32_e64 v15, s4, v15
    v_mfma_f32_16x16x32_bf16 v[28:31], v[162:165], v[44:47], v[28:31]
    ds_read_b128 v[44:47], v2 offset:35840
    v_mfma_f32_16x16x32_bf16 v[32:35], v[158:161], v[48:51], v[32:35]
    s_waitcnt vmcnt(10)
    v_swap_b32 v168, v170
    v_swap_b32 v169, v171
    v_mfma_f32_16x16x32_bf16 v[36:39], v[162:165], v[48:51], v[36:39]
    ds_read_b128 v[48:51], v2 offset:36864
    s_waitcnt lgkmcnt(3)
    v_mfma_f32_16x16x32_bf16 v[16:19], v[166:169], v[52:55], v[16:19]
    buffer_load_dwordx4 v[214:217], v14, s[8:11], 0 offen sc1
    v_add_u32_e64 v14, s4, v14
    v_mfma_f32_16x16x32_bf16 v[20:23], v[170:173], v[52:55], v[20:23]
    ds_read_b128 v[52:55], v2 offset:37888
    v_mfma_f32_16x16x32_bf16 v[24:27], v[166:169], v[56:59], v[24:27]
    buffer_load_dwordx4 v[218:221], v15, s[8:11], 0 offen sc1
    v_add_u32_e64 v15, s4, v15
    v_mfma_f32_16x16x32_bf16 v[28:31], v[170:173], v[56:59], v[28:31]
    ds_read_b128 v[56:59], v2 offset:38912
    v_mfma_f32_16x16x32_bf16 v[32:35], v[166:169], v[60:63], v[32:35]
    s_waitcnt vmcnt(10)
    v_swap_b32 v176, v178
    v_swap_b32 v177, v179
    v_mfma_f32_16x16x32_bf16 v[36:39], v[170:173], v[60:63], v[36:39]
    ds_read_b128 v[60:63], v2 offset:39936
    s_waitcnt lgkmcnt(3)
    v_mfma_f32_16x16x32_bf16 v[16:19], v[174:177], v[40:43], v[16:19]
    buffer_load_dwordx4 v[222:225], v14, s[8:11], 0 offen sc1
    v_add_u32_e64 v14, s4, v14
    v_mfma_f32_16x16x32_bf16 v[20:23], v[178:181], v[40:43], v[20:23]
    ds_read_b128 v[40:43], v2 offset:40960
    v_mfma_f32_16x16x32_bf16 v[24:27], v[174:177], v[44:47], v[24:27]
    buffer_load_dwordx4 v[226:229], v15, s[8:11], 0 offen sc1
    v_add_u32_e64 v15, s4, v15
    v_mfma_f32_16x16x32_bf16 v[28:31], v[178:181], v[44:47], v[28:31]
    ds_read_b128 v[44:47], v2 offset:41984
    v_mfma_f32_16x16x32_bf16 v[32:35], v[174:177], v[48:51], v[32:35]
    s_waitcnt vmcnt(10)
    v_swap_b32 v184, v186
    v_swap_b32 v185, v187
    v_mfma_f32_16x16x32_bf16 v[36:39], v[178:181], v[48:51], v[36:39]
    ds_read_b128 v[48:51], v3 offset:12288
    s_waitcnt lgkmcnt(3)
    v_mfma_f32_16x16x32_bf16 v[16:19], v[182:185], v[52:55], v[16:19]
    buffer_load_dwordx4 v[230:233], v14, s[8:11], 0 offen sc1
    v_add_u32_e64 v14, s4, v14
    v_mfma_f32_16x16x32_bf16 v[20:23], v[186:189], v[52:55], v[20:23]
    ds_read_b128 v[52:55], v3 offset:13312
    v_mfma_f32_16x16x32_bf16 v[24:27], v[182:185], v[56:59], v[24:27]
    buffer_load_dwordx4 v[234:237], v15, s[8:11], 0 offen sc1
    v_add_u32_e64 v15, s4, v15
    v_mfma_f32_16x16x32_bf16 v[28:31], v[186:189], v[56:59], v[28:31]
    ds_read_b128 v[56:59], v3 offset:14336
    v_mfma_f32_16x16x32_bf16 v[32:35], v[182:185], v[60:63], v[32:35]
    s_waitcnt vmcnt(10)
    v_swap_b32 v192, v194
    v_swap_b32 v193, v195
    v_mfma_f32_16x16x32_bf16 v[36:39], v[186:189], v[60:63], v[36:39]
    ds_read_b128 v[60:63], v3 offset:15360
    s_waitcnt lgkmcnt(3)
    v_mfma_f32_16x16x32_bf16 v[16:19], v[190:193], v[40:43], v[16:19]
    buffer_load_dwordx4 v[238:241], v14, s[8:11], 0 offen sc1
    v_add_u32_e64 v14, s4, v14
    v_mfma_f32_16x16x32_bf16 v[20:23], v[194:197], v[40:43], v[20:23]
    ds_read_b128 v[40:43], v2 offset:43264
    v_mfma_f32_16x16x32_bf16 v[24:27], v[190:193], v[44:47], v[24:27]
    buffer_load_dwordx4 v[242:245], v15, s[8:11], 0 offen sc1
    v_add_u32_e64 v15, s4, v15
    v_mfma_f32_16x16x32_bf16 v[28:31], v[194:197], v[44:47], v[28:31]
    buffer_load_dwordx4 v[84:87], v2, s[8:11], s33 offen sc1
    ds_read_b128 v[44:47], v2 offset:44288
    v_mfma_f32_16x16x32_bf16 v[32:35], v[190:193], v[48:51], v[32:35]
    s_waitcnt vmcnt(11)
    v_swap_b32 v200, v202
    v_swap_b32 v201, v203
    v_mfma_f32_16x16x32_bf16 v[36:39], v[194:197], v[48:51], v[36:39]
    ds_read_b128 v[48:51], v2 offset:45312
    s_waitcnt lgkmcnt(3)
    v_mfma_f32_16x16x32_bf16 v[16:19], v[198:201], v[52:55], v[16:19]
    buffer_load_dwordx4 v[246:249], v14, s[8:11], 0 offen sc1
    v_add_u32_e64 v14, s4, v14
    v_mfma_f32_16x16x32_bf16 v[20:23], v[202:205], v[52:55], v[20:23]
    ds_read_b128 v[52:55], v2 offset:52224
    v_mfma_f32_16x16x32_bf16 v[24:27], v[198:201], v[56:59], v[24:27]
    buffer_load_dwordx4 v[250:253], v15, s[8:11], 0 offen sc1
    v_add_u32_e64 v15, s4, v15
    v_mfma_f32_16x16x32_bf16 v[28:31], v[202:205], v[56:59], v[28:31]
    ds_read_b128 v[56:59], v2 offset:53248
    v_mfma_f32_16x16x32_bf16 v[32:35], v[198:201], v[60:63], v[32:35]
    s_waitcnt vmcnt(11)
    v_swap_b32 v208, v210
    v_swap_b32 v209, v211
    v_mfma_f32_16x16x32_bf16 v[36:39], v[202:205], v[60:63], v[36:39]
    ds_read_b128 v[60:63], v2 offset:54272
    s_waitcnt lgkmcnt(3)
    v_mfma_f32_16x16x32_bf16 v[16:19], v[206:209], v[40:43], v[16:19]
    s_add_u32 m0, s25, 106496
    v_mfma_f32_16x16x32_bf16 v[20:23], v[210:213], v[40:43], v[20:23]
    s_add_u32 s76, s27, 8192
    ds_read_b128 v[40:43], v2 offset:55296
    v_mfma_f32_16x16x32_bf16 v[24:27], v[206:209], v[44:47], v[24:27]
    buffer_load_dwordx4 v2, s[8:11], s76 offen offset:0 sc1 lds
    v_mfma_f32_16x16x32_bf16 v[28:31], v[210:213], v[44:47], v[28:31]
    buffer_load_dwordx4 v2, s[8:11], s76 offen offset:1024 sc1 lds
    ds_read_b128 v[44:47], v2 offset:56320
    v_mfma_f32_16x16x32_bf16 v[32:35], v[206:209], v[48:51], v[32:35]
    s_waitcnt vmcnt(11)
    v_swap_b32 v216, v218
    v_swap_b32 v217, v219
    v_mfma_f32_16x16x32_bf16 v[36:39], v[210:213], v[48:51], v[36:39]
    ds_read_b128 v[48:51], v2 offset:57344
    s_waitcnt lgkmcnt(3)
    v_mfma_f32_16x16x32_bf16 v[16:19], v[214:217], v[52:55], v[16:19]
    buffer_load_dwordx4 v2, s[8:11], s76 offen offset:2048 sc1 lds
    v_mfma_f32_16x16x32_bf16 v[20:23], v[218:221], v[52:55], v[20:23]
    buffer_load_dwordx4 v2, s[8:11], s76 offen offset:3072 sc1 lds
    ds_read_b128 v[52:55], v2 offset:58368
    v_mfma_f32_16x16x32_bf16 v[24:27], v[214:217], v[56:59], v[24:27]
    s_add_u32 m0, s25, 110592
    v_mfma_f32_16x16x32_bf16 v[28:31], v[218:221], v[56:59], v[28:31]
    s_add_u32 s76, s27, 12288
    ds_read_b128 v[56:59], v2 offset:59392
    v_mfma_f32_16x16x32_bf16 v[32:35], v[214:217], v[60:63], v[32:35]
    s_waitcnt vmcnt(11)
    v_swap_b32 v224, v226
    v_swap_b32 v225, v227
    v_mfma_f32_16x16x32_bf16 v[36:39], v[218:221], v[60:63], v[36:39]
    ds_read_b128 v[60:63], v3 offset:16384
    s_waitcnt lgkmcnt(3)
    v_mfma_f32_16x16x32_bf16 v[16:19], v[222:225], v[40:43], v[16:19]
    buffer_load_dwordx4 v2, s[8:11], s76 offen offset:0 sc1 lds
    v_mfma_f32_16x16x32_bf16 v[20:23], v[226:229], v[40:43], v[20:23]
    buffer_load_dwordx4 v2, s[8:11], s76 offen offset:1024 sc1 lds
    ds_read_b128 v[40:43], v3 offset:17408
    v_mfma_f32_16x16x32_bf16 v[24:27], v[222:225], v[44:47], v[24:27]
    buffer_load_dwordx4 v2, s[8:11], s76 offen offset:2048 sc1 lds
    v_mfma_f32_16x16x32_bf16 v[28:31], v[226:229], v[44:47], v[28:31]
    s_and_b32 s76, s22, 7
    ds_read_b128 v[44:47], v3 offset:18432
    v_mfma_f32_16x16x32_bf16 v[32:35], v[222:225], v[48:51], v[32:35]
    s_waitcnt vmcnt(12)
    v_swap_b32 v232, v234
    v_swap_b32 v233, v235
    v_mfma_f32_16x16x32_bf16 v[36:39], v[226:229], v[48:51], v[36:39]
    ds_read_b128 v[48:51], v3 offset:19456
    s_waitcnt lgkmcnt(3)
    v_mfma_f32_16x16x32_bf16 v[16:19], v[230:233], v[52:55], v[16:19]
    s_lshl_b32 s76, s76, 14
    v_mfma_f32_16x16x32_bf16 v[20:23], v[234:237], v[52:55], v[20:23]
L_pg4:
    s_cbranch_execz L_wr
    ds_read_b128 v[52:55], v2 offset:60672
    v_mfma_f32_16x16x32_bf16 v[24:27], v[230:233], v[56:59], v[24:27]
    s_add_u32 s76, s76, s74
    v_mfma_f32_16x16x32_bf16 v[28:31], v[234:237], v[56:59], v[28:31]
    ds_read_b128 v[56:59], v2 offset:61696
    s_nop 0
    v_mfma_f32_16x16x32_bf16 v[32:35], v[230:233], v[60:63], v[32:35]
    s_waitcnt vmcnt(10)
    v_swap_b32 v240, v242
    v_swap_b32 v241, v243
    v_mfma_f32_16x16x32_bf16 v[36:39], v[234:237], v[60:63], v[36:39]
    ds_read_b128 v[60:63], v2 offset:62720
    s_waitcnt lgkmcnt(3)
    v_mfma_f32_16x16x32_bf16 v[16:19], v[238:241], v[40:43], v[16:19]
    v_and_b32 v7, 12, v0
    v_mfma_f32_16x16x32_bf16 v[20:23], v[242:245], v[40:43], v[20:23]
    v_mfma_f32_16x16x32_bf16 v[24:27], v[238:241], v[44:47], v[24:27]
    v_lshlrev_b32 v7, 10, v7
    v_mfma_f32_16x16x32_bf16 v[28:31], v[242:245], v[44:47], v[28:31]
    v_mfma_f32_16x16x32_bf16 v[32:35], v[238:241], v[48:51], v[32:35]
    s_waitcnt vmcnt(7)
    v_swap_b32 v248, v250
    v_swap_b32 v249, v251
    v_mfma_f32_16x16x32_bf16 v[36:39], v[242:245], v[48:51], v[36:39]
    v_max3_u32 v92, v84, v85, v86
    v_max_u32 v92, v92, v87
    v_cmp_eq_u32 vcc, -1, v92
    s_cbranch_vccnz L2_r
L2_d:
    v_permlane16_swap_b32 v84, v86
    v_permlane16_swap_b32 v85, v87
    v_add_f32 v84, v84, v86
    v_add_f32 v85, v85, v87
    v_mov_b32 v86, v84
    v_mov_b32 v87, v85
    s_nop 0
    v_permlane32_swap_b32 v84, v86
    v_permlane32_swap_b32 v85, v87
    v_add_f32 v84, v84, v86
    v_add_f32 v85, v85, v87
    v_mul_f32 v93, 0x3acccccd, v84
    v_mul_f32 v86, 0x3acccccd, v85
    v_fma_f32 v86, -v93, v93, v86
    v_max_f32_e64 v86, 0, v86
    v_cvt_pk_bf16_f32 v86, v86, v86
    v_lshlrev_b32_e64 v86, 16, v86
    v_add_f32 v86, 0x3727c5ac, v86
    v_cvt_pk_bf16_f32 v86, v86, v86
    v_lshlrev_b32 v86, 16, v86
    v_sqrt_f32 v86, v86
    v_cvt_pk_bf16_f32 v93, v93, v93
    v_lshlrev_b32_e64 v93, 16, v93
    v_cvt_pk_bf16_f32 v86, v86, v86
    v_lshlrev_b32 v86, 16, v86
    v_rcp_f32 v92, v86
    s_nop 0
    v_mul_f32 v93, v93, v92
    ds_write2_b32 v90, v92, v93 offset1:32
    ds_read_b128 v[64:67], v89 offset:0
    ds_read_b128 v[68:71], v89 offset:64
    ds_read_b128 v[72:75], v89 offset:128
    ds_read_b128 v[76:79], v89 offset:192
    s_waitcnt lgkmcnt(5)
    v_mfma_f32_16x16x32_bf16 v[16:19], v[246:249], v[52:55], v[16:19]
    v_and_b32 v91, 3, v0
    v_mfma_f32_16x16x32_bf16 v[20:23], v[250:253], v[52:55], v[20:23]
    v_mfma_f32_16x16x32_bf16 v[24:27], v[246:249], v[56:59], v[24:27]
    v_lshl_add_u32 v7, v91, 7, v7
    v_mfma_f32_16x16x32_bf16 v[28:31], v[250:253], v[56:59], v[28:31]
    v_mfma_f32_16x16x32_bf16 v[32:35], v[246:249], v[60:63], v[32:35]
    v_mfma_f32_16x16x32_bf16 v[36:39], v[250:253], v[60:63], v[36:39]
    buffer_load_dword v91, v7, s[12:15], s76 offen offset:1536
    v_mov_b32 v14, 0xc0135761
    v_mov_b32 v15, 0xbdd2d3e8
    s_lshr_b32 s30, s70, 3
    s_and_b32 s34, s71, 14
    s_add_u32 s34, s34, s30
    s_cmp_eq_u32 s34, s71
    s_cselect_b32 s30, 96, 0
    s_mul_i32 s31, s34, 192
    s_add_u32 s30, s30, s31
    s_add_u32 s30, s30, 6144
    s_and_b32 s31, s78, 31
    s_add_u32 s33, s30, s31
    s_add_u32 s29, s33, s31
    s_add_u32 s33, s33, 64
    s_lshl_b32 s29, s29, 10
    s_lshl_b32 s33, s33, 10
    s_lshl_b32 s32, s78, 12
    s_add_u32 s32, s32, 5636096
    s_lshl_b32 s31, s71, 8
    s_add_u32 s31, s31, s32
    s_waitcnt lgkmcnt(0)
    v_mov_b32 v84, -1
    v_mov_b32 v85, -1
    v_mov_b32 v86, -1
    v_mov_b32_e64 v87, -1
    buffer_store_dwordx4 v[84:87], v2, s[8:11], s87 offen offset:0 sc1
    v_pk_mul_f32 v[16:17], v[16:17], v[64:65]
    v_pk_mul_f32 v[18:19], v[18:19], v[66:67]
    v_pk_mul_f32 v[20:21], v[20:21], v[68:69]
    v_pk_mul_f32 v[22:23], v[22:23], v[70:71]
    v_pk_fma_f32 v[16:17], v[72:73], v[80:81], v[16:17] op_sel:[0,0,0] op_sel_hi:[1,0,1] neg_lo:[1,0,0] neg_hi:[1,0,0]
    v_pk_fma_f32 v[18:19], v[74:75], v[80:81], v[18:19] op_sel:[0,0,0] op_sel_hi:[1,0,1] neg_lo:[1,0,0] neg_hi:[1,0,0]
    v_pk_fma_f32 v[20:21], v[76:77], v[80:81], v[20:21] op_sel:[0,0,0] op_sel_hi:[1,0,1] neg_lo:[1,0,0] neg_hi:[1,0,0]
    v_pk_fma_f32 v[22:23], v[78:79], v[80:81], v[22:23] op_sel:[0,0,0] op_sel_hi:[1,0,1] neg_lo:[1,0,0] neg_hi:[1,0,0]
    v_pk_mul_f32 v[40:41], v[16:17], v[16:17]
    v_pk_mul_f32 v[42:43], v[18:19], v[18:19]
    v_pk_mul_f32 v[44:45], v[20:21], v[20:21]
    v_pk_mul_f32 v[46:47], v[22:23], v[22:23]
    v_pk_fma_f32 v[40:41], v[40:41], v[14:15], v[14:15] op_sel:[0,1,0] op_sel_hi:[1,1,0]
    v_pk_fma_f32 v[42:43], v[42:43], v[14:15], v[14:15] op_sel:[0,1,0] op_sel_hi:[1,1,0]
    v_pk_fma_f32 v[44:45], v[44:45], v[14:15], v[14:15] op_sel:[0,1,0] op_sel_hi:[1,1,0]
    v_pk_fma_f32 v[46:47], v[46:47], v[14:15], v[14:15] op_sel:[0,1,0] op_sel_hi:[1,1,0]
    v_pk_mul_f32 v[40:41], v[40:41], v[16:17]
    v_pk_mul_f32 v[42:43], v[42:43], v[18:19]
    v_pk_mul_f32 v[44:45], v[44:45], v[20:21]
    v_pk_mul_f32 v[46:47], v[46:47], v[22:23]
    v_exp_f32 v40, v40
    v_exp_f32 v41, v41
    v_exp_f32 v42, v42
    v_exp_f32 v43, v43
    v_exp_f32 v44, v44
    v_exp_f32 v45, v45
    v_exp_f32 v46, v46
    v_exp_f32 v47, v47
    v_pk_add_f32 v[40:41], v[40:41], 1.0 op_sel_hi:[1,0]
    v_pk_add_f32 v[42:43], v[42:43], 1.0 op_sel_hi:[1,0]
    v_pk_add_f32 v[44:45], v[44:45], 1.0 op_sel_hi:[1,0]
    v_pk_add_f32 v[46:47], v[46:47], 1.0 op_sel_hi:[1,0]
    v_rcp_f32 v40, v40
    v_rcp_f32 v41, v41
    v_rcp_f32 v42, v42
    v_rcp_f32 v43, v43
    v_rcp_f32 v44, v44
    v_rcp_f32 v45, v45
    v_rcp_f32 v46, v46
    v_rcp_f32 v47, v47
    v_pk_mul_f32 v[16:17], v[16:17], v[40:41]
    v_pk_mul_f32 v[18:19], v[18:19], v[42:43]
    v_pk_mul_f32 v[20:21], v[20:21], v[44:45]
    v_pk_mul_f32 v[22:23], v[22:23], v[46:47]
    v_pk_mul_f32 v[48:49], v[16:17], v[16:17]
    v_pk_mul_f32 v[50:51], v[18:19], v[18:19]
    v_pk_mul_f32 v[52:53], v[20:21], v[20:21]
    v_pk_mul_f32 v[54:55], v[22:23], v[22:23]
    buffer_store_dwordx4 v[84:87], v2, s[8:11], s87 offen offset:1024 sc1
    v_pk_mul_f32 v[24:25], v[24:25], v[64:65]
    v_pk_mul_f32 v[26:27], v[26:27], v[66:67]
    v_pk_mul_f32 v[28:29], v[28:29], v[68:69]
    v_pk_mul_f32 v[30:31], v[30:31], v[70:71]
    v_pk_fma_f32 v[24:25], v[72:73], v[80:81], v[24:25] op_sel:[0,1,0] op_sel_hi:[1,1,1] neg_lo:[1,0,0] neg_hi:[1,0,0]
    v_pk_fma_f32 v[26:27], v[74:75], v[80:81], v[26:27] op_sel:[0,1,0] op_sel_hi:[1,1,1] neg_lo:[1,0,0] neg_hi:[1,0,0]
    v_pk_fma_f32 v[28:29], v[76:77], v[80:81], v[28:29] op_sel:[0,1,0] op_sel_hi:[1,1,1] neg_lo:[1,0,0] neg_hi:[1,0,0]
    v_pk_fma_f32 v[30:31], v[78:79], v[80:81], v[30:31] op_sel:[0,1,0] op_sel_hi:[1,1,1] neg_lo:[1,0,0] neg_hi:[1,0,0]
    v_pk_mul_f32 v[40:41], v[24:25], v[24:25]
    v_pk_mul_f32 v[42:43], v[26:27], v[26:27]
    v_pk_mul_f32 v[44:45], v[28:29], v[28:29]
    v_pk_mul_f32 v[46:47], v[30:31], v[30:31]
    v_pk_fma_f32 v[40:41], v[40:41], v[14:15], v[14:15] op_sel:[0,1,0] op_sel_hi:[1,1,0]
    v_pk_fma_f32 v[42:43], v[42:43], v[14:15], v[14:15] op_sel:[0,1,0] op_sel_hi:[1,1,0]
    v_pk_fma_f32 v[44:45], v[44:45], v[14:15], v[14:15] op_sel:[0,1,0] op_sel_hi:[1,1,0]
    v_pk_fma_f32 v[46:47], v[46:47], v[14:15], v[14:15] op_sel:[0,1,0] op_sel_hi:[1,1,0]
    v_pk_mul_f32 v[40:41], v[40:41], v[24:25]
    v_pk_mul_f32 v[42:43], v[42:43], v[26:27]
    v_pk_mul_f32 v[44:45], v[44:45], v[28:29]
    v_pk_mul_f32 v[46:47], v[46:47], v[30:31]
    v_exp_f32 v40, v40
    v_exp_f32 v41, v41
    v_exp_f32 v42, v42
    v_exp_f32 v43, v43
    v_exp_f32 v44, v44
    v_exp_f32 v45, v45
    v_exp_f32 v46, v46
    v_exp_f32 v47, v47
    v_pk_add_f32 v[40:41], v[40:41], 1.0 op_sel_hi:[1,0]
    v_pk_add_f32 v[42:43], v[42:43], 1.0 op_sel_hi:[1,0]
    v_pk_add_f32 v[44:45], v[44:45], 1.0 op_sel_hi:[1,0]
    v_pk_add_f32 v[46:47], v[46:47], 1.0 op_sel_hi:[1,0]
    v_rcp_f32 v40, v40
    v_rcp_f32 v41, v41
    v_rcp_f32 v42, v42
    v_rcp_f32 v43, v43
    v_rcp_f32 v44, v44
    v_rcp_f32 v45, v45
    v_rcp_f32 v46, v46
    v_rcp_f32 v47, v47
    v_pk_mul_f32 v[24:25], v[24:25], v[40:41]
    v_pk_mul_f32 v[26:27], v[26:27], v[42:43]
    v_pk_mul_f32 v[28:29], v[28:29], v[44:45]
    v_pk_mul_f32 v[30:31], v[30:31], v[46:47]
    v_pk_add_f32 v[56:57], v[24:25], v[16:17]
    v_pk_fma_f32 v[48:49], v[24:25], v[24:25], v[48:49]
    v_pk_add_f32 v[58:59], v[26:27], v[18:19]
    v_pk_fma_f32 v[50:51], v[26:27], v[26:27], v[50:51]
    v_pk_add_f32 v[60:61], v[28:29], v[20:21]
    v_pk_fma_f32 v[52:53], v[28:29], v[28:29], v[52:53]
    v_pk_add_f32 v[62:63], v[30:31], v[22:23]
    v_pk_fma_f32 v[54:55], v[30:31], v[30:31], v[54:55]
    buffer_store_dwordx4 v[84:87], v2, s[8:11], s87 offen offset:2048 sc1
    v_pk_mul_f32 v[32:33], v[32:33], v[64:65]
    v_pk_mul_f32 v[34:35], v[34:35], v[66:67]
    v_pk_mul_f32 v[36:37], v[36:37], v[68:69]
    v_pk_mul_f32 v[38:39], v[38:39], v[70:71]
    v_pk_fma_f32 v[32:33], v[72:73], v[82:83], v[32:33] op_sel:[0,0,0] op_sel_hi:[1,0,1] neg_lo:[1,0,0] neg_hi:[1,0,0]
    v_pk_fma_f32 v[34:35], v[74:75], v[82:83], v[34:35] op_sel:[0,0,0] op_sel_hi:[1,0,1] neg_lo:[1,0,0] neg_hi:[1,0,0]
    v_pk_fma_f32 v[36:37], v[76:77], v[82:83], v[36:37] op_sel:[0,0,0] op_sel_hi:[1,0,1] neg_lo:[1,0,0] neg_hi:[1,0,0]
    v_pk_fma_f32 v[38:39], v[78:79], v[82:83], v[38:39] op_sel:[0,0,0] op_sel_hi:[1,0,1] neg_lo:[1,0,0] neg_hi:[1,0,0]
    v_pk_mul_f32 v[40:41], v[32:33], v[32:33]
    v_pk_mul_f32 v[42:43], v[34:35], v[34:35]
    v_pk_mul_f32 v[44:45], v[36:37], v[36:37]
    v_pk_mul_f32 v[46:47], v[38:39], v[38:39]
    v_pk_fma_f32 v[40:41], v[40:41], v[14:15], v[14:15] op_sel:[0,1,0] op_sel_hi:[1,1,0]
    v_pk_fma_f32 v[42:43], v[42:43], v[14:15], v[14:15] op_sel:[0,1,0] op_sel_hi:[1,1,0]
    v_pk_fma_f32 v[44:45], v[44:45], v[14:15], v[14:15] op_sel:[0,1,0] op_sel_hi:[1,1,0]
    v_pk_fma_f32 v[46:47], v[46:47], v[14:15], v[14:15] op_sel:[0,1,0] op_sel_hi:[1,1,0]
    v_pk_mul_f32 v[40:41], v[40:41], v[32:33]
    v_pk_mul_f32 v[42:43], v[42:43], v[34:35]
    v_pk_mul_f32 v[44:45], v[44:45], v[36:37]
    v_pk_mul_f32 v[46:47], v[46:47], v[38:39]
    v_exp_f32 v40, v40
    v_exp_f32 v41, v41
    v_exp_f32 v42, v42
    v_exp_f32 v43, v43
    v_exp_f32 v44, v44
    v_exp_f32 v45, v45
    v_exp_f32 v46, v46
    v_exp_f32 v47, v47
    v_pk_add_f32 v[40:41], v[40:41], 1.0 op_sel_hi:[1,0]
    v_pk_add_f32 v[42:43], v[42:43], 1.0 op_sel_hi:[1,0]
    v_pk_add_f32 v[44:45], v[44:45], 1.0 op_sel_hi:[1,0]
    v_pk_add_f32 v[46:47], v[46:47], 1.0 op_sel_hi:[1,0]
    v_rcp_f32 v40, v40
    v_rcp_f32 v41, v41
    v_rcp_f32 v42, v42
    v_rcp_f32 v43, v43
    v_rcp_f32 v44, v44
    v_rcp_f32 v45, v45
    v_rcp_f32 v46, v46
    v_rcp_f32 v47, v47
    v_pk_mul_f32 v[32:33], v[32:33], v[40:41]
    v_pk_mul_f32 v[34:35], v[34:35], v[42:43]
    v_pk_mul_f32 v[36:37], v[36:37], v[44:45]
    v_pk_mul_f32 v[38:39], v[38:39], v[46:47]
    v_pk_add_f32 v[56:57], v[32:33], v[56:57]
    v_pk_fma_f32 v[48:49], v[32:33], v[32:33], v[48:49]
    v_pk_add_f32 v[58:59], v[34:35], v[58:59]
    v_pk_fma_f32 v[50:51], v[34:35], v[34:35], v[50:51]
    v_pk_add_f32 v[60:61], v[36:37], v[60:61]
    v_pk_fma_f32 v[52:53], v[36:37], v[36:37], v[52:53]
    v_pk_add_f32 v[62:63], v[38:39], v[62:63]
    v_pk_fma_f32 v[54:55], v[38:39], v[38:39], v[54:55]
    v_add_f32_dpp v56, v56, v56 row_ror:8 row_mask:0xf bank_mask:0x3
    v_add_f32_dpp v57, v57, v57 row_ror:8 row_mask:0xf bank_mask:0x3
    v_add_f32_dpp v58, v58, v58 row_ror:8 row_mask:0xf bank_mask:0x3
    v_add_f32_dpp v59, v59, v59 row_ror:8 row_mask:0xf bank_mask:0x3
    v_add_f32_dpp v60, v60, v60 row_ror:8 row_mask:0xf bank_mask:0x3
    v_add_f32_dpp v61, v61, v61 row_ror:8 row_mask:0xf bank_mask:0x3
    v_add_f32_dpp v62, v62, v62 row_ror:8 row_mask:0xf bank_mask:0x3
    v_add_f32_dpp v63, v63, v63 row_ror:8 row_mask:0xf bank_mask:0x3
    v_add_f32_dpp v56, v48, v48 row_ror:8 row_mask:0xf bank_mask:0xc
    v_add_f32_dpp v57, v49, v49 row_ror:8 row_mask:0xf bank_mask:0xc
    v_add_f32_dpp v58, v50, v50 row_ror:8 row_mask:0xf bank_mask:0xc
    v_add_f32_dpp v59, v51, v51 row_ror:8 row_mask:0xf bank_mask:0xc
    v_add_f32_dpp v60, v52, v52 row_ror:8 row_mask:0xf bank_mask:0xc
    v_add_f32_dpp v61, v53, v53 row_ror:8 row_mask:0xf bank_mask:0xc
    v_add_f32_dpp v62, v54, v54 row_ror:8 row_mask:0xf bank_mask:0xc
    v_add_f32_dpp v63, v55, v55 row_ror:8 row_mask:0xf bank_mask:0xc
    v_add_f32_dpp v56, v56, v56 row_half_mirror row_mask:0xf bank_mask:0x5
    v_add_f32_dpp v57, v57, v57 row_half_mirror row_mask:0xf bank_mask:0x5
    v_add_f32_dpp v58, v58, v58 row_half_mirror row_mask:0xf bank_mask:0x5
    v_add_f32_dpp v59, v59, v59 row_half_mirror row_mask:0xf bank_mask:0x5
    v_add_f32_dpp v56, v60, v60 row_half_mirror row_mask:0xf bank_mask:0xa
    v_add_f32_dpp v57, v61, v61 row_half_mirror row_mask:0xf bank_mask:0xa
    v_add_f32_dpp v58, v62, v62 row_half_mirror row_mask:0xf bank_mask:0xa
    v_add_f32_dpp v59, v63, v63 row_half_mirror row_mask:0xf bank_mask:0xa
    v_add_f32_dpp v56, v56, v56 quad_perm:[2,3,0,1] row_mask:0xf bank_mask:0xf
    v_add_f32_dpp v57, v57, v57 quad_perm:[2,3,0,1] row_mask:0xf bank_mask:0xf
    v_add_f32_dpp v58, v58, v58 quad_perm:[2,3,0,1] row_mask:0xf bank_mask:0xf
    v_add_f32_dpp v59, v59, v59 quad_perm:[2,3,0,1] row_mask:0xf bank_mask:0xf
    v_add_f32_dpp v56, v56, v56 quad_perm:[1,0,3,2] row_mask:0xf bank_mask:0xf
    v_add_f32_dpp v57, v57, v57 quad_perm:[1,0,3,2] row_mask:0xf bank_mask:0xf
    v_add_f32_dpp v58, v58, v58 quad_perm:[1,0,3,2] row_mask:0xf bank_mask:0xf
    v_add_f32_dpp v59, v59, v59 quad_perm:[1,0,3,2] row_mask:0xf bank_mask:0xf
    v_cndmask_b32 v92, v56, v57, s[80:81]
    v_cndmask_b32 v92, v92, v58, s[82:83]
    v_cndmask_b32 v92, v92, v59, s[18:19]
    buffer_store_dword v92, v1, s[8:11], s31 offen sc1
    v_add_u32_e64 v1, s32, v2
    s_waitcnt vmcnt(5)
    s_barrier
    ds_read_b128 v[40:43], v4 offset:10240
    ds_read_b128 v[44:47], v4 offset:11264
    ds_read_b128 v[48:51], v4 offset:12288
    ds_read_b128 v[52:55], v4 offset:13312
    ds_read_b128 v[56:59], v4 offset:14336
    ds_read_b128 v[60:63], v4 offset:15360
    s_waitcnt lgkmcnt(5)
    v_mfma_f32_16x16x32_bf16 v[64:67], v[40:43], v[206:209], 0
    s_nop 0
    v_mfma_f32_16x16x32_bf16 v[68:71], v[40:43], v[210:213], 0
    ds_read_b128 v[40:43], v4 offset:16384
    s_add_u32 m0, s75, -512
    s_waitcnt lgkmcnt(5)
    v_mfma_f32_16x16x32_bf16 v[72:75], v[44:47], v[206:209], 0
    s_nop 0
    v_mfma_f32_16x16x32_bf16 v[76:79], v[44:47], v[210:213], 0
    ds_read_b128 v[44:47], v4 offset:17408
    s_waitcnt lgkmcnt(5)
    v_mfma_f32_16x16x32_bf16 v[80:83], v[48:51], v[206:209], 0
    s_nop 0
    v_mfma_f32_16x16x32_bf16 v[84:87], v[48:51], v[210:213], 0
    ds_read_b128 v[48:51], v4 offset:18432
    s_waitcnt lgkmcnt(3)
    v_mfma_f32_16x16x32_bf16 v[64:67], v[52:55], v[214:217], v[64:67]
    s_nop 0
    v_mfma_f32_16x16x32_bf16 v[68:71], v[52:55], v[218:221], v[68:71]
    ds_read_b128 v[52:55], v4 offset:19456
    buffer_load_dwordx4 v8, s[12:15], 0 offen offset:512 lds
    v_mfma_f32_16x16x32_bf16 v[72:75], v[56:59], v[214:217], v[72:75]
    v_mfma_f32_16x16x32_bf16 v[76:79], v[56:59], v[218:221], v[76:79]
    ds_read_b128 v[56:59], v4 offset:20480
    buffer_load_dwordx4 v9, s[12:15], 0 offen offset:1536 lds
    v_mfma_f32_16x16x32_bf16 v[80:83], v[60:63], v[214:217], v[80:83]
    v_mfma_f32_16x16x32_bf16 v[84:87], v[60:63], v[218:221], v[84:87]
    ds_read_b128 v[60:63], v4 offset:21504
    s_waitcnt lgkmcnt(3)
    v_mfma_f32_16x16x32_bf16 v[64:67], v[40:43], v[222:225], v[64:67]
    v_mfma_f32_16x16x32_bf16 v[68:71], v[40:43], v[226:229], v[68:71]
    ds_read_b128 v[40:43], v4 offset:22528
    v_mfma_f32_16x16x32_bf16 v[72:75], v[44:47], v[222:225], v[72:75]
    s_nop 0
    v_mfma_f32_16x16x32_bf16 v[76:79], v[44:47], v[226:229], v[76:79]
    ds_read_b128 v[44:47], v4 offset:23552
    buffer_load_dwordx4 v10, s[12:15], 0 offen offset:2560 lds
    v_mfma_f32_16x16x32_bf16 v[80:83], v[48:51], v[222:225], v[80:83]
    v_mfma_f32_16x16x32_bf16 v[84:87], v[48:51], v[226:229], v[84:87]
    ds_read_b128 v[48:51], v4 offset:24576
    s_waitcnt lgkmcnt(3)
    v_mfma_f32_16x16x32_bf16 v[64:67], v[52:55], v[230:233], v[64:67]
    s_nop 0
    v_mfma_f32_16x16x32_bf16 v[68:71], v[52:55], v[234:237], v[68:71]
    ds_read_b128 v[52:55], v4 offset:25600
    buffer_load_dwordx4 v11, s[12:15], 0 offen offset:3584 lds
    v_mfma_f32_16x16x32_bf16 v[72:75], v[56:59], v[230:233], v[72:75]
    v_mfma_f32_16x16x32_bf16 v[76:79], v[56:59], v[234:237], v[76:79]
    ds_read_b128 v[56:59], v4 offset:26624
    s_add_u32 m0, s75, 3456
    v_mfma_f32_16x16x32_bf16 v[80:83], v[60:63], v[230:233], v[80:83]
    v_mfma_f32_16x16x32_bf16 v[84:87], v[60:63], v[234:237], v[84:87]
    ds_read_b128 v[60:63], v4 offset:27648
    s_waitcnt lgkmcnt(3)
    v_mfma_f32_16x16x32_bf16 v[64:67], v[40:43], v[238:241], v[64:67]
    v_mfma_f32_16x16x32_bf16 v[68:71], v[40:43], v[242:245], v[68:71]
    ds_read_b128 v[40:43], v3 offset:32768
    v_mfma_f32_16x16x32_bf16 v[72:75], v[44:47], v[238:241], v[72:75]
    s_nop 0
    v_mfma_f32_16x16x32_bf16 v[76:79], v[44:47], v[242:245], v[76:79]
    ds_read_b128 v[44:47], v3 offset:33792
    buffer_load_dwordx4 v8, s[12:15], 0 offen offset:640 lds
    v_mfma_f32_16x16x32_bf16 v[80:83], v[48:51], v[238:241], v[80:83]
    v_mfma_f32_16x16x32_bf16 v[84:87], v[48:51], v[242:245], v[84:87]
    ds_read_b128 v[48:51], v3 offset:34816
    s_waitcnt lgkmcnt(3)
    v_mfma_f32_16x16x32_bf16 v[64:67], v[52:55], v[246:249], v[64:67]
    s_nop 0
    v_mfma_f32_16x16x32_bf16 v[68:71], v[52:55], v[250:253], v[68:71]
    ds_read_b128 v[52:55], v3 offset:35840
    buffer_load_dwordx4 v9, s[12:15], 0 offen offset:1664 lds
    v_mfma_f32_16x16x32_bf16 v[72:75], v[56:59], v[246:249], v[72:75]
    v_mfma_f32_16x16x32_bf16 v[76:79], v[56:59], v[250:253], v[76:79]
    ds_read_b128 v[56:59], v3 offset:36864
    v_mfma_f32_16x16x32_bf16 v[80:83], v[60:63], v[246:249], v[80:83]
    v_mfma_f32_16x16x32_bf16 v[84:87], v[60:63], v[250:253], v[84:87]
    ds_read_b128 v[60:63], v3 offset:37888
    s_waitcnt lgkmcnt(3)
    v_mfma_f32_16x16x32_bf16 v[64:67], v[40:43], v[94:97], v[64:67]
    s_nop 0
    v_mfma_f32_16x16x32_bf16 v[68:71], v[40:43], v[98:101], v[68:71]
    ds_read_b128 v[40:43], v3 offset:38912
    buffer_load_dwordx4 v10, s[12:15], 0 offen offset:2688 lds
    v_mfma_f32_16x16x32_bf16 v[72:75], v[44:47], v[94:97], v[72:75]
    v_mfma_f32_16x16x32_bf16 v[76:79], v[44:47], v[98:101], v[76:79]
    ds_read_b128 v[44:47], v3 offset:39936
    buffer_load_dwordx4 v11, s[12:15], 0 offen offset:3712 lds
    v_mfma_f32_16x16x32_bf16 v[80:83], v[48:51], v[94:97], v[80:83]
    v_mfma_f32_16x16x32_bf16 v[84:87], v[48:51], v[98:101], v[84:87]
    ds_read_b128 v[48:51], v3 offset:40960
    s_waitcnt lgkmcnt(3)
    v_mfma_f32_16x16x32_bf16 v[64:67], v[52:55], v[102:105], v[64:67]
    s_nop 0
    v_mfma_f32_16x16x32_bf16 v[68:71], v[52:55], v[106:109], v[68:71]
    ds_read_b128 v[52:55], v3 offset:41984
    s_add_u32 m0, s75, 7424
    v_mfma_f32_16x16x32_bf16 v[72:75], v[56:59], v[102:105], v[72:75]
    v_mfma_f32_16x16x32_bf16 v[76:79], v[56:59], v[106:109], v[76:79]
    ds_read_b128 v[56:59], v3 offset:43008
    v_mfma_f32_16x16x32_bf16 v[80:83], v[60:63], v[102:105], v[80:83]
    v_mfma_f32_16x16x32_bf16 v[84:87], v[60:63], v[106:109], v[84:87]
    ds_read_b128 v[60:63], v3 offset:44032
    s_waitcnt lgkmcnt(3)
    v_mfma_f32_16x16x32_bf16 v[64:67], v[40:43], v[110:113], v[64:67]
    s_nop 0
    v_mfma_f32_16x16x32_bf16 v[68:71], v[40:43], v[114:117], v[68:71]
    ds_read_b128 v[40:43], v3 offset:45056
    buffer_load_dwordx4 v8, s[12:15], 0 offen offset:768 lds
    v_mfma_f32_16x16x32_bf16 v[72:75], v[44:47], v[110:113], v[72:75]
    v_mfma_f32_16x16x32_bf16 v[76:79], v[44:47], v[114:117], v[76:79]
    ds_read_b128 v[44:47], v3 offset:46080
    buffer_load_dwordx4 v9, s[12:15], 0 offen offset:1792 lds
    v_mfma_f32_16x16x32_bf16 v[80:83], v[48:51], v[110:113], v[80:83]
    s_nop 0
    v_mfma_f32_16x16x32_bf16 v[84:87], v[48:51], v[114:117], v[84:87]
    ds_read_b128 v[48:51], v3 offset:47104
    s_waitcnt lgkmcnt(3)
    v_mfma_f32_16x16x32_bf16 v[64:67], v[52:55], v[118:121], v[64:67]
    buffer_load_dwordx4 v[222:225], v1, s[8:11], 0 offen offset:0 sc1
    buffer_load_dwordx4 v[226:229], v1, s[8:11], 0 offen offset:1024 sc1
    v_mfma_f32_16x16x32_bf16 v[68:71], v[52:55], v[122:125], v[68:71]
    ds_read_b128 v[52:55], v3 offset:48128
    buffer_load_dwordx4 v[230:233], v1, s[8:11], 0 offen offset:2048 sc1
    v_mfma_f32_16x16x32_bf16 v[72:75], v[56:59], v[118:121], v[72:75]
    buffer_load_dwordx4 v[234:237], v1, s[8:11], 0 offen offset:3072 sc1
    v_mfma_f32_16x16x32_bf16 v[76:79], v[56:59], v[122:125], v[76:79]
    ds_read_b128 v[56:59], v3 offset:49152
    buffer_load_dwordx4 v10, s[12:15], 0 offen offset:2816 lds
    v_mfma_f32_16x16x32_bf16 v[80:83], v[60:63], v[118:121], v[80:83]
    v_mfma_f32_16x16x32_bf16 v[84:87], v[60:63], v[122:125], v[84:87]
    ds_read_b128 v[60:63], v3 offset:50176
    s_waitcnt lgkmcnt(3)
    v_mfma_f32_16x16x32_bf16 v[64:67], v[40:43], v[126:129], v[64:67]
    s_lshl_b32 s30, s78, 6
    v_lshl_add_u32 v7, v5, 2, s30
    v_mfma_f32_16x16x32_bf16 v[68:71], v[40:43], v[130:133], v[68:71]
    ds_read_b128 v[40:43], v3 offset:51200
    buffer_load_dwordx4 v11, s[12:15], 0 offen offset:3840 lds
    v_mfma_f32_16x16x32_bf16 v[72:75], v[44:47], v[126:129], v[72:75]
    global_load_dword v91, v7, s[60:61]
    v_mfma_f32_16x16x32_bf16 v[76:79], v[44:47], v[130:133], v[76:79]
    ds_read_b128 v[44:47], v3 offset:52224
    s_add_u32 m0, s75, 11392
    v_mfma_f32_16x16x32_bf16 v[80:83], v[48:51], v[126:129], v[80:83]
    v_and_b32 v7, 3, v0
    v_lshlrev_b32 v7, 4, v7
    v_mfma_f32_16x16x32_bf16 v[84:87], v[48:51], v[130:133], v[84:87]
    ds_read_b128 v[48:51], v3 offset:53248
    s_waitcnt lgkmcnt(3)
    v_mfma_f32_16x16x32_bf16 v[64:67], v[52:55], v[134:137], v[64:67]
    v_lshl_add_u32 v7, v6, 6, v7
    v_mfma_f32_16x16x32_bf16 v[68:71], v[52:55], v[138:141], v[68:71]
    s_nop 0
    ds_read_b128 v[52:55], v3 offset:54272
    v_mfma_f32_16x16x32_bf16 v[72:75], v[56:59], v[134:137], v[72:75]
    buffer_load_dwordx4 v[206:209], v7, s[8:11], s79 offen offset:0 sc1
    v_mfma_f32_16x16x32_bf16 v[76:79], v[56:59], v[138:141], v[76:79]
    ds_read_b128 v[56:59], v3 offset:55296
    buffer_load_dwordx4 v8, s[12:15], 0 offen offset:896 lds
    v_mfma_f32_16x16x32_bf16 v[80:83], v[60:63], v[134:137], v[80:83]
    buffer_load_dwordx4 v[210:213], v7, s[8:11], s79 offen offset:256 sc1
    v_mfma_f32_16x16x32_bf16 v[84:87], v[60:63], v[138:141], v[84:87]
    ds_read_b128 v[60:63], v3 offset:56320
    s_nop 0
    s_waitcnt lgkmcnt(3)
    v_mfma_f32_16x16x32_bf16 v[64:67], v[40:43], v[142:145], v[64:67]
    buffer_load_dwordx4 v[214:217], v7, s[8:11], s79 offen offset:512 sc1
    v_mfma_f32_16x16x32_bf16 v[68:71], v[40:43], v[146:149], v[68:71]
    ds_read_b128 v[40:43], v3 offset:57344
    buffer_load_dwordx4 v9, s[12:15], 0 offen offset:1920 lds
    v_mfma_f32_16x16x32_bf16 v[72:75], v[44:47], v[142:145], v[72:75]
    ds_read2_b32 v[218:219], v88 offset0:0 offset1:16
    ds_read2_b32 v[220:221], v88 offset0:32 offset1:48
    v_mfma_f32_16x16x32_bf16 v[76:79], v[44:47], v[146:149], v[76:79]
    ds_read_b128 v[44:47], v3 offset:58368
    v_mfma_f32_16x16x32_bf16 v[80:83], v[48:51], v[142:145], v[80:83]
    v_mfma_f32_16x16x32_bf16 v[84:87], v[48:51], v[146:149], v[84:87]
    ds_read_b128 v[48:51], v3 offset:59392
    s_waitcnt lgkmcnt(5)
    v_mfma_f32_16x16x32_bf16 v[64:67], v[52:55], v[150:153], v[64:67]
    s_nop 0
    v_mfma_f32_16x16x32_bf16 v[68:71], v[52:55], v[154:157], v[68:71]
    ds_read_b128 v[52:55], v3 offset:60416
    buffer_load_dwordx4 v10, s[12:15], 0 offen offset:2944 lds
    v_mfma_f32_16x16x32_bf16 v[72:75], v[56:59], v[150:153], v[72:75]
    v_mfma_f32_16x16x32_bf16 v[76:79], v[56:59], v[154:157], v[76:79]
    ds_read_b128 v[56:59], v3 offset:61440
    buffer_load_dwordx4 v11, s[12:15], 0 offen offset:3968 lds
    v_mfma_f32_16x16x32_bf16 v[80:83], v[60:63], v[150:153], v[80:83]
    v_mfma_f32_16x16x32_bf16 v[84:87], v[60:63], v[154:157], v[84:87]
    ds_read_b128 v[60:63], v3 offset:62464
    s_waitcnt lgkmcnt(3)
    v_mfma_f32_16x16x32_bf16 v[64:67], v[40:43], v[158:161], v[64:67]
    s_waitcnt vmcnt(10)
    v_max3_u32 v92, v222, v223, v224
    v_mfma_f32_16x16x32_bf16 v[68:71], v[40:43], v[162:165], v[68:71]
    ds_read_b128 v[40:43], v3 offset:63488
    v_max3_u32 v92, v92, v225, v226
    v_mfma_f32_16x16x32_bf16 v[72:75], v[44:47], v[158:161], v[72:75]
    v_max3_u32 v92, v92, v227, v228
    v_max3_u32 v92, v92, v229, v230
    v_mfma_f32_16x16x32_bf16 v[76:79], v[44:47], v[162:165], v[76:79]
    ds_read_b128 v[44:47], v3 offset:64512
    v_max3_u32 v92, v92, v231, v232
    v_mfma_f32_16x16x32_bf16 v[80:83], v[48:51], v[158:161], v[80:83]
    v_max3_u32 v92, v92, v233, v234
    v_max3_u32 v92, v92, v235, v236
    v_mfma_f32_16x16x32_bf16 v[84:87], v[48:51], v[162:165], v[84:87]
    ds_read_b128 v[48:51], v4 offset:0
    v_max_u32_e64 v92, v92, v237
    v_cmp_eq_u32 vcc, -1, v92
    s_cbranch_vccnz L3_r
L3_d:
    v_add_f32 v222, v222, v230
    v_add_f32 v223, v223, v231
    v_add_f32 v224, v224, v232
    v_add_f32 v225, v225, v233
    v_add_f32 v226, v226, v234
    v_add_f32 v227, v227, v235
    v_add_f32 v228, v228, v236
    v_add_f32 v229, v229, v237
    v_add_f32 v222, v222, v226
    v_add_f32 v223, v223, v227
    v_add_f32 v224, v224, v228
    v_add_f32 v225, v225, v229
    s_nop 0
    v_permlane16_swap_b32 v222, v224
    v_permlane16_swap_b32 v223, v225
    v_add_f32 v222, v222, v224
    v_add_f32 v223, v223, v225
    v_mov_b32 v224, v222
    v_mov_b32 v225, v223
    s_nop 0
    v_permlane32_swap_b32 v222, v224
    v_permlane32_swap_b32 v223, v225
    v_add_f32 v222, v222, v224
    v_add_f32 v223, v223, v225
    v_mul_f32 v93, 0x3aaaaaab, v222
    v_mul_f32 v224, 0x3aaaaaab, v223
    v_fma_f32 v224, -v93, v93, v224
    v_max_f32_e64 v224, 0, v224
    v_cvt_pk_bf16_f32 v224, v224, v224
    v_lshlrev_b32_e64 v224, 16, v224
    v_add_f32 v224, 0x3727c5ac, v224
    v_cvt_pk_bf16_f32 v224, v224, v224
    v_lshlrev_b32 v224, 16, v224
    v_sqrt_f32 v224, v224
    v_cvt_pk_bf16_f32 v93, v93, v93
    v_lshlrev_b32_e64 v93, 16, v93
    v_cvt_pk_bf16_f32 v224, v224, v224
    v_lshlrev_b32 v224, 16, v224
    v_rcp_f32 v92, v224
    s_nop 0
    v_mul_f32 v93, v93, v92
    ds_write2_b32 v90, v92, v93 offset1:32
    ds_read_b128 v[238:241], v89 offset:0
    ds_read_b128 v[242:245], v89 offset:64
    ds_read_b128 v[246:249], v89 offset:128
    ds_read_b128 v[250:253], v89 offset:192
    s_nop 0
    s_waitcnt lgkmcnt(0)
    v_pk_fma_f32 v[16:17], v[16:17], v[238:239], v[246:247] neg_lo:[0,0,1] neg_hi:[0,0,1]
    v_pk_fma_f32 v[18:19], v[18:19], v[240:241], v[248:249] neg_lo:[0,0,1] neg_hi:[0,0,1]
    v_pk_fma_f32 v[20:21], v[20:21], v[242:243], v[250:251] neg_lo:[0,0,1] neg_hi:[0,0,1]
    v_pk_fma_f32 v[22:23], v[22:23], v[244:245], v[252:253] neg_lo:[0,0,1] neg_hi:[0,0,1]
    v_cvt_pk_bf16_f32 v226, v16, v20
    v_cvt_pk_bf16_f32 v227, v17, v21
    v_cvt_pk_bf16_f32 v228, v18, v22
    v_cvt_pk_bf16_f32 v229, v19, v23
    buffer_store_dwordx4 v[226:229], v2, s[8:11], s29 offen offset:0 sc1
    v_pk_fma_f32 v[24:25], v[24:25], v[238:239], v[246:247] neg_lo:[0,0,1] neg_hi:[0,0,1]
    v_pk_fma_f32 v[26:27], v[26:27], v[240:241], v[248:249] neg_lo:[0,0,1] neg_hi:[0,0,1]
    v_pk_fma_f32 v[28:29], v[28:29], v[242:243], v[250:251] neg_lo:[0,0,1] neg_hi:[0,0,1]
    v_pk_fma_f32 v[30:31], v[30:31], v[244:245], v[252:253] neg_lo:[0,0,1] neg_hi:[0,0,1]
    v_cvt_pk_bf16_f32 v230, v24, v28
    v_cvt_pk_bf16_f32 v231, v25, v29
    v_cvt_pk_bf16_f32 v232, v26, v30
    v_cvt_pk_bf16_f32 v233, v27, v31
    buffer_store_dwordx4 v[230:233], v2, s[8:11], s29 offen offset:1024 sc1
    v_pk_fma_f32 v[32:33], v[32:33], v[238:239], v[246:247] neg_lo:[0,0,1] neg_hi:[0,0,1]
    v_pk_fma_f32 v[34:35], v[34:35], v[240:241], v[248:249] neg_lo:[0,0,1] neg_hi:[0,0,1]
    v_pk_fma_f32 v[36:37], v[36:37], v[242:243], v[250:251] neg_lo:[0,0,1] neg_hi:[0,0,1]
    v_pk_fma_f32 v[38:39], v[38:39], v[244:245], v[252:253] neg_lo:[0,0,1] neg_hi:[0,0,1]
    v_cvt_pk_bf16_f32 v234, v32, v36
    v_cvt_pk_bf16_f32 v235, v33, v37
    v_cvt_pk_bf16_f32 v236, v34, v38
    v_cvt_pk_bf16_f32 v237, v35, v39
    buffer_store_dwordx4 v[234:237], v2, s[8:11], s33 offen offset:0 sc1
    v_mfma_f32_16x16x32_bf16 v[64:67], v[52:55], v[166:169], v[64:67]
    v_mfma_f32_16x16x32_bf16 v[68:71], v[52:55], v[170:173], v[68:71]
    ds_read_b128 v[52:55], v4 offset:1024
    v_mfma_f32_16x16x32_bf16 v[72:75], v[56:59], v[166:169], v[72:75]
    v_mfma_f32_16x16x32_bf16 v[76:79], v[56:59], v[170:173], v[76:79]
    ds_read_b128 v[56:59], v4 offset:2048
    v_mfma_f32_16x16x32_bf16 v[80:83], v[60:63], v[166:169], v[80:83]
    v_mfma_f32_16x16x32_bf16 v[84:87], v[60:63], v[170:173], v[84:87]
    ds_read_b128 v[60:63], v4 offset:3072
    v_mfma_f32_16x16x32_bf16 v[64:67], v[40:43], v[174:177], v[64:67]
    s_waitcnt vmcnt(6)
    v_add_f32_dpp v206, v206, v206 quad_perm:[2,3,0,1] row_mask:0xf bank_mask:0xf
    v_mfma_f32_16x16x32_bf16 v[68:71], v[40:43], v[178:181], v[68:71]
L_pg5:
    s_cbranch_execz L_wr
    ds_read_b128 v[40:43], v4 offset:4096
    v_add_f32_dpp v207, v207, v207 quad_perm:[2,3,0,1] row_mask:0xf bank_mask:0xf
    v_mfma_f32_16x16x32_bf16 v[72:75], v[44:47], v[174:177], v[72:75]
    v_add_f32_dpp v208, v208, v208 quad_perm:[2,3,0,1] row_mask:0xf bank_mask:0xf
    v_add_f32_dpp v209, v209, v209 quad_perm:[2,3,0,1] row_mask:0xf bank_mask:0xf
    v_mfma_f32_16x16x32_bf16 v[76:79], v[44:47], v[178:181], v[76:79]
    ds_read_b128 v[44:47], v4 offset:5120
    v_add_f32_dpp v210, v210, v210 quad_perm:[2,3,0,1] row_mask:0xf bank_mask:0xf
    v_mfma_f32_16x16x32_bf16 v[80:83], v[48:51], v[174:177], v[80:83]
    v_add_f32_dpp v211, v211, v211 quad_perm:[2,3,0,1] row_mask:0xf bank_mask:0xf
    v_add_f32_dpp v212, v212, v212 quad_perm:[2,3,0,1] row_mask:0xf bank_mask:0xf
    v_mfma_f32_16x16x32_bf16 v[84:87], v[48:51], v[178:181], v[84:87]
    ds_read_b128 v[48:51], v4 offset:6144
    s_waitcnt lgkmcnt(3)
    s_nop 0
    v_mfma_f32_16x16x32_bf16 v[64:67], v[52:55], v[182:185], v[64:67]
    v_add_f32_dpp v213, v213, v213 quad_perm:[2,3,0,1] row_mask:0xf bank_mask:0xf
    v_add_f32_dpp v214, v214, v214 quad_perm:[2,3,0,1] row_mask:0xf bank_mask:0xf
    v_mfma_f32_16x16x32_bf16 v[68:71], v[52:55], v[186:189], v[68:71]
    ds_read_b128 v[52:55], v4 offset:7168
    v_add_f32_dpp v215, v215, v215 quad_perm:[2,3,0,1] row_mask:0xf bank_mask:0xf
    v_mfma_f32_16x16x32_bf16 v[72:75], v[56:59], v[182:185], v[72:75]
    v_add_f32_dpp v216, v216, v216 quad_perm:[2,3,0,1] row_mask:0xf bank_mask:0xf
    v_add_f32_dpp v217, v217, v217 quad_perm:[2,3,0,1] row_mask:0xf bank_mask:0xf
    v_mfma_f32_16x16x32_bf16 v[76:79], v[56:59], v[186:189], v[76:79]
    ds_read_b128 v[56:59], v4 offset:8192
    v_add_f32_dpp v206, v206, v206 quad_perm:[1,0,3,2] row_mask:0xf bank_mask:0xf
    v_mfma_f32_16x16x32_bf16 v[80:83], v[60:63], v[182:185], v[80:83]
    v_add_f32_dpp v207, v207, v207 quad_perm:[1,0,3,2] row_mask:0xf bank_mask:0xf
    v_add_f32_dpp v208, v208, v208 quad_perm:[1,0,3,2] row_mask:0xf bank_mask:0xf
    v_mfma_f32_16x16x32_bf16 v[84:87], v[60:63], v[186:189], v[84:87]
    ds_read_b128 v[60:63], v4 offset:9216
    s_nop 0
    s_waitcnt lgkmcnt(3)
    v_mfma_f32_16x16x32_bf16 v[64:67], v[40:43], v[190:193], v[64:67]
    v_add_f32_dpp v209, v209, v209 quad_perm:[1,0,3,2] row_mask:0xf bank_mask:0xf
    v_add_f32_dpp v210, v210, v210 quad_perm:[1,0,3,2] row_mask:0xf bank_mask:0xf
    v_mfma_f32_16x16x32_bf16 v[68:71], v[40:43], v[194:197], v[68:71]
    v_add_f32_dpp v211, v211, v211 quad_perm:[1,0,3,2] row_mask:0xf bank_mask:0xf
    v_add_f32_dpp v212, v212, v212 quad_perm:[1,0,3,2] row_mask:0xf bank_mask:0xf
    v_mfma_f32_16x16x32_bf16 v[72:75], v[44:47], v[190:193], v[72:75]
    v_add_f32_dpp v213, v213, v213 quad_perm:[1,0,3,2] row_mask:0xf bank_mask:0xf
    v_add_f32_dpp v214, v214, v214 quad_perm:[1,0,3,2] row_mask:0xf bank_mask:0xf
    v_mfma_f32_16x16x32_bf16 v[76:79], v[44:47], v[194:197], v[76:79]
    v_add_f32_dpp v215, v215, v215 quad_perm:[1,0,3,2] row_mask:0xf bank_mask:0xf
    v_add_f32_dpp v216, v216, v216 quad_perm:[1,0,3,2] row_mask:0xf bank_mask:0xf
    v_mfma_f32_16x16x32_bf16 v[80:83], v[48:51], v[190:193], v[80:83]
    v_add_f32_dpp v217, v217, v217 quad_perm:[1,0,3,2] row_mask:0xf bank_mask:0xf
    v_mfma_f32_16x16x32_bf16 v[84:87], v[48:51], v[194:197], v[84:87]
    s_waitcnt lgkmcnt(0)
    v_mfma_f32_16x16x32_bf16 v[64:67], v[52:55], v[198:201], v[64:67]
    v_mfma_f32_16x16x32_bf16 v[68:71], v[52:55], v[202:205], v[68:71]
    v_mfma_f32_16x16x32_bf16 v[72:75], v[56:59], v[198:201], v[72:75]
    v_mfma_f32_16x16x32_bf16 v[76:79], v[56:59], v[202:205], v[76:79]
    v_mfma_f32_16x16x32_bf16 v[80:83], v[60:63], v[198:201], v[80:83]
    s_nop 0
    v_mfma_f32_16x16x32_bf16 v[84:87], v[60:63], v[202:205], v[84:87]
    s_lshl_b32 s25, s71, 8
    s_lshr_b32 s88, s70, 2
    s_mul_i32 s88, s88, 4096
    s_add_u32 s25, s25, s88
    v_lshlrev_b32 v7, 12, v0
    s_add_u32 s25, s25, 5971968
    s_lshl_b32 s28, s34, 1
    s_and_b32 s30, s71, 1
    s_add_u32 s28, s28, s30
    s_lshl_b32 s28, s28, 3
    s_and_b32 s30, s70, 7
    s_add_u32 s28, s28, s30
    s_lshl_b32 s28, s28, 4
    s_add_u32 s28, s28, 5971968
    v_add_u32 v9, s84, v2
    s_sub_u32 s75, s75, 1024
    ds_read_b128 a[192:195], v12 offset:0
    ds_read_b128 a[196:199], v12 offset:2048
    ds_read_b128 a[200:203], v13 offset:0
    ds_read_b128 a[204:207], v13 offset:2048
    ds_read_b128 a[208:211], v12 offset:4096
    ds_read_b128 a[212:215], v12 offset:6144
    ds_read_b128 a[216:219], v13 offset:4096
    ds_read_b128 a[220:223], v13 offset:6144
    ds_read_b128 a[224:227], v12 offset:8192
    ds_read_b128 a[228:231], v12 offset:10240
    ds_read_b128 a[232:235], v13 offset:8192
    ds_read_b128 a[236:239], v13 offset:10240
    s_waitcnt vmcnt(3)
    ds_read_b128 a[240:243], v12 offset:12288
    ds_read_b128 a[244:247], v12 offset:14336
    ds_read_b128 a[248:251], v13 offset:12288
    ds_read_b128 a[252:255], v13 offset:14336
    s_waitcnt vmcnt(0)
    s_barrier
    s_cmp_lg_u32 s20, 0
    s_cbranch_scc1 L_f3
    s_mov_b64 exec, 15
    buffer_store_dword v0, v7, s[8:11], s28 offen sc1
    s_mov_b64 exec, -1
L_f3:
    s_waitcnt lgkmcnt(0)
    v_pk_mul_f32 v[80:81], v[80:81], v[218:219] op_sel:[0,0] op_sel_hi:[1,0]
    v_pk_mul_f32 v[82:83], v[82:83], v[218:219] op_sel:[0,0] op_sel_hi:[1,0]
    v_pk_mul_f32 v[84:85], v[84:85], v[218:219] op_sel:[0,1] op_sel_hi:[1,1]
    v_pk_mul_f32 v[86:87], v[86:87], v[218:219] op_sel:[0,1] op_sel_hi:[1,1]
    v_pk_fma_f32 v[80:81], v[214:215], v[220:221], v[80:81] op_sel:[0,0,0] op_sel_hi:[1,0,1] neg_lo:[1,0,0] neg_hi:[1,0,0]
    v_pk_fma_f32 v[82:83], v[216:217], v[220:221], v[82:83] op_sel:[0,0,0] op_sel_hi:[1,0,1] neg_lo:[1,0,0] neg_hi:[1,0,0]
    v_pk_fma_f32 v[84:85], v[214:215], v[220:221], v[84:85] op_sel:[0,1,0] op_sel_hi:[1,1,1] neg_lo:[1,0,0] neg_hi:[1,0,0]
    v_pk_fma_f32 v[86:87], v[216:217], v[220:221], v[86:87] op_sel:[0,1,0] op_sel_hi:[1,1,1] neg_lo:[1,0,0] neg_hi:[1,0,0]
    v_pk_mul_f32 v[52:53], v[80:81], v[80:81]
    v_pk_mul_f32 v[54:55], v[82:83], v[82:83]
    v_pk_mul_f32 v[56:57], v[84:85], v[84:85]
    v_pk_mul_f32 v[58:59], v[86:87], v[86:87]
    v_pk_fma_f32 v[52:53], v[52:53], v[14:15], v[14:15] op_sel:[0,1,0] op_sel_hi:[1,1,0]
    v_pk_fma_f32 v[54:55], v[54:55], v[14:15], v[14:15] op_sel:[0,1,0] op_sel_hi:[1,1,0]
    v_pk_fma_f32 v[56:57], v[56:57], v[14:15], v[14:15] op_sel:[0,1,0] op_sel_hi:[1,1,0]
    v_pk_fma_f32 v[58:59], v[58:59], v[14:15], v[14:15] op_sel:[0,1,0] op_sel_hi:[1,1,0]
    v_pk_mul_f32 v[52:53], v[52:53], v[80:81]
    v_pk_mul_f32 v[54:55], v[54:55], v[82:83]
    v_pk_mul_f32 v[56:57], v[56:57], v[84:85]
    v_pk_mul_f32 v[58:59], v[58:59], v[86:87]
    s_add_u32 m0, s75, 0
    v_add_u32 v10, 0, v9
    buffer_load_dwordx4 v10, s[8:11], 0 offen offset:0 sc1 lds
    v_exp_f32 v52, v52
    v_exp_f32 v53, v53
    v_exp_f32 v54, v54
    v_exp_f32 v55, v55
    v_exp_f32 v56, v56
    v_exp_f32 v57, v57
    v_exp_f32 v58, v58
    v_exp_f32 v59, v59
    buffer_load_dwordx4 v10, s[8:11], 0 offen offset:1024 sc1 lds
    v_pk_add_f32 v[52:53], v[52:53], 1.0 op_sel_hi:[1,0]
    v_pk_add_f32 v[54:55], v[54:55], 1.0 op_sel_hi:[1,0]
    v_pk_add_f32 v[56:57], v[56:57], 1.0 op_sel_hi:[1,0]
    v_pk_add_f32 v[58:59], v[58:59], 1.0 op_sel_hi:[1,0]
    v_rcp_f32 v52, v52
    v_rcp_f32 v53, v53
    v_rcp_f32 v54, v54
    v_rcp_f32 v55, v55
    v_rcp_f32 v56, v56
    v_rcp_f32 v57, v57
    v_rcp_f32 v58, v58
    v_rcp_f32 v59, v59
    buffer_load_dwordx4 v10, s[8:11], 0 offen offset:2048 sc1 lds
    v_pk_mul_f32 v[80:81], v[80:81], v[52:53]
    v_pk_mul_f32 v[82:83], v[82:83], v[54:55]
    v_pk_mul_f32 v[84:85], v[84:85], v[56:57]
    v_pk_mul_f32 v[86:87], v[86:87], v[58:59]
    v_cvt_pk_bf16_f32 v87, v86, v87
    v_cvt_pk_bf16_f32 v86, v84, v85
    v_cvt_pk_bf16_f32 v85, v82, v83
    v_cvt_pk_bf16_f32 v84, v80, v81
    buffer_load_dwordx4 v10, s[8:11], 0 offen offset:3072 sc1 lds
    v_lshlrev_b32_e64 v16, 16, v91
    v_mov_b32 v17, v16
    v_mov_b32 v18, v16
    v_mov_b32 v19, v16
    v_mov_b32 v20, v16
    v_mov_b32 v21, v16
    v_mov_b32 v22, v16
    s_add_u32 m0, s75, 4096
    v_add_u32 v10, 4096, v9
    buffer_load_dwordx4 v10, s[8:11], 0 offen offset:0 sc1 lds
    v_mov_b32 v23, v16
    v_mov_b32 v24, v16
    v_mov_b32 v25, v16
    v_mov_b32 v26, v16
    v_mov_b32_e64 v27, v16
    v_and_b32 v28, 0xffff0000, v91
    v_mov_b32 v29, v28
    v_mov_b32 v30, v28
    buffer_load_dwordx4 v10, s[8:11], 0 offen offset:1024 sc1 lds
    v_mov_b32 v31, v28
    v_mov_b32 v32, v28
    v_mov_b32 v33, v28
    v_mov_b32 v34, v28
    v_mov_b32 v35, v28
    v_mov_b32 v36, v28
    v_mov_b32 v37, v28
    v_mov_b32 v38, v28
    buffer_load_dwordx4 v10, s[8:11], 0 offen offset:2048 sc1 lds
    v_mov_b32_e64 v39, v28
    v_lshl_add_u32 v7, v5, 4, s25
    s_xor_b32 s28, s28, 128
    s_add_u32 s28, s28, s88
    v_mov_b32 v89, s28
    v_cmp_gt_u32_e64 vcc, 16, v0
    s_mul_i32 s27, s20, 3072
    s_mul_i32 s26, s71, 196608
    buffer_load_dwordx4 v10, s[8:11], 0 offen offset:3072 sc1 lds
    s_add_u32 s26, s26, s27
    s_add_u32 s26, s26, 6291456
    s_add_u32 s27, s27, 73728
    v_cndmask_b32 v7, v89, v7, vcc
    s_mul_i32 s30, s78, 49152
    s_lshr_b32 s31, s71, 1
    s_mul_i32 s31, s31, 3072
    s_add_u32 s30, s30, s31
    s_add_u32 m0, s75, 8192
    v_add_u32 v10, 8192, v9
    buffer_load_dwordx4 v10, s[8:11], 0 offen offset:0 sc1 lds
    s_add_u32 s30, s30, 9437184
    s_and_b32 s32, s71, 1
    s_lshl_b32 s31, s32, 9
    s_add_u32 s31, s31, s30
    s_add_u32 s31, s31, 1024
    s_lshl_b32 s32, s32, 11
    s_add_u32 s30, s30, s32
    s_add_u32 s32, s30, 24576
    buffer_load_dwordx4 v10, s[8:11], 0 offen offset:1024 sc1 lds
    v_and_b32 v88, 1, v6
    v_mul_u32_u24 v88, 24576, v88
    v_lshrrev_b32_e64 v89, 1, v6
    v_lshl_add_u32 v88, v89, 8, v88
    v_lshl_add_u32 v88, v5, 4, v88
    v_lshlrev_b32 v12, 14, v0
    s_lshl_b32 s28, s85, 4
    s_add_u32 s28, s28, 6012928
    s_mov_b64 exec, 0
    s_cmp_eq_u32 s20, 1
    s_cbranch_scc1 L_pg6
    s_cmp_eq_u32 s20, 2
    s_cbranch_scc1 L_pg7
L_w3:
    s_mov_b64 exec, -1
    s_cmp_lg_u32 s20, 0
    s_cbranch_scc1 S3_d
    buffer_load_dword v89, v7, s[8:11], 0 offen sc1
    s_waitcnt vmcnt(0)
    v_cmp_eq_u32 vcc, -1, v89
    s_cbranch_vccnz S3_r
S3_d:
    s_barrier
    s_add_u32 m0, s27, 0
    v_add_u32 v13, s26, v2
    buffer_load_dwordx4 v13, s[8:11], 0 offen offset:0 sc1 lds
    buffer_load_dwordx4 v13, s[8:11], 0 offen offset:1024 sc1 lds
    buffer_load_dwordx4 v13, s[8:11], 0 offen offset:2048 sc1 lds
    s_add_u32 m0, s27, 12288
    v_add_u32 v13, 12288, v13
    buffer_load_dwordx4 v13, s[8:11], 0 offen offset:0 sc1 lds
    v_pk_mul_f32 v[72:73], v[72:73], v[218:219] op_sel:[0,0] op_sel_hi:[1,0]
    v_pk_mul_f32 v[74:75], v[74:75], v[218:219] op_sel:[0,0] op_sel_hi:[1,0]
    v_pk_mul_f32 v[76:77], v[76:77], v[218:219] op_sel:[0,1] op_sel_hi:[1,1]
    v_pk_mul_f32 v[78:79], v[78:79], v[218:219] op_sel:[0,1] op_sel_hi:[1,1]
    v_pk_fma_f32 v[72:73], v[210:211], v[220:221], v[72:73] op_sel:[0,0,0] op_sel_hi:[1,0,1] neg_lo:[1,0,0] neg_hi:[1,0,0]
    v_pk_fma_f32 v[74:75], v[212:213], v[220:221], v[74:75] op_sel:[0,0,0] op_sel_hi:[1,0,1] neg_lo:[1,0,0] neg_hi:[1,0,0]
    v_pk_fma_f32 v[76:77], v[210:211], v[220:221], v[76:77] op_sel:[0,1,0] op_sel_hi:[1,1,1] neg_lo:[1,0,0] neg_hi:[1,0,0]
    v_pk_fma_f32 v[78:79], v[212:213], v[220:221], v[78:79] op_sel:[0,1,0] op_sel_hi:[1,1,1] neg_lo:[1,0,0] neg_hi:[1,0,0]
    v_pk_mul_f32 v[52:53], v[72:73], v[72:73]
    v_pk_mul_f32 v[54:55], v[74:75], v[74:75]
    v_pk_mul_f32 v[56:57], v[76:77], v[76:77]
    v_pk_mul_f32 v[58:59], v[78:79], v[78:79]
    v_pk_fma_f32 v[52:53], v[52:53], v[14:15], v[14:15] op_sel:[0,1,0] op_sel_hi:[1,1,0]
    v_pk_fma_f32 v[54:55], v[54:55], v[14:15], v[14:15] op_sel:[0,1,0] op_sel_hi:[1,1,0]
    v_pk_fma_f32 v[56:57], v[56:57], v[14:15], v[14:15] op_sel:[0,1,0] op_sel_hi:[1,1,0]
    v_pk_fma_f32 v[58:59], v[58:59], v[14:15], v[14:15] op_sel:[0,1,0] op_sel_hi:[1,1,0]
    v_pk_mul_f32 v[52:53], v[52:53], v[72:73]
    v_pk_mul_f32 v[54:55], v[54:55], v[74:75]
    v_pk_mul_f32 v[56:57], v[56:57], v[76:77]
    v_pk_mul_f32 v[58:59], v[58:59], v[78:79]
    buffer_load_dwordx4 v13, s[8:11], 0 offen offset:1024 sc1 lds
    v_exp_f32 v52, v52
    v_exp_f32 v53, v53
    v_exp_f32 v54, v54
    v_exp_f32 v55, v55
    v_exp_f32 v56, v56
    v_exp_f32 v57, v57
    v_exp_f32 v58, v58
    v_exp_f32 v59, v59
    buffer_load_dwordx4 v13, s[8:11], 0 offen offset:2048 sc1 lds
    v_pk_add_f32 v[52:53], v[52:53], 1.0 op_sel_hi:[1,0]
    v_pk_add_f32 v[54:55], v[54:55], 1.0 op_sel_hi:[1,0]
    v_pk_add_f32 v[56:57], v[56:57], 1.0 op_sel_hi:[1,0]
    v_pk_add_f32 v[58:59], v[58:59], 1.0 op_sel_hi:[1,0]
    v_rcp_f32 v52, v52
    v_rcp_f32 v53, v53
    v_rcp_f32 v54, v54
    v_rcp_f32 v55, v55
    v_rcp_f32 v56, v56
    v_rcp_f32 v57, v57
    v_rcp_f32 v58, v58
    v_rcp_f32 v59, v59
    s_add_u32 m0, s27, 24576
    v_add_u32 v13, 12288, v13
    buffer_load_dwordx4 v13, s[8:11], 0 offen offset:0 sc1 lds
    v_pk_mul_f32 v[72:73], v[72:73], v[52:53]
    v_pk_mul_f32 v[74:75], v[74:75], v[54:55]
    v_pk_mul_f32 v[76:77], v[76:77], v[56:57]
    v_pk_mul_f32 v[78:79], v[78:79], v[58:59]
    v_cvt_pk_bf16_f32 v83, v78, v79
    v_cvt_pk_bf16_f32 v82, v76, v77
    v_cvt_pk_bf16_f32 v81, v74, v75
    v_cvt_pk_bf16_f32 v80, v72, v73
    buffer_load_dwordx4 v13, s[8:11], 0 offen offset:1024 sc1 lds
    v_pk_mul_f32 v[64:65], v[64:65], v[218:219] op_sel:[0,0] op_sel_hi:[1,0]
    v_pk_mul_f32 v[66:67], v[66:67], v[218:219] op_sel:[0,0] op_sel_hi:[1,0]
    v_pk_mul_f32 v[68:69], v[68:69], v[218:219] op_sel:[0,1] op_sel_hi:[1,1]
    v_pk_mul_f32 v[70:71], v[70:71], v[218:219] op_sel:[0,1] op_sel_hi:[1,1]
    v_pk_fma_f32 v[64:65], v[206:207], v[220:221], v[64:65] op_sel:[0,0,0] op_sel_hi:[1,0,1] neg_lo:[1,0,0] neg_hi:[1,0,0]
    v_pk_fma_f32 v[66:67], v[208:209], v[220:221], v[66:67] op_sel:[0,0,0] op_sel_hi:[1,0,1] neg_lo:[1,0,0] neg_hi:[1,0,0]
    v_pk_fma_f32 v[68:69], v[206:207], v[220:221], v[68:69] op_sel:[0,1,0] op_sel_hi:[1,1,1] neg_lo:[1,0,0] neg_hi:[1,0,0]
    v_pk_fma_f32 v[70:71], v[208:209], v[220:221], v[70:71] op_sel:[0,1,0] op_sel_hi:[1,1,1] neg_lo:[1,0,0] neg_hi:[1,0,0]
    v_pk_mul_f32 v[52:53], v[64:65], v[64:65]
    v_pk_mul_f32 v[54:55], v[66:67], v[66:67]
    v_pk_mul_f32 v[56:57], v[68:69], v[68:69]
    v_pk_mul_f32 v[58:59], v[70:71], v[70:71]
    v_pk_fma_f32 v[52:53], v[52:53], v[14:15], v[14:15] op_sel:[0,1,0] op_sel_hi:[1,1,0]
    v_pk_fma_f32 v[54:55], v[54:55], v[14:15], v[14:15] op_sel:[0,1,0] op_sel_hi:[1,1,0]
    v_pk_fma_f32 v[56:57], v[56:57], v[14:15], v[14:15] op_sel:[0,1,0] op_sel_hi:[1,1,0]
    v_pk_fma_f32 v[58:59], v[58:59], v[14:15], v[14:15] op_sel:[0,1,0] op_sel_hi:[1,1,0]
    v_pk_mul_f32 v[52:53], v[52:53], v[64:65]
    v_pk_mul_f32 v[54:55], v[54:55], v[66:67]
    v_pk_mul_f32 v[56:57], v[56:57], v[68:69]
    v_pk_mul_f32 v[58:59], v[58:59], v[70:71]
    buffer_load_dwordx4 v13, s[8:11], 0 offen offset:2048 sc1 lds
    v_exp_f32 v52, v52
    v_exp_f32 v53, v53
    v_exp_f32 v54, v54
    v_exp_f32 v55, v55
    v_exp_f32 v56, v56
    v_exp_f32 v57, v57
    v_exp_f32 v58, v58
    v_exp_f32 v59, v59
    s_add_u32 m0, s27, 36864
    v_add_u32 v13, 12288, v13
    buffer_load_dwordx4 v13, s[8:11], 0 offen offset:0 sc1 lds
    v_pk_add_f32 v[52:53], v[52:53], 1.0 op_sel_hi:[1,0]
    v_pk_add_f32 v[54:55], v[54:55], 1.0 op_sel_hi:[1,0]
    v_pk_add_f32 v[56:57], v[56:57], 1.0 op_sel_hi:[1,0]
    v_pk_add_f32 v[58:59], v[58:59], 1.0 op_sel_hi:[1,0]
    v_rcp_f32 v52, v52
    v_rcp_f32 v53, v53
    v_rcp_f32 v54, v54
    v_rcp_f32 v55, v55
    v_rcp_f32 v56, v56
    v_rcp_f32 v57, v57
    v_rcp_f32 v58, v58
    v_rcp_f32 v59, v59
    buffer_load_dwordx4 v13, s[8:11], 0 offen offset:1024 sc1 lds
    v_pk_mul_f32 v[64:65], v[64:65], v[52:53]
    v_pk_mul_f32 v[66:67], v[66:67], v[54:55]
    v_pk_mul_f32 v[68:69], v[68:69], v[56:57]
    v_pk_mul_f32 v[70:71], v[70:71], v[58:59]
    v_cvt_pk_bf16_f32 v79, v70, v71
    v_cvt_pk_bf16_f32 v78, v68, v69
    v_cvt_pk_bf16_f32 v77, v66, v67
    v_cvt_pk_bf16_f32 v76, v64, v65
    buffer_load_dwordx4 v13, s[8:11], 0 offen offset:2048 sc1 lds
    s_waitcnt vmcnt(9)
    s_barrier
    ds_read_b128 v[40:43], v3 offset:8192
    ds_read_b128 v[44:47], v3 offset:9216
    ds_read_b128 v[48:51], v3 offset:10240
    ds_read_b128 v[52:55], v3 offset:11264
    ds_read_b128 v[56:59], v3 offset:12288
    ds_read_b128 v[60:63], v3 offset:13312
    s_waitcnt lgkmcnt(5)
    v_mfma_f32_16x16x32_bf16 v[96:99], v[40:43], a[0:3], 0
    ds_read_b128 v[64:67], v3 offset:14336
    s_add_u32 m0, s27, 49152
    v_mfma_f32_16x16x32_bf16 v[108:111], v[40:43], a[4:7], 0
    ds_read_b128 v[68:71], v3 offset:15360
    v_add_u32 v13, 12288, v13
    s_waitcnt lgkmcnt(6)
    v_mfma_f32_16x16x32_bf16 v[100:103], v[44:47], a[0:3], 0
    ds_read_b128 v[72:75], v3 offset:16384
    buffer_load_dwordx4 v13, s[8:11], 0 offen offset:0 sc1 lds
    v_mfma_f32_16x16x32_bf16 v[112:115], v[44:47], a[4:7], 0
    s_waitcnt lgkmcnt(6)
    v_mfma_f32_16x16x32_bf16 v[96:99], v[48:51], a[8:11], v[96:99]
    v_mfma_f32_16x16x32_bf16 v[108:111], v[48:51], a[12:15], v[108:111]
    s_waitcnt lgkmcnt(3)
    v_mfma_f32_16x16x32_bf16 v[100:103], v[52:55], a[8:11], v[100:103]
    ds_read_b128 v[40:43], v3 offset:17408
    buffer_load_dwordx4 v13, s[8:11], 0 offen offset:1024 sc1 lds
    v_mfma_f32_16x16x32_bf16 v[112:115], v[52:55], a[12:15], v[112:115]
    ds_read_b128 v[44:47], v3 offset:18432
    v_mfma_f32_16x16x32_bf16 v[96:99], v[56:59], a[16:19], v[96:99]
    ds_read_b128 v[48:51], v3 offset:19456
    v_mfma_f32_16x16x32_bf16 v[108:111], v[56:59], a[20:23], v[108:111]
    buffer_load_dwordx4 v13, s[8:11], 0 offen offset:2048 sc1 lds
    v_mfma_f32_16x16x32_bf16 v[100:103], v[60:63], a[16:19], v[100:103]
    s_waitcnt vmcnt(9)
    s_nop 0
    v_mfma_f32_16x16x32_bf16 v[112:115], v[60:63], a[20:23], v[112:115]
    s_barrier
    s_waitcnt lgkmcnt(3)
    v_mfma_f32_16x16x32_bf16 v[96:99], v[64:67], a[24:27], v[96:99]
    ds_read_b128 v[52:55], v3 offset:20480
    s_add_u32 m0, s27, 61440
    v_mfma_f32_16x16x32_bf16 v[108:111], v[64:67], a[28:31], v[108:111]
    ds_read_b128 v[56:59], v3 offset:21504
    v_add_u32 v13, 12288, v13
    v_mfma_f32_16x16x32_bf16 v[100:103], v[68:71], a[24:27], v[100:103]
    ds_read_b128 v[60:63], v3 offset:22528
    buffer_load_dwordx4 v13, s[8:11], 0 offen offset:0 sc1 lds
    v_mfma_f32_16x16x32_bf16 v[112:115], v[68:71], a[28:31], v[112:115]
    v_lshlrev_b32_e64 v144, 16, v76
    v_and_b32 v145, 0xffff0000, v76
    v_mfma_f32_16x16x32_bf16 v[96:99], v[72:75], a[32:35], v[96:99]
    v_lshlrev_b32_e64 v146, 16, v77
    v_and_b32 v147, 0xffff0000, v77
    v_mfma_f32_16x16x32_bf16 v[108:111], v[72:75], a[36:39], v[108:111]
    v_lshlrev_b32 v148, 16, v78
    s_waitcnt lgkmcnt(3)
    v_mfma_f32_16x16x32_bf16 v[100:103], v[40:43], a[32:35], v[100:103]
    ds_read_b128 v[64:67], v3 offset:23552
    buffer_load_dwordx4 v13, s[8:11], 0 offen offset:1024 sc1 lds
    v_mfma_f32_16x16x32_bf16 v[112:115], v[40:43], a[36:39], v[112:115]
    ds_read_b128 v[68:71], v3 offset:24576
    v_and_b32 v149, 0xffff0000, v78
    v_mfma_f32_16x16x32_bf16 v[96:99], v[44:47], a[40:43], v[96:99]
    ds_read_b128 v[72:75], v3 offset:25600
    v_lshlrev_b32_e64 v150, 16, v79
    v_mfma_f32_16x16x32_bf16 v[108:111], v[44:47], a[44:47], v[108:111]
    buffer_load_dwordx4 v13, s[8:11], 0 offen offset:2048 sc1 lds
    v_and_b32 v151, 0xffff0000, v79
    v_mfma_f32_16x16x32_bf16 v[100:103], v[48:51], a[40:43], v[100:103]
    v_lshlrev_b32_e64 v152, 16, v80
    v_and_b32 v153, 0xffff0000, v80
    v_mfma_f32_16x16x32_bf16 v[112:115], v[48:51], a[44:47], v[112:115]
    v_lshlrev_b32 v154, 16, v81
    s_waitcnt lgkmcnt(3)
    v_mfma_f32_16x16x32_bf16 v[96:99], v[52:55], a[48:51], v[96:99]
    ds_read_b128 v[40:43], v3 offset:26624
    s_add_u32 m0, s27, 73728
    v_mfma_f32_16x16x32_bf16 v[108:111], v[52:55], a[52:55], v[108:111]
    ds_read_b128 v[44:47], v3 offset:27648
    v_add_u32 v13, 12288, v13
    v_mfma_f32_16x16x32_bf16 v[100:103], v[56:59], a[48:51], v[100:103]
    ds_read_b128 v[48:51], v3 offset:28672
    buffer_load_dwordx4 v13, s[8:11], 0 offen offset:0 sc1 lds
    v_mfma_f32_16x16x32_bf16 v[112:115], v[56:59], a[52:55], v[112:115]
    v_and_b32 v155, 0xffff0000, v81
    v_lshlrev_b32_e64 v156, 16, v82
    v_mfma_f32_16x16x32_bf16 v[96:99], v[60:63], a[56:59], v[96:99]
    v_and_b32 v157, 0xffff0000, v82
    v_lshlrev_b32 v158, 16, v83
    v_mfma_f32_16x16x32_bf16 v[108:111], v[60:63], a[60:63], v[108:111]
    v_and_b32 v159, 0xffff0000, v83
    s_waitcnt lgkmcnt(3)
    v_mfma_f32_16x16x32_bf16 v[100:103], v[64:67], a[56:59], v[100:103]
    ds_read_b128 v[52:55], v3 offset:29696
    buffer_load_dwordx4 v13, s[8:11], 0 offen offset:1024 sc1 lds
    v_mfma_f32_16x16x32_bf16 v[112:115], v[64:67], a[60:63], v[112:115]
    ds_read_b128 v[56:59], v3 offset:30720
    v_lshlrev_b32_e64 v160, 16, v84
    v_mfma_f32_16x16x32_bf16 v[96:99], v[68:71], a[64:67], v[96:99]
    ds_read_b128 v[60:63], v3 offset:31744
    v_and_b32 v161, 0xffff0000, v84
    v_mfma_f32_16x16x32_bf16 v[108:111], v[68:71], a[68:71], v[108:111]
    buffer_load_dwordx4 v13, s[8:11], 0 offen offset:2048 sc1 lds
    v_lshlrev_b32_e64 v162, 16, v85
    v_mfma_f32_16x16x32_bf16 v[100:103], v[72:75], a[64:67], v[100:103]
    s_waitcnt vmcnt(12)
    v_and_b32 v163, 0xffff0000, v85
    v_mfma_f32_16x16x32_bf16 v[112:115], v[72:75], a[68:71], v[112:115]
    s_barrier
    s_waitcnt lgkmcnt(3)
    v_mfma_f32_16x16x32_bf16 v[96:99], v[40:43], a[72:75], v[96:99]
    ds_read_b128 v[64:67], v3 offset:32768
    s_add_u32 m0, s27, 0
    v_mfma_f32_16x16x32_bf16 v[108:111], v[40:43], a[76:79], v[108:111]
    ds_read_b128 v[68:71], v3 offset:33792
    v_add_u32 v13, 12288, v13
    v_mfma_f32_16x16x32_bf16 v[100:103], v[44:47], a[72:75], v[100:103]
    ds_read_b128 v[72:75], v3 offset:34816
    buffer_load_dwordx4 v13, s[8:11], 0 offen offset:0 sc1 lds
    v_mfma_f32_16x16x32_bf16 v[112:115], v[44:47], a[76:79], v[112:115]
    v_lshlrev_b32_e64 v164, 16, v86
    v_and_b32 v165, 0xffff0000, v86
    v_mfma_f32_16x16x32_bf16 v[96:99], v[48:51], a[80:83], v[96:99]
    v_lshlrev_b32_e64 v166, 16, v87
    v_and_b32 v167, 0xffff0000, v87
    v_mfma_f32_16x16x32_bf16 v[108:111], v[48:51], a[84:87], v[108:111]
    s_waitcnt lgkmcnt(3)
    s_nop 0
    v_mfma_f32_16x16x32_bf16 v[100:103], v[52:55], a[80:83], v[100:103]
    ds_read_b128 v[40:43], v3 offset:35840
    buffer_load_dwordx4 v13, s[8:11], 0 offen offset:1024 sc1 lds
    v_mfma_f32_16x16x32_bf16 v[112:115], v[52:55], a[84:87], v[112:115]
    ds_read_b128 v[44:47], v3 offset:36864
    s_nop 0
    v_mfma_f32_16x16x32_bf16 v[96:99], v[56:59], a[88:91], v[96:99]
    ds_read_b128 v[48:51], v3 offset:37888
    v_mfma_f32_16x16x32_bf16 v[108:111], v[56:59], a[92:95], v[108:111]
    buffer_load_dwordx4 v13, s[8:11], 0 offen offset:2048 sc1 lds
    v_mfma_f32_16x16x32_bf16 v[100:103], v[60:63], a[88:91], v[100:103]
    v_mfma_f32_16x16x32_bf16 v[112:115], v[60:63], a[92:95], v[112:115]
    s_waitcnt lgkmcnt(3)
    v_mfma_f32_16x16x32_bf16 v[96:99], v[64:67], a[96:99], v[96:99]
    ds_read_b128 v[52:55], v3 offset:38912
    s_add_u32 m0, s75, 10240
    v_mfma_f32_16x16x32_bf16 v[108:111], v[64:67], a[100:103], v[108:111]
    ds_read_b128 v[56:59], v3 offset:39936
    v_add_u32 v10, 10240, v9
    v_mfma_f32_16x16x32_bf16 v[100:103], v[68:71], a[96:99], v[100:103]
    ds_read_b128 v[60:63], v3 offset:40960
    buffer_load_dwordx4 v10, s[8:11], 0 offen offset:0 sc1 lds
    v_mfma_f32_16x16x32_bf16 v[112:115], v[68:71], a[100:103], v[112:115]
    v_mfma_f32_16x16x32_bf16 v[96:99], v[72:75], a[104:107], v[96:99]
    v_mfma_f32_16x16x32_bf16 v[108:111], v[72:75], a[108:111], v[108:111]
    s_waitcnt lgkmcnt(3)
    s_nop 0
    v_mfma_f32_16x16x32_bf16 v[100:103], v[40:43], a[104:107], v[100:103]
    ds_read_b128 v[64:67], v3 offset:41984
    buffer_load_dwordx4 v10, s[8:11], 0 offen offset:1024 sc1 lds
    v_mfma_f32_16x16x32_bf16 v[112:115], v[40:43], a[108:111], v[112:115]
    ds_read_b128 v[68:71], v3 offset:43008
    s_nop 0
    v_mfma_f32_16x16x32_bf16 v[96:99], v[44:47], a[112:115], v[96:99]
    ds_read_b128 v[72:75], v3 offset:44032
    v_mfma_f32_16x16x32_bf16 v[108:111], v[44:47], a[116:119], v[108:111]
    v_mfma_f32_16x16x32_bf16 v[100:103], v[48:51], a[112:115], v[100:103]
    s_waitcnt vmcnt(14)
    v_mfma_f32_16x16x32_bf16 v[112:115], v[48:51], a[116:119], v[112:115]
    s_barrier
    s_waitcnt lgkmcnt(3)
    v_mfma_f32_16x16x32_bf16 v[96:99], v[52:55], a[120:123], v[96:99]
    ds_read_b128 v[40:43], v3 offset:45056
    s_add_u32 m0, s27, 12288
    v_mfma_f32_16x16x32_bf16 v[108:111], v[52:55], a[124:127], v[108:111]
    ds_read_b128 v[44:47], v3 offset:46080
    v_add_u32 v13, 12288, v13
    v_mfma_f32_16x16x32_bf16 v[100:103], v[56:59], a[120:123], v[100:103]
    ds_read_b128 v[48:51], v3 offset:47104
    buffer_load_dwordx4 v13, s[8:11], 0 offen offset:0 sc1 lds
    v_mfma_f32_16x16x32_bf16 v[112:115], v[56:59], a[124:127], v[112:115]
    v_mfma_f32_16x16x32_bf16 v[96:99], v[60:63], a[128:131], v[96:99]
    v_mfma_f32_16x16x32_bf16 v[108:111], v[60:63], a[132:135], v[108:111]
    s_waitcnt lgkmcnt(3)
    s_nop 0
    v_mfma_f32_16x16x32_bf16 v[100:103], v[64:67], a[128:131], v[100:103]
    ds_read_b128 v[52:55], v3 offset:48128
    buffer_load_dwordx4 v13, s[8:11], 0 offen offset:1024 sc1 lds
    v_mfma_f32_16x16x32_bf16 v[112:115], v[64:67], a[132:135], v[112:115]
    ds_read_b128 v[56:59], v3 offset:49152
    s_nop 0
    v_mfma_f32_16x16x32_bf16 v[96:99], v[68:71], a[136:139], v[96:99]
    ds_read_b128 v[60:63], v3 offset:50176
    v_mfma_f32_16x16x32_bf16 v[108:111], v[68:71], a[140:143], v[108:111]
    buffer_load_dwordx4 v13, s[8:11], 0 offen offset:2048 sc1 lds
    v_mfma_f32_16x16x32_bf16 v[100:103], v[72:75], a[136:139], v[100:103]
    v_mfma_f32_16x16x32_bf16 v[112:115], v[72:75], a[140:143], v[112:115]
    s_waitcnt lgkmcnt(3)
    v_mfma_f32_16x16x32_bf16 v[96:99], v[40:43], a[144:147], v[96:99]
    ds_read_b128 v[64:67], v3 offset:51200
    s_add_u32 m0, s75, 12288
    v_mfma_f32_16x16x32_bf16 v[108:111], v[40:43], a[148:151], v[108:111]
    ds_read_b128 v[68:71], v3 offset:52224
    v_add_u32 v10, 12288, v9
    v_mfma_f32_16x16x32_bf16 v[100:103], v[44:47], a[144:147], v[100:103]
    ds_read_b128 v[72:75], v3 offset:53248
    buffer_load_dwordx4 v10, s[8:11], 0 offen offset:0 sc1 lds
    v_mfma_f32_16x16x32_bf16 v[112:115], v[44:47], a[148:151], v[112:115]
    v_mfma_f32_16x16x32_bf16 v[96:99], v[48:51], a[152:155], v[96:99]
    v_mfma_f32_16x16x32_bf16 v[108:111], v[48:51], a[156:159], v[108:111]
    s_waitcnt lgkmcnt(3)
    s_nop 0
    v_mfma_f32_16x16x32_bf16 v[100:103], v[52:55], a[152:155], v[100:103]
    ds_read_b128 v[40:43], v3 offset:54272
    buffer_load_dwordx4 v10, s[8:11], 0 offen offset:1024 sc1 lds
    v_mfma_f32_16x16x32_bf16 v[112:115], v[52:55], a[156:159], v[112:115]
    ds_read_b128 v[44:47], v3 offset:55296
    s_nop 0
    v_mfma_f32_16x16x32_bf16 v[96:99], v[56:59], a[160:163], v[96:99]
    ds_read_b128 v[48:51], v3 offset:56320
    v_mfma_f32_16x16x32_bf16 v[108:111], v[56:59], a[164:167], v[108:111]
    v_mfma_f32_16x16x32_bf16 v[100:103], v[60:63], a[160:163], v[100:103]
    s_waitcnt vmcnt(16)
    v_mfma_f32_16x16x32_bf16 v[112:115], v[60:63], a[164:167], v[112:115]
    s_barrier
    s_waitcnt lgkmcnt(3)
    v_mfma_f32_16x16x32_bf16 v[96:99], v[64:67], a[168:171], v[96:99]
    ds_read_b128 v[52:55], v3 offset:57344
    s_add_u32 m0, s27, 24576
    v_mfma_f32_16x16x32_bf16 v[108:111], v[64:67], a[172:175], v[108:111]
    ds_read_b128 v[56:59], v3 offset:58368
    v_add_u32 v13, 12288, v13
    v_mfma_f32_16x16x32_bf16 v[100:103], v[68:71], a[168:171], v[100:103]
    ds_read_b128 v[60:63], v3 offset:59392
    buffer_load_dwordx4 v13, s[8:11], 0 offen offset:0 sc1 lds
    v_mfma_f32_16x16x32_bf16 v[112:115], v[68:71], a[172:175], v[112:115]
    v_mfma_f32_16x16x32_bf16 v[96:99], v[72:75], a[176:179], v[96:99]
    v_mfma_f32_16x16x32_bf16 v[108:111], v[72:75], a[180:183], v[108:111]
    s_waitcnt lgkmcnt(3)
    s_nop 0
    v_mfma_f32_16x16x32_bf16 v[100:103], v[40:43], a[176:179], v[100:103]
    ds_read_b128 v[64:67], v3 offset:60416
    buffer_load_dwordx4 v13, s[8:11], 0 offen offset:1024 sc1 lds
    v_mfma_f32_16x16x32_bf16 v[112:115], v[40:43], a[180:183], v[112:115]
    ds_read_b128 v[68:71], v3 offset:61440
    v_mfma_f32_16x16x32_bf16 v[96:99], v[44:47], a[184:187], v[96:99]
    ds_read_b128 v[72:75], v3 offset:62464
    v_mfma_f32_16x16x32_bf16 v[108:111], v[44:47], a[188:191], v[108:111]
    buffer_load_dwordx4 v13, s[8:11], 0 offen offset:2048 sc1 lds
    v_mfma_f32_16x16x32_bf16 v[100:103], v[48:51], a[184:187], v[100:103]
L_pg6:
    s_cbranch_execz L_w3
    v_mfma_f32_16x16x32_bf16 v[112:115], v[48:51], a[188:191], v[112:115]
    s_waitcnt lgkmcnt(3)
    v_mfma_f32_16x16x32_bf16 v[96:99], v[52:55], a[192:195], v[96:99]
    ds_read_b128 v[40:43], v3 offset:63488
    s_add_u32 m0, s75, 14336
    v_mfma_f32_16x16x32_bf16 v[108:111], v[52:55], a[196:199], v[108:111]
    ds_read_b128 v[44:47], v3 offset:64512
    v_add_u32 v10, 14336, v9
    v_mfma_f32_16x16x32_bf16 v[100:103], v[56:59], a[192:195], v[100:103]
    ds_read_b128 v[48:51], v4 offset:0
    buffer_load_dwordx4 v10, s[8:11], 0 offen offset:0 sc1 lds
    v_mfma_f32_16x16x32_bf16 v[112:115], v[56:59], a[196:199], v[112:115]
    s_nop 0
    v_mfma_f32_16x16x32_bf16 v[96:99], v[60:63], a[200:203], v[96:99]
    v_mfma_f32_16x16x32_bf16 v[108:111], v[60:63], a[204:207], v[108:111]
    s_waitcnt lgkmcnt(3)
    v_mfma_f32_16x16x32_bf16 v[100:103], v[64:67], a[200:203], v[100:103]
    ds_read_b128 v[52:55], v4 offset:1024
    buffer_load_dwordx4 v10, s[8:11], 0 offen offset:1024 sc1 lds
    v_mfma_f32_16x16x32_bf16 v[112:115], v[64:67], a[204:207], v[112:115]
    ds_read_b128 v[56:59], v4 offset:2048
    v_mfma_f32_16x16x32_bf16 v[96:99], v[68:71], a[208:211], v[96:99]
    ds_read_b128 v[60:63], v4 offset:3072
    v_mfma_f32_16x16x32_bf16 v[108:111], v[68:71], a[212:215], v[108:111]
    v_mfma_f32_16x16x32_bf16 v[100:103], v[72:75], a[208:211], v[100:103]
    s_waitcnt vmcnt(18)
    s_nop 0
    v_mfma_f32_16x16x32_bf16 v[112:115], v[72:75], a[212:215], v[112:115]
    s_barrier
    s_waitcnt lgkmcnt(3)
    v_mfma_f32_16x16x32_bf16 v[96:99], v[40:43], a[216:219], v[96:99]
    ds_read_b128 v[64:67], v4 offset:4096
    s_add_u32 m0, s27, 36864
    v_mfma_f32_16x16x32_bf16 v[108:111], v[40:43], a[220:223], v[108:111]
    ds_read_b128 v[68:71], v4 offset:5120
    v_add_u32 v13, 12288, v13
    v_mfma_f32_16x16x32_bf16 v[100:103], v[44:47], a[216:219], v[100:103]
    ds_read_b128 v[72:75], v4 offset:6144
    buffer_load_dwordx4 v13, s[8:11], 0 offen offset:0 sc1 lds
    v_mfma_f32_16x16x32_bf16 v[112:115], v[44:47], a[220:223], v[112:115]
    s_nop 0
    v_mfma_f32_16x16x32_bf16 v[96:99], v[48:51], a[224:227], v[96:99]
    v_mfma_f32_16x16x32_bf16 v[108:111], v[48:51], a[228:231], v[108:111]
    s_waitcnt lgkmcnt(3)
    v_mfma_f32_16x16x32_bf16 v[100:103], v[52:55], a[224:227], v[100:103]
    ds_read_b128 v[40:43], v4 offset:7168
    buffer_load_dwordx4 v13, s[8:11], 0 offen offset:1024 sc1 lds
    v_mfma_f32_16x16x32_bf16 v[112:115], v[52:55], a[228:231], v[112:115]
    ds_read_b128 v[44:47], v4 offset:8192
    v_mfma_f32_16x16x32_bf16 v[96:99], v[56:59], a[232:235], v[96:99]
    ds_read_b128 v[48:51], v4 offset:9216
    v_mfma_f32_16x16x32_bf16 v[108:111], v[56:59], a[236:239], v[108:111]
    buffer_load_dwordx4 v13, s[8:11], 0 offen offset:2048 sc1 lds
    v_mfma_f32_16x16x32_bf16 v[100:103], v[60:63], a[232:235], v[100:103]
    v_mfma_f32_16x16x32_bf16 v[112:115], v[60:63], a[236:239], v[112:115]
    s_waitcnt lgkmcnt(3)
    s_nop 0
    v_mfma_f32_16x16x32_bf16 v[96:99], v[64:67], a[240:243], v[96:99]
    ds_read_b128 v[52:55], v4 offset:10240
    s_add_u32 m0, s75, 16384
    v_mfma_f32_16x16x32_bf16 v[108:111], v[64:67], a[244:247], v[108:111]
    ds_read_b128 v[56:59], v4 offset:11264
    v_add_u32 v10, 16384, v9
    v_mfma_f32_16x16x32_bf16 v[100:103], v[68:71], a[240:243], v[100:103]
    ds_read_b128 v[60:63], v4 offset:12288
    buffer_load_dwordx4 v10, s[8:11], 0 offen offset:0 sc1 lds
    v_mfma_f32_16x16x32_bf16 v[112:115], v[68:71], a[244:247], v[112:115]
    s_nop 0
    v_mfma_f32_16x16x32_bf16 v[96:99], v[72:75], a[248:251], v[96:99]
    v_mfma_f32_16x16x32_bf16 v[108:111], v[72:75], a[252:255], v[108:111]
    s_waitcnt lgkmcnt(3)
    v_mfma_f32_16x16x32_bf16 v[100:103], v[40:43], a[248:251], v[100:103]
    ds_read_b128 v[64:67], v4 offset:13312
    buffer_load_dwordx4 v10, s[8:11], 0 offen offset:1024 sc1 lds
    v_mfma_f32_16x16x32_bf16 v[112:115], v[40:43], a[252:255], v[112:115]
    ds_read_b128 v[68:71], v4 offset:14336
    v_mfma_f32_16x16x32_bf16 v[104:107], v[44:47], a[0:3], 0
    ds_read_b128 v[72:75], v4 offset:15360
    v_mfma_f32_16x16x32_bf16 v[116:119], v[44:47], a[4:7], 0
    v_mfma_f32_16x16x32_bf16 v[104:107], v[48:51], a[8:11], v[104:107]
    s_waitcnt vmcnt(20)
    s_nop 0
    v_mfma_f32_16x16x32_bf16 v[116:119], v[48:51], a[12:15], v[116:119]
    s_barrier
    s_waitcnt lgkmcnt(3)
    v_mfma_f32_16x16x32_bf16 v[104:107], v[52:55], a[16:19], v[104:107]
    ds_read_b128 v[40:43], v4 offset:16384
    s_add_u32 m0, s27, 49152
    v_mfma_f32_16x16x32_bf16 v[116:119], v[52:55], a[20:23], v[116:119]
    ds_read_b128 v[44:47], v4 offset:17408
    v_add_u32 v13, 12288, v13
    v_mfma_f32_16x16x32_bf16 v[104:107], v[56:59], a[24:27], v[104:107]
    ds_read_b128 v[48:51], v4 offset:18432
    buffer_load_dwordx4 v13, s[8:11], 0 offen offset:0 sc1 lds
    v_mfma_f32_16x16x32_bf16 v[116:119], v[56:59], a[28:31], v[116:119]
    v_cvt_pk_bf16_f32 v168, v96, v97
    v_cvt_pk_bf16_f32 v169, v98, v99
    v_mfma_f32_16x16x32_bf16 v[104:107], v[60:63], a[32:35], v[104:107]
    v_cvt_pk_bf16_f32 v170, v108, v109
    v_cvt_pk_bf16_f32 v171, v110, v111
    v_mfma_f32_16x16x32_bf16 v[116:119], v[60:63], a[36:39], v[116:119]
    buffer_store_dwordx4 v[168:171], v2, s[8:11], s87 offen offset:0 sc1
    s_waitcnt lgkmcnt(3)
    v_mfma_f32_16x16x32_bf16 v[104:107], v[64:67], a[40:43], v[104:107]
    ds_read_b128 v[52:55], v4 offset:19456
    buffer_load_dwordx4 v13, s[8:11], 0 offen offset:1024 sc1 lds
    v_mfma_f32_16x16x32_bf16 v[116:119], v[64:67], a[44:47], v[116:119]
    ds_read_b128 v[56:59], v4 offset:20480
    v_mfma_f32_16x16x32_bf16 v[104:107], v[68:71], a[48:51], v[104:107]
    ds_read_b128 v[60:63], v4 offset:21504
    v_mfma_f32_16x16x32_bf16 v[116:119], v[68:71], a[52:55], v[116:119]
    buffer_load_dwordx4 v13, s[8:11], 0 offen offset:2048 sc1 lds
    v_mfma_f32_16x16x32_bf16 v[104:107], v[72:75], a[56:59], v[104:107]
    v_mfma_f32_16x16x32_bf16 v[116:119], v[72:75], a[60:63], v[116:119]
    s_waitcnt lgkmcnt(3)
    v_mfma_f32_16x16x32_bf16 v[104:107], v[40:43], a[64:67], v[104:107]
    ds_read_b128 v[64:67], v4 offset:22528
    v_cvt_pk_bf16_f32 v172, v100, v101
    v_mfma_f32_16x16x32_bf16 v[116:119], v[40:43], a[68:71], v[116:119]
    ds_read_b128 v[68:71], v4 offset:23552
    v_cvt_pk_bf16_f32 v173, v102, v103
    v_mfma_f32_16x16x32_bf16 v[104:107], v[44:47], a[72:75], v[104:107]
    ds_read_b128 v[72:75], v4 offset:24576
    v_cvt_pk_bf16_f32 v174, v112, v113
    v_mfma_f32_16x16x32_bf16 v[116:119], v[44:47], a[76:79], v[116:119]
    v_cvt_pk_bf16_f32 v175, v114, v115
    v_mfma_f32_16x16x32_bf16 v[104:107], v[48:51], a[80:83], v[104:107]
    buffer_store_dwordx4 v[172:175], v2, s[8:11], s87 offen offset:1024 sc1
    v_mfma_f32_16x16x32_bf16 v[116:119], v[48:51], a[84:87], v[116:119]
    s_waitcnt lgkmcnt(3)
    v_mfma_f32_16x16x32_bf16 v[104:107], v[52:55], a[88:91], v[104:107]
    ds_read_b128 v[40:43], v4 offset:25600
    v_mfma_f32_16x16x32_bf16 v[116:119], v[52:55], a[92:95], v[116:119]
    ds_read_b128 v[44:47], v4 offset:26624
    v_mfma_f32_16x16x32_bf16 v[104:107], v[56:59], a[96:99], v[104:107]
    ds_read_b128 v[48:51], v4 offset:27648
    v_mfma_f32_16x16x32_bf16 v[116:119], v[56:59], a[100:103], v[116:119]
    v_mfma_f32_16x16x32_bf16 v[104:107], v[60:63], a[104:107], v[104:107]
    s_waitcnt vmcnt(22)
    v_mfma_f32_16x16x32_bf16 v[116:119], v[60:63], a[108:111], v[116:119]
    s_barrier
    s_waitcnt lgkmcnt(3)
    v_mfma_f32_16x16x32_bf16 v[104:107], v[64:67], a[112:115], v[104:107]
    ds_read_b128 v[52:55], v3 offset:8192
    s_add_u32 m0, s27, 61440
    v_mfma_f32_16x16x32_bf16 v[116:119], v[64:67], a[116:119], v[116:119]
    ds_read_b128 v[56:59], v3 offset:9216
    v_add_u32 v13, 12288, v13
    v_mfma_f32_16x16x32_bf16 v[104:107], v[68:71], a[120:123], v[104:107]
    ds_read_b128 v[60:63], v3 offset:10240
    buffer_load_dwordx4 v13, s[8:11], 0 offen offset:0 sc1 lds
    v_mfma_f32_16x16x32_bf16 v[116:119], v[68:71], a[124:127], v[116:119]
    s_nop 0
    v_mfma_f32_16x16x32_bf16 v[104:107], v[72:75], a[128:131], v[104:107]
    v_mfma_f32_16x16x32_bf16 v[116:119], v[72:75], a[132:135], v[116:119]
    s_waitcnt lgkmcnt(3)
    v_mfma_f32_16x16x32_bf16 v[104:107], v[40:43], a[136:139], v[104:107]
    ds_read_b128 v[64:67], v3 offset:11264
    buffer_load_dwordx4 v13, s[8:11], 0 offen offset:1024 sc1 lds
    v_mfma_f32_16x16x32_bf16 v[116:119], v[40:43], a[140:143], v[116:119]
    ds_read_b128 v[68:71], v3 offset:12288
    v_mfma_f32_16x16x32_bf16 v[104:107], v[44:47], a[144:147], v[104:107]
    ds_read_b128 v[72:75], v3 offset:13312
    v_mfma_f32_16x16x32_bf16 v[116:119], v[44:47], a[148:151], v[116:119]
    buffer_load_dwordx4 v13, s[8:11], 0 offen offset:2048 sc1 lds
    v_mfma_f32_16x16x32_bf16 v[104:107], v[48:51], a[152:155], v[104:107]
    v_mfma_f32_16x16x32_bf16 v[116:119], v[48:51], a[156:159], v[116:119]
    s_waitcnt lgkmcnt(3)
    v_mfma_f32_16x16x32_bf16 v[104:107], v[52:55], a[160:163], v[104:107]
    ds_read_b128 v[40:43], v3 offset:14336
    v_mfma_f32_16x16x32_bf16 v[116:119], v[52:55], a[164:167], v[116:119]
    ds_read_b128 v[44:47], v3 offset:15360
    v_mfma_f32_16x16x32_bf16 v[104:107], v[56:59], a[168:171], v[104:107]
    ds_read_b128 v[48:51], v3 offset:16384
    v_mfma_f32_16x16x32_bf16 v[116:119], v[56:59], a[172:175], v[116:119]
    v_mfma_f32_16x16x32_bf16 v[104:107], v[60:63], a[176:179], v[104:107]
    v_mfma_f32_16x16x32_bf16 v[116:119], v[60:63], a[180:183], v[116:119]
    s_waitcnt lgkmcnt(3)
    v_mfma_f32_16x16x32_bf16 v[104:107], v[64:67], a[184:187], v[104:107]
    ds_read_b128 v[52:55], v3 offset:17408
    v_mfma_f32_16x16x32_bf16 v[116:119], v[64:67], a[188:191], v[116:119]
    ds_read_b128 v[56:59], v3 offset:18432
    v_mfma_f32_16x16x32_bf16 v[104:107], v[68:71], a[192:195], v[104:107]
    ds_read_b128 v[60:63], v3 offset:19456
    v_mfma_f32_16x16x32_bf16 v[116:119], v[68:71], a[196:199], v[116:119]
    v_mfma_f32_16x16x32_bf16 v[104:107], v[72:75], a[200:203], v[104:107]
    s_waitcnt vmcnt(20)
    s_nop 0
    v_mfma_f32_16x16x32_bf16 v[116:119], v[72:75], a[204:207], v[116:119]
    s_barrier
    s_waitcnt lgkmcnt(3)
    v_mfma_f32_16x16x32_bf16 v[104:107], v[40:43], a[208:211], v[104:107]
    ds_read_b128 v[64:67], v3 offset:20480
    s_add_u32 m0, s27, 73728
    v_mfma_f32_16x16x32_bf16 v[116:119], v[40:43], a[212:215], v[116:119]
    ds_read_b128 v[68:71], v3 offset:21504
    v_add_u32 v13, 12288, v13
    v_mfma_f32_16x16x32_bf16 v[104:107], v[44:47], a[216:219], v[104:107]
    ds_read_b128 v[72:75], v3 offset:22528
    buffer_load_dwordx4 v13, s[8:11], 0 offen offset:0 sc1 lds
    v_mfma_f32_16x16x32_bf16 v[116:119], v[44:47], a[220:223], v[116:119]
    s_nop 0
    v_mfma_f32_16x16x32_bf16 v[104:107], v[48:51], a[224:227], v[104:107]
    v_mfma_f32_16x16x32_bf16 v[116:119], v[48:51], a[228:231], v[116:119]
    s_waitcnt lgkmcnt(3)
    v_mfma_f32_16x16x32_bf16 v[104:107], v[52:55], a[232:235], v[104:107]
    ds_read_b128 v[40:43], v3 offset:23552
    buffer_load_dwordx4 v13, s[8:11], 0 offen offset:1024 sc1 lds
    v_mfma_f32_16x16x32_bf16 v[116:119], v[52:55], a[236:239], v[116:119]
    ds_read_b128 v[44:47], v3 offset:24576
    v_mfma_f32_16x16x32_bf16 v[104:107], v[56:59], a[240:243], v[104:107]
    ds_read_b128 v[48:51], v3 offset:25600
    v_mfma_f32_16x16x32_bf16 v[116:119], v[56:59], a[244:247], v[116:119]
    buffer_load_dwordx4 v13, s[8:11], 0 offen offset:2048 sc1 lds
    v_mfma_f32_16x16x32_bf16 v[104:107], v[60:63], a[248:251], v[104:107]
    v_mfma_f32_16x16x32_bf16 v[116:119], v[60:63], a[252:255], v[116:119]
    s_waitcnt lgkmcnt(3)
    v_mfma_f32_16x16x32_bf16 v[16:19], v[64:67], a[0:3], v[16:19]
    ds_read_b128 v[52:55], v3 offset:26624
    v_mfma_f32_16x16x32_bf16 v[28:31], v[64:67], a[4:7], v[28:31]
    ds_read_b128 v[56:59], v3 offset:27648
    v_mfma_f32_16x16x32_bf16 v[20:23], v[68:71], a[0:3], v[20:23]
    ds_read_b128 v[60:63], v3 offset:28672
    v_mfma_f32_16x16x32_bf16 v[32:35], v[68:71], a[4:7], v[32:35]
    v_mfma_f32_16x16x32_bf16 v[16:19], v[72:75], a[8:11], v[16:19]
    v_mfma_f32_16x16x32_bf16 v[28:31], v[72:75], a[12:15], v[28:31]
    s_waitcnt lgkmcnt(3)
    v_mfma_f32_16x16x32_bf16 v[20:23], v[40:43], a[8:11], v[20:23]
    ds_read_b128 v[64:67], v3 offset:29696
    v_cvt_pk_bf16_f32 v176, v104, v105
    v_mfma_f32_16x16x32_bf16 v[32:35], v[40:43], a[12:15], v[32:35]
    ds_read_b128 v[68:71], v3 offset:30720
    v_cvt_pk_bf16_f32 v177, v106, v107
    v_mfma_f32_16x16x32_bf16 v[16:19], v[44:47], a[16:19], v[16:19]
    ds_read_b128 v[72:75], v3 offset:31744
    v_cvt_pk_bf16_f32 v178, v116, v117
    v_mfma_f32_16x16x32_bf16 v[28:31], v[44:47], a[20:23], v[28:31]
    v_cvt_pk_bf16_f32 v179, v118, v119
    v_mfma_f32_16x16x32_bf16 v[20:23], v[48:51], a[16:19], v[20:23]
    s_waitcnt vmcnt(18)
    v_mfma_f32_16x16x32_bf16 v[32:35], v[48:51], a[20:23], v[32:35]
    s_barrier
    s_waitcnt lgkmcnt(3)
    v_mfma_f32_16x16x32_bf16 v[16:19], v[52:55], a[24:27], v[16:19]
    ds_read_b128 v[40:43], v3 offset:32768
    s_add_u32 m0, s27, 0
    v_mfma_f32_16x16x32_bf16 v[28:31], v[52:55], a[28:31], v[28:31]
    ds_read_b128 v[44:47], v3 offset:33792
    v_add_u32 v13, 12288, v13
    v_mfma_f32_16x16x32_bf16 v[20:23], v[56:59], a[24:27], v[20:23]
    ds_read_b128 v[48:51], v3 offset:34816
    buffer_load_dwordx4 v13, s[8:11], 0 offen offset:0 sc1 lds
    v_mfma_f32_16x16x32_bf16 v[32:35], v[56:59], a[28:31], v[32:35]
    buffer_store_dwordx4 v[176:179], v2, s[8:11], s87 offen offset:2048 sc1
    v_mfma_f32_16x16x32_bf16 v[16:19], v[60:63], a[32:35], v[16:19]
    v_mfma_f32_16x16x32_bf16 v[28:31], v[60:63], a[36:39], v[28:31]
    s_waitcnt lgkmcnt(3)
    s_nop 0
    v_mfma_f32_16x16x32_bf16 v[20:23], v[64:67], a[32:35], v[20:23]
    ds_read_b128 v[52:55], v3 offset:35840
    buffer_load_dwordx4 v13, s[8:11], 0 offen offset:1024 sc1 lds
    v_mfma_f32_16x16x32_bf16 v[32:35], v[64:67], a[36:39], v[32:35]
    ds_read_b128 v[56:59], v3 offset:36864
    s_nop 0
    v_mfma_f32_16x16x32_bf16 v[16:19], v[68:71], a[40:43], v[16:19]
    ds_read_b128 v[60:63], v3 offset:37888
    v_mfma_f32_16x16x32_bf16 v[28:31], v[68:71], a[44:47], v[28:31]
    buffer_load_dwordx4 v13, s[8:11], 0 offen offset:2048 sc1 lds
    v_mfma_f32_16x16x32_bf16 v[20:23], v[72:75], a[40:43], v[20:23]
    v_mfma_f32_16x16x32_bf16 v[32:35], v[72:75], a[44:47], v[32:35]
    s_waitcnt lgkmcnt(3)
    v_mfma_f32_16x16x32_bf16 v[16:19], v[40:43], a[48:51], v[16:19]
    ds_read_b128 v[64:67], v3 offset:38912
    v_mfma_f32_16x16x32_bf16 v[28:31], v[40:43], a[52:55], v[28:31]
    ds_read_b128 v[68:71], v3 offset:39936
    v_mfma_f32_16x16x32_bf16 v[20:23], v[44:47], a[48:51], v[20:23]
    ds_read_b128 v[72:75], v3 offset:40960
    v_mfma_f32_16x16x32_bf16 v[32:35], v[44:47], a[52:55], v[32:35]
    v_mfma_f32_16x16x32_bf16 v[16:19], v[48:51], a[56:59], v[16:19]
    v_mfma_f32_16x16x32_bf16 v[28:31], v[48:51], a[60:63], v[28:31]
    s_waitcnt lgkmcnt(3)
    v_mfma_f32_16x16x32_bf16 v[20:23], v[52:55], a[56:59], v[20:23]
    ds_read_b128 v[40:43], v3 offset:41984
    v_mfma_f32_16x16x32_bf16 v[32:35], v[52:55], a[60:63], v[32:35]
    ds_read_b128 v[44:47], v3 offset:43008
    v_mfma_f32_16x16x32_bf16 v[16:19], v[56:59], a[64:67], v[16:19]
    ds_read_b128 v[48:51], v3 offset:44032
    v_mfma_f32_16x16x32_bf16 v[28:31], v[56:59], a[68:71], v[28:31]
    v_mfma_f32_16x16x32_bf16 v[20:23], v[60:63], a[64:67], v[20:23]
    s_waitcnt vmcnt(17)
    v_mfma_f32_16x16x32_bf16 v[32:35], v[60:63], a[68:71], v[32:35]
    s_barrier
    s_waitcnt lgkmcnt(3)
    v_mfma_f32_16x16x32_bf16 v[16:19], v[64:67], a[72:75], v[16:19]
    ds_read_b128 v[52:55], v3 offset:45056
    s_add_u32 m0, s27, 12288
    v_mfma_f32_16x16x32_bf16 v[28:31], v[64:67], a[76:79], v[28:31]
    ds_read_b128 v[56:59], v3 offset:46080
    v_add_u32 v13, 12288, v13
    v_mfma_f32_16x16x32_bf16 v[20:23], v[68:71], a[72:75], v[20:23]
    ds_read_b128 v[60:63], v3 offset:47104
    buffer_load_dwordx4 v13, s[8:11], 0 offen offset:0 sc1 lds
    v_mfma_f32_16x16x32_bf16 v[32:35], v[68:71], a[76:79], v[32:35]
    buffer_load_dwordx4 v[180:183], v2, s[8:11], s86 offen offset:0 sc1
    v_mfma_f32_16x16x32_bf16 v[16:19], v[72:75], a[80:83], v[16:19]
    v_mfma_f32_16x16x32_bf16 v[28:31], v[72:75], a[84:87], v[28:31]
    s_waitcnt lgkmcnt(3)
    s_nop 0
    v_mfma_f32_16x16x32_bf16 v[20:23], v[40:43], a[80:83], v[20:23]
    ds_read_b128 v[64:67], v3 offset:48128
    buffer_load_dwordx4 v13, s[8:11], 0 offen offset:1024 sc1 lds
    v_mfma_f32_16x16x32_bf16 v[32:35], v[40:43], a[84:87], v[32:35]
    ds_read_b128 v[68:71], v3 offset:49152
    s_nop 0
    v_mfma_f32_16x16x32_bf16 v[16:19], v[44:47], a[88:91], v[16:19]
    ds_read_b128 v[72:75], v3 offset:50176
    v_mfma_f32_16x16x32_bf16 v[28:31], v[44:47], a[92:95], v[28:31]
    buffer_load_dwordx4 v13, s[8:11], 0 offen offset:2048 sc1 lds
    v_mfma_f32_16x16x32_bf16 v[20:23], v[48:51], a[88:91], v[20:23]
    v_mfma_f32_16x16x32_bf16 v[32:35], v[48:51], a[92:95], v[32:35]
    s_waitcnt lgkmcnt(3)
    v_mfma_f32_16x16x32_bf16 v[16:19], v[52:55], a[96:99], v[16:19]
    ds_read_b128 v[40:43], v3 offset:51200
    v_mfma_f32_16x16x32_bf16 v[28:31], v[52:55], a[100:103], v[28:31]
    ds_read_b128 v[44:47], v3 offset:52224
    v_mfma_f32_16x16x32_bf16 v[20:23], v[56:59], a[96:99], v[20:23]
    ds_read_b128 v[48:51], v3 offset:53248
    v_mfma_f32_16x16x32_bf16 v[32:35], v[56:59], a[100:103], v[32:35]
    buffer_load_dwordx4 v[184:187], v2, s[8:11], s86 offen offset:1024 sc1
    v_mfma_f32_16x16x32_bf16 v[16:19], v[60:63], a[104:107], v[16:19]
    v_mfma_f32_16x16x32_bf16 v[28:31], v[60:63], a[108:111], v[28:31]
    s_waitcnt lgkmcnt(3)
    v_mfma_f32_16x16x32_bf16 v[20:23], v[64:67], a[104:107], v[20:23]
    ds_read_b128 v[52:55], v3 offset:54272
    v_mfma_f32_16x16x32_bf16 v[32:35], v[64:67], a[108:111], v[32:35]
    ds_read_b128 v[56:59], v3 offset:55296
    v_mfma_f32_16x16x32_bf16 v[16:19], v[68:71], a[112:115], v[16:19]
    ds_read_b128 v[60:63], v3 offset:56320
    v_mfma_f32_16x16x32_bf16 v[28:31], v[68:71], a[116:119], v[28:31]
    v_mfma_f32_16x16x32_bf16 v[20:23], v[72:75], a[112:115], v[20:23]
    s_waitcnt vmcnt(16)
    v_mfma_f32_16x16x32_bf16 v[32:35], v[72:75], a[116:119], v[32:35]
    s_barrier
    s_waitcnt lgkmcnt(3)
    v_mfma_f32_16x16x32_bf16 v[16:19], v[40:43], a[120:123], v[16:19]
    ds_read_b128 v[64:67], v3 offset:57344
    s_add_u32 m0, s27, 24576
    v_mfma_f32_16x16x32_bf16 v[28:31], v[40:43], a[124:127], v[28:31]
    ds_read_b128 v[68:71], v3 offset:58368
    v_add_u32 v10, 18432, v9
    v_mfma_f32_16x16x32_bf16 v[20:23], v[44:47], a[120:123], v[20:23]
    ds_read_b128 v[72:75], v3 offset:59392
    buffer_load_dwordx4 v10, s[8:11], 0 offen offset:0 sc1 lds
    v_mfma_f32_16x16x32_bf16 v[32:35], v[44:47], a[124:127], v[32:35]
    v_mfma_f32_16x16x32_bf16 v[16:19], v[48:51], a[128:131], v[16:19]
    v_mfma_f32_16x16x32_bf16 v[28:31], v[48:51], a[132:135], v[28:31]
    s_waitcnt lgkmcnt(3)
    s_nop 0
    v_mfma_f32_16x16x32_bf16 v[20:23], v[52:55], a[128:131], v[20:23]
    ds_read_b128 v[40:43], v3 offset:60416
    buffer_load_dwordx4 v10, s[8:11], 0 offen offset:1024 sc1 lds
    v_mfma_f32_16x16x32_bf16 v[32:35], v[52:55], a[132:135], v[32:35]
    ds_read_b128 v[44:47], v3 offset:61440
    s_nop 0
    v_mfma_f32_16x16x32_bf16 v[16:19], v[56:59], a[136:139], v[16:19]
    ds_read_b128 v[48:51], v3 offset:62464
    v_mfma_f32_16x16x32_bf16 v[28:31], v[56:59], a[140:143], v[28:31]
    buffer_load_dwordx4 v10, s[8:11], 0 offen offset:2048 sc1 lds
    v_mfma_f32_16x16x32_bf16 v[20:23], v[60:63], a[136:139], v[20:23]
    v_mfma_f32_16x16x32_bf16 v[32:35], v[60:63], a[140:143], v[32:35]
    s_waitcnt lgkmcnt(3)
    v_mfma_f32_16x16x32_bf16 v[16:19], v[64:67], a[144:147], v[16:19]
    ds_read_b128 v[52:55], v3 offset:63488
    v_mfma_f32_16x16x32_bf16 v[28:31], v[64:67], a[148:151], v[28:31]
    ds_read_b128 v[56:59], v3 offset:64512
    v_mfma_f32_16x16x32_bf16 v[20:23], v[68:71], a[144:147], v[20:23]
    ds_read_b128 v[60:63], v4 offset:0
    v_mfma_f32_16x16x32_bf16 v[32:35], v[68:71], a[148:151], v[32:35]
    v_mfma_f32_16x16x32_bf16 v[16:19], v[72:75], a[152:155], v[16:19]
    v_mfma_f32_16x16x32_bf16 v[28:31], v[72:75], a[156:159], v[28:31]
    s_waitcnt lgkmcnt(3)
    v_mfma_f32_16x16x32_bf16 v[20:23], v[40:43], a[152:155], v[20:23]
    ds_read_b128 v[64:67], v4 offset:1024
    v_mfma_f32_16x16x32_bf16 v[32:35], v[40:43], a[156:159], v[32:35]
    ds_read_b128 v[68:71], v4 offset:2048
    v_mfma_f32_16x16x32_bf16 v[16:19], v[44:47], a[160:163], v[16:19]
    ds_read_b128 v[72:75], v4 offset:3072
    v_mfma_f32_16x16x32_bf16 v[28:31], v[44:47], a[164:167], v[28:31]
    v_mfma_f32_16x16x32_bf16 v[20:23], v[48:51], a[160:163], v[20:23]
    s_waitcnt vmcnt(15)
    v_mfma_f32_16x16x32_bf16 v[32:35], v[48:51], a[164:167], v[32:35]
    s_barrier
    s_waitcnt lgkmcnt(3)
    v_mfma_f32_16x16x32_bf16 v[16:19], v[52:55], a[168:171], v[16:19]
    ds_read_b128 v[40:43], v4 offset:4096
    s_add_u32 m0, s27, 36864
    v_mfma_f32_16x16x32_bf16 v[28:31], v[52:55], a[172:175], v[28:31]
    ds_read_b128 v[44:47], v4 offset:5120
    v_add_u32 v10, 21504, v9
    v_mfma_f32_16x16x32_bf16 v[20:23], v[56:59], a[168:171], v[20:23]
    ds_read_b128 v[48:51], v4 offset:6144
    buffer_load_dwordx4 v10, s[8:11], 0 offen offset:0 sc1 lds
    v_mfma_f32_16x16x32_bf16 v[32:35], v[56:59], a[172:175], v[32:35]
    v_mfma_f32_16x16x32_bf16 v[16:19], v[60:63], a[176:179], v[16:19]
    v_mfma_f32_16x16x32_bf16 v[28:31], v[60:63], a[180:183], v[28:31]
    s_waitcnt lgkmcnt(3)
    s_nop 0
    v_mfma_f32_16x16x32_bf16 v[20:23], v[64:67], a[176:179], v[20:23]
    ds_read_b128 v[52:55], v4 offset:7168
    buffer_load_dwordx4 v10, s[8:11], 0 offen offset:1024 sc1 lds
    v_mfma_f32_16x16x32_bf16 v[32:35], v[64:67], a[180:183], v[32:35]
    ds_read_b128 v[56:59], v4 offset:8192
    v_mfma_f32_16x16x32_bf16 v[16:19], v[68:71], a[184:187], v[16:19]
    ds_read_b128 v[60:63], v4 offset:9216
    v_mfma_f32_16x16x32_bf16 v[28:31], v[68:71], a[188:191], v[28:31]
    buffer_load_dwordx4 v10, s[8:11], 0 offen offset:2048 sc1 lds
    v_mfma_f32_16x16x32_bf16 v[20:23], v[72:75], a[184:187], v[20:23]
    v_mfma_f32_16x16x32_bf16 v[32:35], v[72:75], a[188:191], v[32:35]
    s_waitcnt lgkmcnt(3)
    v_mfma_f32_16x16x32_bf16 v[16:19], v[40:43], a[192:195], v[16:19]
    ds_read_b128 v[64:67], v4 offset:10240
    v_mfma_f32_16x16x32_bf16 v[28:31], v[40:43], a[196:199], v[28:31]
    ds_read_b128 v[68:71], v4 offset:11264
    v_mfma_f32_16x16x32_bf16 v[20:23], v[44:47], a[192:195], v[20:23]
    ds_read_b128 v[72:75], v4 offset:12288
    v_mfma_f32_16x16x32_bf16 v[32:35], v[44:47], a[196:199], v[32:35]
    v_mfma_f32_16x16x32_bf16 v[16:19], v[48:51], a[200:203], v[16:19]
    v_mfma_f32_16x16x32_bf16 v[28:31], v[48:51], a[204:207], v[28:31]
    s_waitcnt lgkmcnt(3)
    v_mfma_f32_16x16x32_bf16 v[20:23], v[52:55], a[200:203], v[20:23]
    ds_read_b128 v[40:43], v4 offset:13312
    s_waitcnt vmcnt(6)
    v_mfma_f32_16x16x32_bf16 v[32:35], v[52:55], a[204:207], v[32:35]
    ds_read_b128 v[44:47], v4 offset:14336
    v_max_u32 v92, v180, v181
    v_mfma_f32_16x16x32_bf16 v[16:19], v[56:59], a[208:211], v[16:19]
    ds_read_b128 v[48:51], v4 offset:15360
    v_max3_u32 v92, v92, v182, v183
    v_mfma_f32_16x16x32_bf16 v[28:31], v[56:59], a[212:215], v[28:31]
    buffer_load_dwordx4 v[188:191], v2, s[8:11], s86 offen offset:2048 sc1
    v_mfma_f32_16x16x32_bf16 v[20:23], v[60:63], a[208:211], v[20:23]
    v_max3_u32 v92, v92, v184, v185
    v_max3_u32 v92, v92, v186, v187
    v_mfma_f32_16x16x32_bf16 v[32:35], v[60:63], a[212:215], v[32:35]
    s_barrier
    s_waitcnt lgkmcnt(3)
    v_mfma_f32_16x16x32_bf16 v[16:19], v[64:67], a[216:219], v[16:19]
    ds_read_b128 v[52:55], v4 offset:16384
    s_add_u32 m0, s27, 49152
    v_mfma_f32_16x16x32_bf16 v[28:31], v[64:67], a[220:223], v[28:31]
    ds_read_b128 v[56:59], v4 offset:17408
    v_add_u32 v10, 24576, v9
    v_mfma_f32_16x16x32_bf16 v[20:23], v[68:71], a[216:219], v[20:23]
    ds_read_b128 v[60:63], v4 offset:18432
    buffer_load_dwordx4 v10, s[8:11], 0 offen offset:0 sc1 lds
    v_mfma_f32_16x16x32_bf16 v[32:35], v[68:71], a[220:223], v[32:35]
    v_cmp_eq_u32 vcc, -1, v92
    s_cbranch_vccnz X0_r
X0_d:
    v_mfma_f32_16x16x32_bf16 v[16:19], v[72:75], a[224:227], v[16:19]
    v_lshlrev_b32_e64 v120, 16, v180
    v_and_b32 v121, 0xffff0000, v180
    v_mfma_f32_16x16x32_bf16 v[28:31], v[72:75], a[228:231], v[28:31]
    v_mul_f32 v120, v120, v144
    s_waitcnt lgkmcnt(3)
    v_mfma_f32_16x16x32_bf16 v[20:23], v[40:43], a[224:227], v[20:23]
    ds_read_b128 v[64:67], v4 offset:19456
    buffer_load_dwordx4 v10, s[8:11], 0 offen offset:1024 sc1 lds
    v_mfma_f32_16x16x32_bf16 v[32:35], v[40:43], a[228:231], v[32:35]
    ds_read_b128 v[68:71], v4 offset:20480
    v_mul_f32_e64 v121, v121, v145
    v_mfma_f32_16x16x32_bf16 v[16:19], v[44:47], a[232:235], v[16:19]
    ds_read_b128 v[72:75], v4 offset:21504
    v_lshlrev_b32_e64 v122, 16, v181
    v_mfma_f32_16x16x32_bf16 v[28:31], v[44:47], a[236:239], v[28:31]
    buffer_load_dwordx4 v10, s[8:11], 0 offen offset:2048 sc1 lds
    v_and_b32 v123, 0xffff0000, v181
    v_mfma_f32_16x16x32_bf16 v[20:23], v[48:51], a[232:235], v[20:23]
    v_mul_f32 v122, v122, v146
    v_mul_f32 v123, v123, v147
    v_mfma_f32_16x16x32_bf16 v[32:35], v[48:51], a[236:239], v[32:35]
    v_lshlrev_b32 v124, 16, v182
    s_waitcnt lgkmcnt(3)
    v_mfma_f32_16x16x32_bf16 v[16:19], v[52:55], a[240:243], v[16:19]
    ds_read_b128 v[40:43], v4 offset:22528
    v_and_b32 v125, 0xffff0000, v182
    v_mfma_f32_16x16x32_bf16 v[28:31], v[52:55], a[244:247], v[28:31]
    ds_read_b128 v[44:47], v4 offset:23552
    v_mul_f32_e64 v124, v124, v148
    v_mfma_f32_16x16x32_bf16 v[20:23], v[56:59], a[240:243], v[20:23]
    ds_read_b128 v[48:51], v4 offset:24576
    v_mul_f32_e64 v125, v125, v149
    v_mfma_f32_16x16x32_bf16 v[32:35], v[56:59], a[244:247], v[32:35]
    v_lshlrev_b32_e64 v126, 16, v183
    v_and_b32 v127, 0xffff0000, v183
    v_mfma_f32_16x16x32_bf16 v[16:19], v[60:63], a[248:251], v[16:19]
    v_mul_f32 v126, v126, v150
    v_mul_f32 v127, v127, v151
    v_mfma_f32_16x16x32_bf16 v[28:31], v[60:63], a[252:255], v[28:31]
    v_lshlrev_b32 v128, 16, v184
    s_waitcnt lgkmcnt(3)
    v_mfma_f32_16x16x32_bf16 v[20:23], v[64:67], a[248:251], v[20:23]
    ds_read_b128 v[52:55], v4 offset:25600
    v_and_b32 v129, 0xffff0000, v184
    v_mfma_f32_16x16x32_bf16 v[32:35], v[64:67], a[252:255], v[32:35]
    ds_read_b128 v[56:59], v4 offset:26624
    v_mul_f32_e64 v128, v128, v152
    v_mfma_f32_16x16x32_bf16 v[24:27], v[68:71], a[0:3], v[24:27]
    ds_read_b128 v[60:63], v4 offset:27648
    v_mul_f32_e64 v129, v129, v153
    v_mfma_f32_16x16x32_bf16 v[36:39], v[68:71], a[4:7], v[36:39]
    v_lshlrev_b32_e64 v130, 16, v185
    v_and_b32 v131, 0xffff0000, v185
    v_mfma_f32_16x16x32_bf16 v[24:27], v[72:75], a[8:11], v[24:27]
    v_mul_f32 v130, v130, v154
    v_mul_f32 v131, v131, v155
    v_mfma_f32_16x16x32_bf16 v[36:39], v[72:75], a[12:15], v[36:39]
    s_barrier
    s_waitcnt lgkmcnt(3)
    v_mfma_f32_16x16x32_bf16 v[24:27], v[40:43], a[16:19], v[24:27]
    ds_read_b128 v[64:67], v3 offset:8192
    s_add_u32 m0, s27, 61440
    v_mfma_f32_16x16x32_bf16 v[36:39], v[40:43], a[20:23], v[36:39]
    ds_read_b128 v[68:71], v3 offset:9216
    v_add_u32 v10, 27648, v9
    v_mfma_f32_16x16x32_bf16 v[24:27], v[44:47], a[24:27], v[24:27]
    ds_read_b128 v[72:75], v3 offset:10240
    buffer_load_dwordx4 v10, s[8:11], 0 offen offset:0 sc1 lds
    v_mfma_f32_16x16x32_bf16 v[36:39], v[44:47], a[28:31], v[36:39]
    v_lshlrev_b32_e64 v132, 16, v186
    v_and_b32 v133, 0xffff0000, v186
    v_mfma_f32_16x16x32_bf16 v[24:27], v[48:51], a[32:35], v[24:27]
    v_mul_f32 v132, v132, v156
    v_mul_f32 v133, v133, v157
    v_mfma_f32_16x16x32_bf16 v[36:39], v[48:51], a[36:39], v[36:39]
    v_lshlrev_b32 v134, 16, v187
    s_waitcnt lgkmcnt(3)
    v_mfma_f32_16x16x32_bf16 v[24:27], v[52:55], a[40:43], v[24:27]
    ds_read_b128 v[40:43], v3 offset:11264
    buffer_load_dwordx4 v10, s[8:11], 0 offen offset:1024 sc1 lds
    v_mfma_f32_16x16x32_bf16 v[36:39], v[52:55], a[44:47], v[36:39]
    ds_read_b128 v[44:47], v3 offset:12288
    v_and_b32 v135, 0xffff0000, v187
    v_mfma_f32_16x16x32_bf16 v[24:27], v[56:59], a[48:51], v[24:27]
    ds_read_b128 v[48:51], v3 offset:13312
    v_mul_f32_e64 v134, v134, v158
    v_mfma_f32_16x16x32_bf16 v[36:39], v[56:59], a[52:55], v[36:39]
    buffer_load_dwordx4 v10, s[8:11], 0 offen offset:2048 sc1 lds
    v_mul_f32_e64 v135, v135, v159
    v_mfma_f32_16x16x32_bf16 v[24:27], v[60:63], a[56:59], v[24:27]
    v_fma_f32 v16, v16, v144, v120
    v_fma_f32 v17, v17, v145, v121
    v_mfma_f32_16x16x32_bf16 v[36:39], v[60:63], a[60:63], v[36:39]
    v_fma_f32 v18, v18, v146, v122
    s_waitcnt lgkmcnt(3)
    v_mfma_f32_16x16x32_bf16 v[24:27], v[64:67], a[64:67], v[24:27]
    ds_read_b128 v[52:55], v3 offset:14336
    v_fma_f32 v19, v19, v147, v123
L_pg7:
    s_cbranch_execz L_w3
    v_mfma_f32_16x16x32_bf16 v[36:39], v[64:67], a[68:71], v[36:39]
    ds_read_b128 v[56:59], v3 offset:15360
    v_cvt_pk_bf16_f32 v16, v16, v17
    v_mfma_f32_16x16x32_bf16 v[24:27], v[68:71], a[72:75], v[24:27]
    ds_read_b128 v[60:63], v3 offset:16384
    v_cvt_pk_bf16_f32 v17, v18, v19
    v_mfma_f32_16x16x32_bf16 v[36:39], v[68:71], a[76:79], v[36:39]
    v_fma_f32 v20, v20, v152, v128
    v_fma_f32 v21, v21, v153, v129
    v_mfma_f32_16x16x32_bf16 v[24:27], v[72:75], a[80:83], v[24:27]
    v_fma_f32 v22, v22, v154, v130
    v_fma_f32 v23, v23, v155, v131
    v_mfma_f32_16x16x32_bf16 v[36:39], v[72:75], a[84:87], v[36:39]
    v_cvt_pk_bf16_f32 v18, v20, v21
    s_nop 0
    s_waitcnt lgkmcnt(3)
    v_mfma_f32_16x16x32_bf16 v[24:27], v[40:43], a[88:91], v[24:27]
    ds_read_b128 v[64:67], v3 offset:17408
    v_cvt_pk_bf16_f32 v19, v22, v23
    v_mfma_f32_16x16x32_bf16 v[36:39], v[40:43], a[92:95], v[36:39]
    ds_read_b128 v[68:71], v3 offset:18432
    v_mfma_f32_16x16x32_bf16 v[24:27], v[44:47], a[96:99], v[24:27]
    ds_read_b128 v[72:75], v3 offset:19456
    v_mfma_f32_16x16x32_bf16 v[36:39], v[44:47], a[100:103], v[36:39]
    buffer_store_dwordx4 v[16:19], v2, s[8:11], s30 offen sc1
    v_mfma_f32_16x16x32_bf16 v[24:27], v[48:51], a[104:107], v[24:27]
    v_fma_f32 v28, v28, v148, v124
    v_fma_f32 v29, v29, v149, v125
    v_mfma_f32_16x16x32_bf16 v[36:39], v[48:51], a[108:111], v[36:39]
    s_barrier
    s_waitcnt lgkmcnt(3)
    v_mfma_f32_16x16x32_bf16 v[24:27], v[52:55], a[112:115], v[24:27]
    ds_read_b128 v[40:43], v3 offset:20480
    v_fma_f32 v30, v30, v150, v126
    v_mfma_f32_16x16x32_bf16 v[36:39], v[52:55], a[116:119], v[36:39]
    ds_read_b128 v[44:47], v3 offset:21504
    v_fma_f32 v31, v31, v151, v127
    v_mfma_f32_16x16x32_bf16 v[24:27], v[56:59], a[120:123], v[24:27]
    ds_read_b128 v[48:51], v3 offset:22528
    v_cvt_pk_bf16_f32 v28, v28, v29
    v_mfma_f32_16x16x32_bf16 v[36:39], v[56:59], a[124:127], v[36:39]
    v_cvt_pk_bf16_f32 v29, v30, v31
    v_fma_f32 v32, v32, v156, v132
    v_mfma_f32_16x16x32_bf16 v[24:27], v[60:63], a[128:131], v[24:27]
    v_fma_f32 v33, v33, v157, v133
    v_fma_f32 v34, v34, v158, v134
    v_mfma_f32_16x16x32_bf16 v[36:39], v[60:63], a[132:135], v[36:39]
    v_fma_f32 v35, v35, v159, v135
    s_waitcnt lgkmcnt(3)
    s_nop 0
    v_mfma_f32_16x16x32_bf16 v[24:27], v[64:67], a[136:139], v[24:27]
    ds_read_b128 v[52:55], v3 offset:23552
    v_cvt_pk_bf16_f32 v30, v32, v33
    v_mfma_f32_16x16x32_bf16 v[36:39], v[64:67], a[140:143], v[36:39]
    ds_read_b128 v[56:59], v3 offset:24576
    v_cvt_pk_bf16_f32 v31, v34, v35
    v_mfma_f32_16x16x32_bf16 v[24:27], v[68:71], a[144:147], v[24:27]
    ds_read_b128 v[60:63], v3 offset:25600
    v_mfma_f32_16x16x32_bf16 v[36:39], v[68:71], a[148:151], v[36:39]
    buffer_store_dwordx4 v[28:31], v2, s[8:11], s32 offen sc1
    v_mfma_f32_16x16x32_bf16 v[24:27], v[72:75], a[152:155], v[24:27]
    s_waitcnt vmcnt(8)
    v_max_u32 v92, v188, v189
    v_mfma_f32_16x16x32_bf16 v[36:39], v[72:75], a[156:159], v[36:39]
    v_max3_u32 v92, v92, v190, v191
    s_waitcnt lgkmcnt(3)
    v_mfma_f32_16x16x32_bf16 v[24:27], v[40:43], a[160:163], v[24:27]
    ds_read_b128 v[64:67], v3 offset:26624
    v_cmp_eq_u32 vcc, -1, v92
    v_mfma_f32_16x16x32_bf16 v[36:39], v[40:43], a[164:167], v[36:39]
    ds_read_b128 v[68:71], v3 offset:27648
    s_cbranch_vccnz X1_r
X1_d:
    v_mfma_f32_16x16x32_bf16 v[24:27], v[44:47], a[168:171], v[24:27]
    ds_read_b128 v[72:75], v3 offset:28672
    v_lshlrev_b32 v136, 16, v188
    v_mfma_f32_16x16x32_bf16 v[36:39], v[44:47], a[172:175], v[36:39]
    v_and_b32 v137, 0xffff0000, v188
    v_mul_f32_e64 v136, v136, v160
    v_mfma_f32_16x16x32_bf16 v[24:27], v[48:51], a[176:179], v[24:27]
    v_mul_f32 v137, v137, v161
    v_lshlrev_b32 v138, 16, v189
    v_mfma_f32_16x16x32_bf16 v[36:39], v[48:51], a[180:183], v[36:39]
    v_and_b32 v139, 0xffff0000, v189
    s_waitcnt lgkmcnt(3)
    v_mfma_f32_16x16x32_bf16 v[24:27], v[52:55], a[184:187], v[24:27]
    ds_read_b128 v[40:43], v3 offset:29696
    v_mul_f32 v138, v138, v162
    v_mfma_f32_16x16x32_bf16 v[36:39], v[52:55], a[188:191], v[36:39]
    ds_read_b128 v[44:47], v3 offset:30720
    v_mul_f32_e64 v139, v139, v163
    v_mfma_f32_16x16x32_bf16 v[24:27], v[56:59], a[192:195], v[24:27]
    ds_read_b128 v[48:51], v3 offset:31744
    v_lshlrev_b32_e64 v140, 16, v190
    v_mfma_f32_16x16x32_bf16 v[36:39], v[56:59], a[196:199], v[36:39]
    v_and_b32 v141, 0xffff0000, v190
    v_mul_f32_e64 v140, v140, v164
    v_mfma_f32_16x16x32_bf16 v[24:27], v[60:63], a[200:203], v[24:27]
    v_mul_f32 v141, v141, v165
    v_lshlrev_b32 v142, 16, v191
    v_mfma_f32_16x16x32_bf16 v[36:39], v[60:63], a[204:207], v[36:39]
    v_and_b32 v143, 0xffff0000, v191
    s_waitcnt lgkmcnt(3)
    v_mfma_f32_16x16x32_bf16 v[24:27], v[64:67], a[208:211], v[24:27]
    v_mul_f32 v142, v142, v166
    v_mul_f32_e64 v143, v143, v167
    v_mfma_f32_16x16x32_bf16 v[36:39], v[64:67], a[212:215], v[36:39]
    v_mfma_f32_16x16x32_bf16 v[24:27], v[68:71], a[216:219], v[24:27]
    v_mfma_f32_16x16x32_bf16 v[36:39], v[68:71], a[220:223], v[36:39]
    v_mfma_f32_16x16x32_bf16 v[24:27], v[72:75], a[224:227], v[24:27]
    v_mfma_f32_16x16x32_bf16 v[36:39], v[72:75], a[228:231], v[36:39]
    s_waitcnt lgkmcnt(0)
    v_mfma_f32_16x16x32_bf16 v[24:27], v[40:43], a[232:235], v[24:27]
    v_mfma_f32_16x16x32_bf16 v[36:39], v[40:43], a[236:239], v[36:39]
    v_mfma_f32_16x16x32_bf16 v[24:27], v[44:47], a[240:243], v[24:27]
    v_mfma_f32_16x16x32_bf16 v[36:39], v[44:47], a[244:247], v[36:39]
    v_mfma_f32_16x16x32_bf16 v[24:27], v[48:51], a[248:251], v[24:27]
    v_mfma_f32_16x16x32_bf16 v[36:39], v[48:51], a[252:255], v[36:39]
    s_lshl_b32 s25, s72, 2
    s_add_u32 s25, s25, s20
    s_lshr_b32 s30, s25, 1
    s_lshl_b32 s24, s30, 8
    s_lshr_b32 s29, s73, 2
    s_mul_i32 s29, s29, 0
    s_add_u32 s24, s24, s29
    s_add_u32 s24, s24, 6012928
    v_lshlrev_b32 v48, 4, v5
    v_lshlrev_b32 v7, 4, v5
    v_pk_fma_f32 v[24:25], v[24:25], v[160:161], v[136:137]
    v_pk_fma_f32 v[26:27], v[26:27], v[162:163], v[138:139]
    v_pk_fma_f32 v[36:37], v[36:37], v[164:165], v[140:141]
    v_pk_fma_f32 v[38:39], v[38:39], v[166:167], v[142:143]
    v_cvt_pk_bf16_f32 v40, v24, v25
    v_cvt_pk_bf16_f32 v41, v26, v27
    v_cvt_pk_bf16_f32 v42, v36, v37
    v_cvt_pk_bf16_f32 v43, v38, v39
    s_nop 0
    v_permlane16_swap_b32 v40, v42
    v_permlane16_swap_b32 v41, v43
    buffer_store_dwordx4 v[40:43], v88, s[8:11], s31 offen sc1
    s_waitcnt vmcnt(1)
    s_mov_b64 exec, 1
    buffer_store_dword v0, v12, s[8:11], s28 offen sc1
    s_mov_b64 exec, -1
    s_lshl_b32 s30, s30, 5
    s_and_b32 s31, s25, 1
    s_add_u32 s30, s30, s31
    s_lshl_b32 s29, s30, 3
    s_mul_i32 s32, s73, 327680
    s_add_u32 s29, s29, s32
    v_lshl_add_u32 v15, v6, 14, v7
    v_lshl_add_u32 v14, v6, 15, v7
    s_add_u32 s32, s29, 0
    buffer_load_dwordx2 v[212:213], v14, s[8:11], s32 offen sc1
    s_add_u32 s32, s29, 16384
    buffer_load_dwordx2 v[214:215], v14, s[8:11], s32 offen sc1
    s_add_u32 s32, s29, 131072
    buffer_load_dwordx2 v[216:217], v14, s[8:11], s32 offen sc1
    s_add_u32 s32, s29, 147456
    buffer_load_dwordx2 v[218:219], v14, s[8:11], s32 offen sc1
    s_add_u32 s32, s29, 262144
    buffer_load_dwordx2 v[220:221], v15, s[8:11], s32 offen sc1
    s_mov_b32 s16, s64
    s_nop 0
    s_and_b32 s17, s65, 0xffff
    s_mov_b32 s18, 0x280000
    s_mov_b32 s19, 0x20000
    s_mul_i32 s40, s25, 24576
    s_add_u32 s40, s40, 9437184
    s_mul_i32 s31, s30, 1280
    s_mul_i32 s32, s73, 160
    s_add_u32 s31, s31, s32
    s_add_u32 s28, s28, 32768
    v_add_u32 v45, 32768, v48
    v_add_u32 v50, s40, v2
    v_add_u32 v51, 4096, v50
    v_add_u32 v52, 8192, v50
    v_add_u32 v53, 12288, v50
    v_add_u32 v54, 16384, v50
    v_add_u32 v55, 20480, v50
    s_waitcnt vmcnt(6)
    s_mov_b64 exec, 1
    buffer_store_dword v0, v12, s[8:11], s28 offen sc1
    s_nop 0
    s_mov_b64 exec, -1
    s_waitcnt vmcnt(1)
    s_barrier
    buffer_load_dword v49, v48, s[8:11], s24 offen sc1
    ds_read_b128 v[152:155], v2 offset:0
    ds_read_b128 v[156:159], v2 offset:1024
    ds_read_b128 v[160:163], v2 offset:2048
    ds_read_b128 v[164:167], v2 offset:3072
    ds_read_b128 v[168:171], v2 offset:4096
    ds_read_b128 v[172:175], v2 offset:5120
    ds_read_b128 v[176:179], v2 offset:6144
    ds_read_b128 v[180:183], v2 offset:7168
    ds_read_b128 v[184:187], v2 offset:8192
    ds_read_b128 v[188:191], v2 offset:9216
    v_lshlrev_b32_e64 v16, 16, v212
    v_and_b32 v17, 0xffff0000, v212
    v_lshlrev_b32_e64 v18, 16, v213
    v_and_b32 v19, 0xffff0000, v213
    v_lshlrev_b32_e64 v20, 16, v214
    v_and_b32 v21, 0xffff0000, v214
    v_lshlrev_b32_e64 v22, 16, v215
    v_and_b32 v23, 0xffff0000, v215
    v_lshlrev_b32_e64 v24, 16, v216
    v_and_b32 v25, 0xffff0000, v216
    v_lshlrev_b32_e64 v26, 16, v217
    v_and_b32 v27, 0xffff0000, v217
    v_lshlrev_b32_e64 v28, 16, v218
    v_and_b32 v29, 0xffff0000, v218
    v_lshlrev_b32_e64 v30, 16, v219
    v_and_b32 v31, 0xffff0000, v219
    v_lshlrev_b32_e64 v32, 16, v220
    v_and_b32 v33, 0xffff0000, v220
    v_lshlrev_b32_e64 v34, 16, v221
    v_and_b32 v35, 0xffff0000, v221
    s_mul_i32 s30, s20, 2816
    s_add_u32 s30, s30, 147456
    v_mul_u32_u24 v8, 176, v5
    v_add_u32_e64 v8, s30, v8
    v_lshl_add_u32 v46, v6, 3, v8
    v_lshl_add_u32 v8, v6, 4, v8
    v_add_u32_e64 v15, 0, v0
    v_min_u32 v15, 159, v15
    v_mul_u32_u24 v47, 6554, v15
    v_lshrrev_b32 v47, 16, v47
    v_add_u32 v12, v15, v47
    v_lshl_add_u32 v12, v12, 4, s30
    v_mul_u32_u24 v47, 2400, v47
    v_lshl_add_u32 v10, v15, 4, v47
    v_add_u32_e64 v15, 64, v0
    v_min_u32 v15, 159, v15
    v_mul_u32_u24 v47, 6554, v15
    v_lshrrev_b32 v47, 16, v47
    v_add_u32 v13, v15, v47
    v_lshl_add_u32 v13, v13, 4, s30
    v_mul_u32_u24 v47, 2400, v47
    v_lshl_add_u32 v11, v15, 4, v47
    v_add_u32 v15, 128, v0
    v_min_u32 v15, 159, v15
    v_mul_u32_u24 v47, 6554, v15
    v_lshrrev_b32 v47, 16, v47
    v_add_u32 v1, v15, v47
    v_lshl_add_u32 v1, v1, 4, s30
    v_mul_u32_u24 v47, 2400, v47
    v_lshl_add_u32 v14, v15, 4, v47
    s_waitcnt vmcnt(0)
    v_cmp_eq_u32_e64 vcc, -1, v49
    s_cbranch_vccnz S4_r
S4_d:
    buffer_load_dwordx4 v[56:59], v50, s[8:11], 0 offen offset:0 sc1
    buffer_load_dwordx4 v[60:63], v50, s[8:11], 0 offen offset:2048 sc1
    buffer_load_dwordx4 v[64:67], v50, s[8:11], 0 offen offset:3072 sc1
    buffer_load_dwordx4 v[68:71], v51, s[8:11], 0 offen offset:1024 sc1
    buffer_load_dwordx4 v[72:75], v51, s[8:11], 0 offen offset:2048 sc1
    buffer_load_dwordx4 v[76:79], v52, s[8:11], 0 offen offset:0 sc1
    buffer_load_dwordx4 v[80:83], v52, s[8:11], 0 offen offset:1024 sc1
    buffer_load_dword v44, v45, s[8:11], s24 offen sc1
    buffer_load_dwordx4 v[84:87], v52, s[8:11], 0 offen offset:3072 sc1
    buffer_load_dwordx4 v[88:91], v53, s[8:11], 0 offen offset:0 sc1
    s_waitcnt vmcnt(9)
    s_waitcnt lgkmcnt(5)
    v_mfma_f32_16x16x32_bf16 v[16:19], v[152:155], v[56:59], v[16:19]
    ds_read_b128 v[192:195], v2 offset:10240
    buffer_load_dwordx4 v[92:95], v53, s[8:11], 0 offen offset:2048 sc1
    v_mfma_f32_16x16x32_bf16 v[20:23], v[156:159], v[56:59], v[20:23]
    ds_read_b128 v[196:199], v2 offset:11264
    buffer_load_dwordx4 v[96:99], v53, s[8:11], 0 offen offset:3072 sc1
    v_mfma_f32_16x16x32_bf16 v[24:27], v[160:163], v[56:59], v[24:27]
    ds_read_b128 v[200:203], v2 offset:12288
    buffer_load_dwordx4 v[100:103], v54, s[8:11], 0 offen offset:1024 sc1
    v_mfma_f32_16x16x32_bf16 v[28:31], v[164:167], v[56:59], v[28:31]
    ds_read_b128 v[204:207], v2 offset:13312
    v_mfma_f32_16x16x32_bf16 v[32:35], v[168:171], v[56:59], v[32:35]
    ds_read_b128 v[208:211], v2 offset:14336
    s_waitcnt vmcnt(11)
    s_waitcnt lgkmcnt(5)
    v_mfma_f32_16x16x32_bf16 v[16:19], v[172:175], v[60:63], v[16:19]
    ds_read_b128 v[152:155], v2 offset:15360
    buffer_load_dwordx4 v[104:107], v54, s[8:11], 0 offen offset:2048 sc1
    v_mfma_f32_16x16x32_bf16 v[20:23], v[176:179], v[60:63], v[20:23]
    ds_read_b128 v[156:159], v2 offset:16384
    buffer_load_dwordx4 v[108:111], v55, s[8:11], 0 offen offset:0 sc1
    v_mfma_f32_16x16x32_bf16 v[24:27], v[180:183], v[60:63], v[24:27]
    ds_read_b128 v[160:163], v2 offset:17408
    buffer_load_dwordx4 v[112:115], v55, s[8:11], 0 offen offset:1024 sc1
    v_mfma_f32_16x16x32_bf16 v[28:31], v[184:187], v[60:63], v[28:31]
    ds_read_b128 v[164:167], v3 offset:32768
    v_mfma_f32_16x16x32_bf16 v[32:35], v[188:191], v[60:63], v[32:35]
    ds_read_b128 v[168:171], v3 offset:33792
    s_waitcnt vmcnt(13)
    s_waitcnt lgkmcnt(5)
    v_mfma_f32_16x16x32_bf16 v[16:19], v[192:195], v[64:67], v[16:19]
    ds_read_b128 v[172:175], v2 offset:18432
    buffer_load_dwordx4 v[116:119], v55, s[8:11], 0 offen offset:3072 sc1
    v_mfma_f32_16x16x32_bf16 v[20:23], v[196:199], v[64:67], v[20:23]
    ds_read_b128 v[176:179], v2 offset:19456
    v_mfma_f32_16x16x32_bf16 v[24:27], v[200:203], v[64:67], v[24:27]
    ds_read_b128 v[180:183], v2 offset:20480
    v_mfma_f32_16x16x32_bf16 v[28:31], v[204:207], v[64:67], v[28:31]
    ds_read_b128 v[184:187], v2 offset:21504
    v_mfma_f32_16x16x32_bf16 v[32:35], v[208:211], v[64:67], v[32:35]
    ds_read_b128 v[188:191], v2 offset:22528
    s_waitcnt vmcnt(9)
    v_cmp_eq_u32 vcc, -1, v44
    s_cbranch_vccnz S5_r
S5_d:
    s_waitcnt lgkmcnt(5)
    v_mfma_f32_16x16x32_bf16 v[16:19], v[152:155], v[68:71], v[16:19]
    ds_read_b128 v[192:195], v2 offset:23552
    buffer_load_dwordx4 v[120:123], v50, s[8:11], 0 offen offset:1024 sc1
    v_mfma_f32_16x16x32_bf16 v[20:23], v[156:159], v[68:71], v[20:23]
    ds_read_b128 v[196:199], v2 offset:24576
    buffer_load_dwordx4 v[124:127], v51, s[8:11], 0 offen offset:0 sc1
    v_mfma_f32_16x16x32_bf16 v[24:27], v[160:163], v[68:71], v[24:27]
    ds_read_b128 v[200:203], v2 offset:25600
    buffer_load_dwordx4 v[128:131], v51, s[8:11], 0 offen offset:3072 sc1
    v_mfma_f32_16x16x32_bf16 v[28:31], v[164:167], v[68:71], v[28:31]
    ds_read_b128 v[204:207], v2 offset:26624
    s_nop 0
    v_mfma_f32_16x16x32_bf16 v[32:35], v[168:171], v[68:71], v[32:35]
    ds_read_b128 v[208:211], v2 offset:27648
    s_waitcnt lgkmcnt(5)
    v_mfma_f32_16x16x32_bf16 v[16:19], v[172:175], v[72:75], v[16:19]
    ds_read_b128 v[152:155], v2 offset:28672
    buffer_load_dwordx4 v[132:135], v52, s[8:11], 0 offen offset:2048 sc1
    v_mfma_f32_16x16x32_bf16 v[20:23], v[176:179], v[72:75], v[20:23]
    ds_read_b128 v[156:159], v2 offset:29696
    buffer_load_dwordx4 v[136:139], v53, s[8:11], 0 offen offset:1024 sc1
    v_mfma_f32_16x16x32_bf16 v[24:27], v[180:183], v[72:75], v[24:27]
    ds_read_b128 v[160:163], v2 offset:30720
    buffer_load_dwordx4 v[140:143], v54, s[8:11], 0 offen offset:0 sc1
    v_mfma_f32_16x16x32_bf16 v[28:31], v[184:187], v[72:75], v[28:31]
    ds_read_b128 v[164:167], v2 offset:31744
    s_nop 0
    v_mfma_f32_16x16x32_bf16 v[32:35], v[188:191], v[72:75], v[32:35]
    ds_read_b128 v[168:171], v2 offset:32768
    s_waitcnt lgkmcnt(5)
    v_mfma_f32_16x16x32_bf16 v[16:19], v[192:195], v[76:79], v[16:19]
    ds_read_b128 v[172:175], v2 offset:33792
    buffer_load_dwordx4 v[144:147], v54, s[8:11], 0 offen offset:3072 sc1
    v_mfma_f32_16x16x32_bf16 v[20:23], v[196:199], v[76:79], v[20:23]
    ds_read_b128 v[176:179], v2 offset:34816
    buffer_load_dwordx4 v[148:151], v55, s[8:11], 0 offen offset:2048 sc1
    v_mfma_f32_16x16x32_bf16 v[24:27], v[200:203], v[76:79], v[24:27]
    ds_read_b128 v[180:183], v2 offset:35840
    v_mfma_f32_16x16x32_bf16 v[28:31], v[204:207], v[76:79], v[28:31]
    ds_read_b128 v[184:187], v3 offset:35840
    v_mfma_f32_16x16x32_bf16 v[32:35], v[208:211], v[76:79], v[32:35]
    ds_read_b128 v[188:191], v3 offset:36864
    s_waitcnt lgkmcnt(5)
    v_mfma_f32_16x16x32_bf16 v[16:19], v[152:155], v[80:83], v[16:19]
    ds_read_b128 v[192:195], v2 offset:36864
    v_mfma_f32_16x16x32_bf16 v[20:23], v[156:159], v[80:83], v[20:23]
    ds_read_b128 v[196:199], v2 offset:37888
    v_mfma_f32_16x16x32_bf16 v[24:27], v[160:163], v[80:83], v[24:27]
    ds_read_b128 v[200:203], v2 offset:38912
    v_mfma_f32_16x16x32_bf16 v[28:31], v[164:167], v[80:83], v[28:31]
    s_nop 0
    ds_read_b128 v[204:207], v2 offset:39936
    v_mfma_f32_16x16x32_bf16 v[32:35], v[168:171], v[80:83], v[32:35]
    ds_read_b128 v[208:211], v2 offset:40960
    s_waitcnt vmcnt(16)
    s_waitcnt lgkmcnt(5)
    v_mfma_f32_16x16x32_bf16 v[16:19], v[172:175], v[84:87], v[16:19]
    ds_read_b128 v[152:155], v2 offset:41984
    v_mfma_f32_16x16x32_bf16 v[20:23], v[176:179], v[84:87], v[20:23]
    ds_read_b128 v[156:159], v2 offset:43008
    v_mfma_f32_16x16x32_bf16 v[24:27], v[180:183], v[84:87], v[24:27]
    ds_read_b128 v[160:163], v2 offset:44032
    v_mfma_f32_16x16x32_bf16 v[28:31], v[184:187], v[84:87], v[28:31]
    ds_read_b128 v[164:167], v2 offset:45056
    v_mfma_f32_16x16x32_bf16 v[32:35], v[188:191], v[84:87], v[32:35]
    ds_read_b128 v[168:171], v2 offset:46080
    s_waitcnt vmcnt(15)
    s_waitcnt lgkmcnt(5)
    v_mfma_f32_16x16x32_bf16 v[16:19], v[192:195], v[88:91], v[16:19]
    ds_read_b128 v[172:175], v2 offset:47104
    v_mfma_f32_16x16x32_bf16 v[20:23], v[196:199], v[88:91], v[20:23]
    ds_read_b128 v[176:179], v2 offset:48128
    v_mfma_f32_16x16x32_bf16 v[24:27], v[200:203], v[88:91], v[24:27]
    ds_read_b128 v[180:183], v2 offset:49152
    v_mfma_f32_16x16x32_bf16 v[28:31], v[204:207], v[88:91], v[28:31]
    ds_read_b128 v[184:187], v2 offset:50176
    v_mfma_f32_16x16x32_bf16 v[32:35], v[208:211], v[88:91], v[32:35]
    ds_read_b128 v[188:191], v2 offset:51200
    s_waitcnt vmcnt(14)
    s_waitcnt lgkmcnt(5)
    v_mfma_f32_16x16x32_bf16 v[16:19], v[152:155], v[92:95], v[16:19]
    ds_read_b128 v[192:195], v2 offset:52224
    v_mfma_f32_16x16x32_bf16 v[20:23], v[156:159], v[92:95], v[20:23]
    ds_read_b128 v[196:199], v2 offset:53248
    v_mfma_f32_16x16x32_bf16 v[24:27], v[160:163], v[92:95], v[24:27]
    ds_read_b128 v[200:203], v2 offset:54272
    v_mfma_f32_16x16x32_bf16 v[28:31], v[164:167], v[92:95], v[28:31]
    ds_read_b128 v[204:207], v3 offset:38912
    v_mfma_f32_16x16x32_bf16 v[32:35], v[168:171], v[92:95], v[32:35]
    ds_read_b128 v[208:211], v3 offset:39936
    s_waitcnt vmcnt(13)
    s_waitcnt lgkmcnt(5)
    v_mfma_f32_16x16x32_bf16 v[16:19], v[172:175], v[96:99], v[16:19]
    ds_read_b128 v[152:155], v2 offset:55296
    v_mfma_f32_16x16x32_bf16 v[20:23], v[176:179], v[96:99], v[20:23]
    ds_read_b128 v[156:159], v2 offset:56320
    v_mfma_f32_16x16x32_bf16 v[24:27], v[180:183], v[96:99], v[24:27]
    ds_read_b128 v[160:163], v2 offset:57344
    v_mfma_f32_16x16x32_bf16 v[28:31], v[184:187], v[96:99], v[28:31]
    ds_read_b128 v[164:167], v2 offset:58368
    v_mfma_f32_16x16x32_bf16 v[32:35], v[188:191], v[96:99], v[32:35]
    ds_read_b128 v[168:171], v2 offset:59392
    s_waitcnt vmcnt(12)
    s_waitcnt lgkmcnt(5)
    v_mfma_f32_16x16x32_bf16 v[16:19], v[192:195], v[100:103], v[16:19]
    ds_read_b128 v[172:175], v2 offset:60416
    v_mfma_f32_16x16x32_bf16 v[20:23], v[196:199], v[100:103], v[20:23]
    ds_read_b128 v[176:179], v2 offset:61440
    v_mfma_f32_16x16x32_bf16 v[24:27], v[200:203], v[100:103], v[24:27]
    ds_read_b128 v[180:183], v2 offset:62464
    v_mfma_f32_16x16x32_bf16 v[28:31], v[204:207], v[100:103], v[28:31]
    ds_read_b128 v[184:187], v2 offset:63488
    v_mfma_f32_16x16x32_bf16 v[32:35], v[208:211], v[100:103], v[32:35]
    ds_read_b128 v[188:191], v2 offset:64512
    s_waitcnt vmcnt(11)
    s_waitcnt lgkmcnt(5)
    v_mfma_f32_16x16x32_bf16 v[16:19], v[152:155], v[104:107], v[16:19]
    ds_read_b128 v[192:195], v3 offset:0
    v_mfma_f32_16x16x32_bf16 v[20:23], v[156:159], v[104:107], v[20:23]
    ds_read_b128 v[196:199], v3 offset:1024
    v_mfma_f32_16x16x32_bf16 v[24:27], v[160:163], v[104:107], v[24:27]
    ds_read_b128 v[200:203], v3 offset:2048
    v_mfma_f32_16x16x32_bf16 v[28:31], v[164:167], v[104:107], v[28:31]
    ds_read_b128 v[204:207], v3 offset:3072
    v_mfma_f32_16x16x32_bf16 v[32:35], v[168:171], v[104:107], v[32:35]
    ds_read_b128 v[208:211], v3 offset:4096
    s_waitcnt vmcnt(10)
    s_waitcnt lgkmcnt(5)
    v_mfma_f32_16x16x32_bf16 v[16:19], v[172:175], v[108:111], v[16:19]
    ds_read_b128 v[152:155], v3 offset:5120
    v_mfma_f32_16x16x32_bf16 v[20:23], v[176:179], v[108:111], v[20:23]
    ds_read_b128 v[156:159], v3 offset:6144
    v_mfma_f32_16x16x32_bf16 v[24:27], v[180:183], v[108:111], v[24:27]
    ds_read_b128 v[160:163], v3 offset:7168
    v_mfma_f32_16x16x32_bf16 v[28:31], v[184:187], v[108:111], v[28:31]
    ds_read_b128 v[164:167], v3 offset:41984
    v_mfma_f32_16x16x32_bf16 v[32:35], v[188:191], v[108:111], v[32:35]
    ds_read_b128 v[168:171], v3 offset:43008
    s_waitcnt vmcnt(9)
    s_waitcnt lgkmcnt(5)
    v_mfma_f32_16x16x32_bf16 v[16:19], v[192:195], v[112:115], v[16:19]
    ds_read_b128 v[172:175], v3 offset:34816
    v_mfma_f32_16x16x32_bf16 v[20:23], v[196:199], v[112:115], v[20:23]
    ds_read_b128 v[176:179], v3 offset:45056
    v_mfma_f32_16x16x32_bf16 v[24:27], v[200:203], v[112:115], v[24:27]
    ds_read_b128 v[180:183], v3 offset:46080
    v_mfma_f32_16x16x32_bf16 v[28:31], v[204:207], v[112:115], v[28:31]
    ds_read_b128 v[184:187], v3 offset:47104
    v_mfma_f32_16x16x32_bf16 v[32:35], v[208:211], v[112:115], v[32:35]
    ds_read_b128 v[188:191], v3 offset:57344
    s_waitcnt vmcnt(8)
    s_waitcnt lgkmcnt(5)
    v_mfma_f32_16x16x32_bf16 v[16:19], v[152:155], v[116:119], v[16:19]
    ds_read_b128 v[192:195], v3 offset:58368
    v_mfma_f32_16x16x32_bf16 v[20:23], v[156:159], v[116:119], v[20:23]
    ds_read_b128 v[196:199], v3 offset:59392
    v_mfma_f32_16x16x32_bf16 v[24:27], v[160:163], v[116:119], v[24:27]
    ds_read_b128 v[200:203], v4 offset:4096
    v_mfma_f32_16x16x32_bf16 v[28:31], v[164:167], v[116:119], v[28:31]
    ds_read_b128 v[204:207], v4 offset:5120
    v_mfma_f32_16x16x32_bf16 v[32:35], v[168:171], v[116:119], v[32:35]
    ds_read_b128 v[208:211], v4 offset:6144
    s_waitcnt vmcnt(7)
    s_waitcnt lgkmcnt(5)
    v_mfma_f32_16x16x32_bf16 v[16:19], v[172:175], v[120:123], v[16:19]
    ds_read_b128 v[152:155], v3 offset:37888
    v_mfma_f32_16x16x32_bf16 v[20:23], v[176:179], v[120:123], v[20:23]
    ds_read_b128 v[156:159], v3 offset:48128
    v_mfma_f32_16x16x32_bf16 v[24:27], v[180:183], v[120:123], v[24:27]
    ds_read_b128 v[160:163], v3 offset:49152
    v_mfma_f32_16x16x32_bf16 v[28:31], v[184:187], v[120:123], v[28:31]
    ds_read_b128 v[164:167], v3 offset:50176
    v_mfma_f32_16x16x32_bf16 v[32:35], v[188:191], v[120:123], v[32:35]
    ds_read_b128 v[168:171], v3 offset:60416
    s_waitcnt vmcnt(6)
    s_waitcnt lgkmcnt(5)
    v_mfma_f32_16x16x32_bf16 v[16:19], v[192:195], v[124:127], v[16:19]
    ds_read_b128 v[172:175], v3 offset:61440
    v_mfma_f32_16x16x32_bf16 v[20:23], v[196:199], v[124:127], v[20:23]
    ds_read_b128 v[176:179], v3 offset:62464
    v_mfma_f32_16x16x32_bf16 v[24:27], v[200:203], v[124:127], v[24:27]
    ds_read_b128 v[180:183], v4 offset:7168
    v_mfma_f32_16x16x32_bf16 v[28:31], v[204:207], v[124:127], v[28:31]
    ds_read_b128 v[184:187], v4 offset:8192
    v_mfma_f32_16x16x32_bf16 v[32:35], v[208:211], v[124:127], v[32:35]
    ds_read_b128 v[188:191], v4 offset:9216
    s_waitcnt vmcnt(5)
    s_waitcnt lgkmcnt(5)
    v_mfma_f32_16x16x32_bf16 v[16:19], v[152:155], v[128:131], v[16:19]
    ds_read_b128 v[192:195], v3 offset:40960
    v_mfma_f32_16x16x32_bf16 v[20:23], v[156:159], v[128:131], v[20:23]
    ds_read_b128 v[196:199], v3 offset:51200
    v_mfma_f32_16x16x32_bf16 v[24:27], v[160:163], v[128:131], v[24:27]
    ds_read_b128 v[200:203], v3 offset:52224
    v_mfma_f32_16x16x32_bf16 v[28:31], v[164:167], v[128:131], v[28:31]
    ds_read_b128 v[204:207], v3 offset:53248
    v_mfma_f32_16x16x32_bf16 v[32:35], v[168:171], v[128:131], v[32:35]
    ds_read_b128 v[208:211], v3 offset:63488
    s_waitcnt vmcnt(4)
    s_waitcnt lgkmcnt(5)
    v_mfma_f32_16x16x32_bf16 v[16:19], v[172:175], v[132:135], v[16:19]
    ds_read_b128 v[152:155], v3 offset:64512
    v_mfma_f32_16x16x32_bf16 v[20:23], v[176:179], v[132:135], v[20:23]
    ds_read_b128 v[156:159], v4 offset:0
    v_mfma_f32_16x16x32_bf16 v[24:27], v[180:183], v[132:135], v[24:27]
    ds_read_b128 v[160:163], v4 offset:10240
    v_mfma_f32_16x16x32_bf16 v[28:31], v[184:187], v[132:135], v[28:31]
    ds_read_b128 v[164:167], v4 offset:11264
    v_mfma_f32_16x16x32_bf16 v[32:35], v[188:191], v[132:135], v[32:35]
    ds_read_b128 v[168:171], v4 offset:12288
    s_waitcnt vmcnt(3)
    s_waitcnt lgkmcnt(5)
    v_mfma_f32_16x16x32_bf16 v[16:19], v[192:195], v[136:139], v[16:19]
    ds_read_b128 v[172:175], v3 offset:44032
    v_mfma_f32_16x16x32_bf16 v[20:23], v[196:199], v[136:139], v[20:23]
    ds_read_b128 v[176:179], v3 offset:54272
    v_mfma_f32_16x16x32_bf16 v[24:27], v[200:203], v[136:139], v[24:27]
    ds_read_b128 v[180:183], v3 offset:55296
    v_mfma_f32_16x16x32_bf16 v[28:31], v[204:207], v[136:139], v[28:31]
    ds_read_b128 v[184:187], v3 offset:56320
    v_mfma_f32_16x16x32_bf16 v[32:35], v[208:211], v[136:139], v[32:35]
    ds_read_b128 v[188:191], v4 offset:1024
    s_waitcnt vmcnt(2)
    s_waitcnt lgkmcnt(5)
    v_mfma_f32_16x16x32_bf16 v[16:19], v[152:155], v[140:143], v[16:19]
    ds_read_b128 v[192:195], v4 offset:2048
    v_mfma_f32_16x16x32_bf16 v[20:23], v[156:159], v[140:143], v[20:23]
    ds_read_b128 v[196:199], v4 offset:3072
    v_mfma_f32_16x16x32_bf16 v[24:27], v[160:163], v[140:143], v[24:27]
    ds_read_b128 v[200:203], v4 offset:13312
    v_mfma_f32_16x16x32_bf16 v[28:31], v[164:167], v[140:143], v[28:31]
    ds_read_b128 v[204:207], v4 offset:14336
    v_mfma_f32_16x16x32_bf16 v[32:35], v[168:171], v[140:143], v[32:35]
    ds_read_b128 v[208:211], v4 offset:15360
    s_waitcnt vmcnt(1)
    s_waitcnt lgkmcnt(5)
    v_mfma_f32_16x16x32_bf16 v[16:19], v[172:175], v[144:147], v[16:19]
    v_mfma_f32_16x16x32_bf16 v[20:23], v[176:179], v[144:147], v[20:23]
    v_mfma_f32_16x16x32_bf16 v[24:27], v[180:183], v[144:147], v[24:27]
    v_mfma_f32_16x16x32_bf16 v[28:31], v[184:187], v[144:147], v[28:31]
    v_mfma_f32_16x16x32_bf16 v[32:35], v[188:191], v[144:147], v[32:35]
    s_waitcnt vmcnt(0)
    s_waitcnt lgkmcnt(0)
    v_mfma_f32_16x16x32_bf16 v[16:19], v[192:195], v[148:151], v[16:19]
    s_nop 0
    v_mfma_f32_16x16x32_bf16 v[20:23], v[196:199], v[148:151], v[20:23]
    v_mfma_f32_16x16x32_bf16 v[24:27], v[200:203], v[148:151], v[24:27]
    v_mfma_f32_16x16x32_bf16 v[28:31], v[204:207], v[148:151], v[28:31]
    v_mfma_f32_16x16x32_bf16 v[32:35], v[208:211], v[148:151], v[32:35]
    s_nop 3
    v_cvt_pk_bf16_f32 v36, v16, v17
    v_cvt_pk_bf16_f32 v37, v18, v19
    v_cvt_pk_bf16_f32 v38, v20, v21
    v_cvt_pk_bf16_f32 v39, v22, v23
    v_cvt_pk_bf16_f32 v40, v24, v25
    v_cvt_pk_bf16_f32 v41, v26, v27
    v_cvt_pk_bf16_f32 v42, v28, v29
    v_cvt_pk_bf16_f32 v43, v30, v31
    v_cvt_pk_bf16_f32 v44, v32, v33
    v_cvt_pk_bf16_f32 v45, v34, v35
    ds_write_b128 v8, v[36:39]
L_pg8:
    s_cbranch_execz L_wr
    s_nop 0
    ds_write_b128 v8, v[40:43] offset:64
    ds_write_b64 v46, v[44:45] offset:128
    ds_read_b128 v[52:55], v12
    ds_read_b128 v[56:59], v13
    ds_read_b128 v[60:63], v1
    s_waitcnt lgkmcnt(2)
    buffer_store_dwordx4 v[52:55], v10, s[16:19], s31 offen
    s_waitcnt lgkmcnt(1)
    buffer_store_dwordx4 v[56:59], v11, s[16:19], s31 offen
    s_mov_b32 exec_hi, 0
    s_waitcnt lgkmcnt(0)
    buffer_store_dwordx4 v[60:63], v14, s[16:19], s31 offen
L_end:
    s_endpgm
S1_r:
    s_mov_b32 s35, 0x3ffff
S1_l:
    s_sleep 1
    global_load_dword v29, v3, s[66:67] sc1
    s_waitcnt vmcnt(0)
    v_cmp_gt_u32 vcc, 16, v29
    s_cbranch_vccz S1_x
    s_sub_u32 s35, s35, 1
    s_cbranch_scc0 S1_l
S1_x:
    s_branch S1_d
S1b_r:
    s_mov_b32 s35, 0x3ffff
S1b_l:
    s_sleep 1
    buffer_load_dword v14, v15, s[8:11], s29 offen sc1
    s_waitcnt vmcnt(0)
    v_cmp_eq_u32 vcc, -1, v14
    s_cbranch_vccz S1b_x
    s_sub_u32 s35, s35, 1
    s_cbranch_scc0 S1b_l
S1b_x:
    s_branch S1b_d
H2p_r:
    s_mov_b32 s35, 0x3ffff
H2p_l:
    s_sleep 4
    buffer_load_dword v41, off, s[8:11], s34 sc1
    s_waitcnt vmcnt(0)
    v_cmp_eq_u32 vcc, -1, v41
    s_cbranch_vccz H2p_x
    s_sub_u32 s35, s35, 1
    s_cbranch_scc0 H2p_l
H2p_x:
    s_sleep 7
    s_branch H2p_d
S2_r:
    s_mov_b32 s35, 0x3ffff
S2_l:
    s_sleep 1
    buffer_load_dword v41, v40, s[8:11], 0 offen sc1
    s_waitcnt vmcnt(0)
    v_cmp_eq_u32 vcc, -1, v41
    s_cbranch_vccz S2_x
    s_sub_u32 s35, s35, 1
    s_cbranch_scc0 S2_l
S2_x:
    s_branch S2_d
L2_r:
    s_mov_b32 s35, 0x3ffff
L2_l:
    s_sleep 1
    buffer_load_dwordx4 v[84:87], v2, s[8:11], s33 offen sc1
    s_waitcnt vmcnt(0)
    v_max3_u32 v92, v84, v85, v86
    v_max_u32 v92, v92, v87
    v_cmp_eq_u32 vcc, -1, v92
    s_cbranch_vccz L2_x
    s_sub_u32 s35, s35, 1
    s_cbranch_scc0 L2_l
L2_x:
    s_branch L2_d
L3_r:
    s_mov_b32 s35, 0x3ffff
L3_l:
    s_sleep 1
    buffer_load_dwordx4 v[222:225], v1, s[8:11], 0 offen offset:0 sc1
    buffer_load_dwordx4 v[226:229], v1, s[8:11], 0 offen offset:1024 sc1
    buffer_load_dwordx4 v[230:233], v1, s[8:11], 0 offen offset:2048 sc1
    buffer_load_dwordx4 v[234:237], v1, s[8:11], 0 offen offset:3072 sc1
    s_waitcnt vmcnt(0)
    v_max3_u32 v92, v222, v223, v224
    v_max3_u32 v92, v92, v225, v226
    v_max3_u32 v92, v92, v227, v228
    v_max3_u32 v92, v92, v229, v230
    v_max3_u32 v92, v92, v231, v232
    v_max3_u32 v92, v92, v233, v234
    v_max3_u32 v92, v92, v235, v236
    v_max_u32 v92, v92, v237
    v_cmp_eq_u32 vcc, -1, v92
    s_cbranch_vccz L3_x
    s_sub_u32 s35, s35, 1
    s_cbranch_scc0 L3_l
L3_x:
    s_branch L3_d
S3_r:
    s_mov_b32 s35, 0x3ffff
S3_l:
    s_sleep 1
    buffer_load_dword v89, v7, s[8:11], 0 offen sc1
    s_waitcnt vmcnt(0)
    v_cmp_eq_u32 vcc, -1, v89
    s_cbranch_vccz S3_x
    s_sub_u32 s35, s35, 1
    s_cbranch_scc0 S3_l
S3_x:
    s_branch S3_d
X0_r:
    s_mov_b32 s35, 0x3ffff
X0_l:
    s_sleep 1
    buffer_load_dwordx4 v[180:183], v2, s[8:11], s86 offen offset:0 sc1
    buffer_load_dwordx4 v[184:187], v2, s[8:11], s86 offen offset:1024 sc1
    s_waitcnt vmcnt(0)
    v_max_u32 v92, v180, v181
    v_max3_u32 v92, v92, v182, v183
    v_max3_u32 v92, v92, v184, v185
    v_max3_u32 v92, v92, v186, v187
    v_cmp_eq_u32 vcc, -1, v92
    s_cbranch_vccz X0_x
    s_sub_u32 s35, s35, 1
    s_cbranch_scc0 X0_l
X0_x:
    s_branch X0_d
X1_r:
    s_mov_b32 s35, 0x3ffff
X1_l:
    s_sleep 1
    buffer_load_dwordx4 v[188:191], v2, s[8:11], s86 offen offset:2048 sc1
    s_waitcnt vmcnt(0)
    v_max_u32 v92, v188, v189
    v_max3_u32 v92, v92, v190, v191
    v_cmp_eq_u32 vcc, -1, v92
    s_cbranch_vccz X1_x
    s_sub_u32 s35, s35, 1
    s_cbranch_scc0 X1_l
X1_x:
    s_branch X1_d
S4_r:
    s_mov_b32 s35, 0x3ffff
S4_l:
    s_sleep 1
    buffer_load_dword v49, v48, s[8:11], s24 offen sc1
    s_waitcnt vmcnt(0)
    v_cmp_eq_u32 vcc, -1, v49
    s_cbranch_vccz S4_x
    s_sub_u32 s35, s35, 1
    s_cbranch_scc0 S4_l
S4_x:
    s_branch S4_d
S5_r:
    s_mov_b32 s35, 0x3ffff
S5_l:
    s_sleep 1
    buffer_load_dword v44, v45, s[8:11], s24 offen sc1
    s_waitcnt vmcnt(0)
    v_cmp_eq_u32 vcc, -1, v44
    s_cbranch_vccz S5_x
    s_sub_u32 s35, s35, 1
    s_cbranch_scc0 S5_l
S5_x:
    s_branch S5_d
L_help:
    v_lshlrev_b32 v2, 4, v0
    v_and_b32 v5, 15, v0
    v_lshrrev_b32 v6, 4, v0
    s_lshr_b32 s80, s21, 1
    s_and_b32 s79, s21, 1
    s_and_b32 s81, s22, 7
    s_lshr_b32 s82, s22, 3
    s_lshr_b32 s83, s81, 1
    s_add_u32 s82, s82, s83
    s_and_b32 s82, s82, 3
    s_lshl_b32 s70, s80, 2
    s_add_u32 s70, s70, s82
    s_lshl_b32 s71, s81, 1
    s_add_u32 s71, s71, s79
    s_lshl_b32 s72, s70, 1
    s_add_u32 s72, s72, s79
    s_mov_b32 s73, s81
    s_lshl_b32 s89, s80, 10
    s_add_u32 s89, s89, s79
    s_lshl_b32 s89, s89, 11
    s_lshl_b32 s78, s70, 2
    s_add_u32 s78, s78, s20
    s_lshl_b32 s74, s78, 17
    s_lshl_b32 s79, s79, 11
    s_add_u32 s74, s74, s79
    s_lshl_b32 s85, s78, 4
    s_add_u32 s85, s85, s71
    s_mul_i32 s86, s85, 3072
    s_add_u32 s86, s86, 12582912
    s_xor_b32 s87, s85, 1
    s_mul_i32 s87, s87, 3072
    s_add_u32 s87, s87, 12582912
    v_lshrrev_b32 v8, 3, v0
    v_lshrrev_b32 v9, 1, v8
    v_and_b32 v10, 7, v0
    v_xor_b32 v10, v10, v9
    v_lshlrev_b32 v8, 13, v8
    v_lshl_add_u32 v8, v10, 4, v8
    v_add_u32 v8, s74, v8
    v_xor_b32 v9, 64, v8
    v_add_u32 v10, 4096-2048, v8
    v_add_u32 v11, 65536+4096-3072, v9
    v_add_u32 v9, 65536-1024, v9
    s_mul_i32 s75, s20, 20480
    s_add_u32 s75, s75, 81920
    v_lshrrev_b32_e64 v12, 1, v5
    v_xor_b32 v12, v12, v6
    v_lshlrev_b32 v12, 4, v12
    v_lshl_add_u32 v12, v5, 7, v12
    v_add_u32 v12, s75, v12
    v_xor_b32 v13, 64, v12
    s_waitcnt lgkmcnt(0)
    s_mov_b32 s8, s68
    s_and_b32 s9, s69, 0xffff
    s_mov_b32 s10, 0xf00000
    s_mov_b32 s11, 0x20000
    s_mov_b32 s12, s58
    s_and_b32 s13, s59, 0xffff
    s_mov_b32 s14, 0x800000
    s_mov_b32 s15, 0x20000
    v_mov_b32 v56, -1
    v_mov_b32 v57, -1
    v_mov_b32 v58, -1
    v_mov_b32_e64 v59, -1
    v_lshlrev_b32 v4, 4, v1
    s_lshl_b32 s28, s23, 13
    s_add_u32 s28, s28, 5636096
    s_add_u32 s29, s28, 4096
    buffer_store_dwordx4 v[56:59], v4, s[8:11], s28 offen sc1
    buffer_store_dwordx4 v[56:59], v4, s[8:11], s29 offen sc1
    v_mov_b32 v62, 0x3f803f80
    v_lshrrev_b32_e64 v7, 1, v3
    v_lshlrev_b32 v7, 4, v7
    v_and_b32 v15, 1, v3
    v_lshl_add_u32 v7, v15, 2, v7
    v_lshl_add_u32 v7, v14, 3, v7
    v_cmp_eq_u32 vcc, 1, v14
    s_mov_b32 s28, 5603328
    s_waitcnt vmcnt(11)
    v_dot2_f32_bf16 v60, v16, v62, 0
    v_dot2_f32_bf16 v61, v16, v16, 0
    v_dot2_f32_bf16 v60, v17, v62, v60
    v_dot2_f32_bf16 v61, v17, v17, v61
    v_dot2_f32_bf16 v60, v18, v62, v60
    v_dot2_f32_bf16 v61, v18, v18, v61
    v_dot2_f32_bf16 v60, v19, v62, v60
    v_dot2_f32_bf16 v61, v19, v19, v61
    s_waitcnt vmcnt(10)
    v_dot2_f32_bf16 v60, v20, v62, v60
    v_dot2_f32_bf16 v61, v20, v20, v61
    v_dot2_f32_bf16 v60, v21, v62, v60
    v_dot2_f32_bf16 v61, v21, v21, v61
    v_dot2_f32_bf16 v60, v22, v62, v60
    v_dot2_f32_bf16 v61, v22, v22, v61
    v_dot2_f32_bf16 v60, v23, v62, v60
    v_dot2_f32_bf16 v61, v23, v23, v61
    s_waitcnt vmcnt(9)
    v_dot2_f32_bf16 v60, v24, v62, v60
    v_dot2_f32_bf16 v61, v24, v24, v61
    v_dot2_f32_bf16 v60, v25, v62, v60
    v_dot2_f32_bf16 v61, v25, v25, v61
    v_dot2_f32_bf16 v60, v26, v62, v60
    v_dot2_f32_bf16 v61, v26, v26, v61
    v_dot2_f32_bf16 v60, v27, v62, v60
    v_dot2_f32_bf16 v61, v27, v27, v61
    s_waitcnt vmcnt(8)
    v_dot2_f32_bf16 v60, v28, v62, v60
    v_dot2_f32_bf16 v61, v28, v28, v61
    v_dot2_f32_bf16 v60, v29, v62, v60
    v_dot2_f32_bf16 v61, v29, v29, v61
    v_dot2_f32_bf16 v60, v30, v62, v60
    v_dot2_f32_bf16 v61, v30, v30, v61
    v_dot2_f32_bf16 v60, v31, v62, v60
    v_dot2_f32_bf16 v61, v31, v31, v61
    s_waitcnt vmcnt(7)
    v_dot2_f32_bf16 v60, v32, v62, v60
    v_dot2_f32_bf16 v61, v32, v32, v61
    v_dot2_f32_bf16 v60, v33, v62, v60
    v_dot2_f32_bf16 v61, v33, v33, v61
    v_dot2_f32_bf16 v60, v34, v62, v60
    v_dot2_f32_bf16 v61, v34, v34, v61
    v_dot2_f32_bf16 v60, v35, v62, v60
    v_dot2_f32_bf16 v61, v35, v35, v61
    s_waitcnt vmcnt(6)
    v_dot2_f32_bf16 v60, v36, v62, v60
    v_dot2_f32_bf16 v61, v36, v36, v61
    v_dot2_f32_bf16 v60, v37, v62, v60
    v_dot2_f32_bf16 v61, v37, v37, v61
    v_dot2_f32_bf16 v60, v38, v62, v60
    v_dot2_f32_bf16 v61, v38, v38, v61
    v_dot2_f32_bf16 v60, v39, v62, v60
    v_dot2_f32_bf16 v61, v39, v39, v61
    s_waitcnt vmcnt(5)
    v_dot2_f32_bf16 v60, v40, v62, v60
    v_dot2_f32_bf16 v61, v40, v40, v61
    v_dot2_f32_bf16 v60, v41, v62, v60
    v_dot2_f32_bf16 v61, v41, v41, v61
    v_dot2_f32_bf16 v60, v42, v62, v60
    v_dot2_f32_bf16 v61, v42, v42, v61
    v_dot2_f32_bf16 v60, v43, v62, v60
    v_dot2_f32_bf16 v61, v43, v43, v61
    s_waitcnt vmcnt(4)
    v_dot2_f32_bf16 v60, v44, v62, v60
    v_dot2_f32_bf16 v61, v44, v44, v61
    v_dot2_f32_bf16 v60, v45, v62, v60
    v_dot2_f32_bf16 v61, v45, v45, v61
    v_dot2_f32_bf16 v60, v46, v62, v60
    v_dot2_f32_bf16 v61, v46, v46, v61
    v_dot2_f32_bf16 v60, v47, v62, v60
    v_dot2_f32_bf16 v61, v47, v47, v61
    s_waitcnt vmcnt(3)
    v_dot2_f32_bf16 v60, v48, v62, v60
    v_dot2_f32_bf16 v61, v48, v48, v61
    v_dot2_f32_bf16 v60, v49, v62, v60
    v_dot2_f32_bf16 v61, v49, v49, v61
    v_dot2_f32_bf16 v60, v50, v62, v60
    v_dot2_f32_bf16 v61, v50, v50, v61
    v_dot2_f32_bf16 v60, v51, v62, v60
    v_dot2_f32_bf16 v61, v51, v51, v61
    s_waitcnt vmcnt(2)
    v_dot2_f32_bf16 v60, v52, v62, v60
    v_dot2_f32_bf16 v61, v52, v52, v61
    v_dot2_f32_bf16 v60, v53, v62, v60
    v_dot2_f32_bf16 v61, v53, v53, v61
    v_dot2_f32_bf16 v60, v54, v62, v60
    v_dot2_f32_bf16 v61, v54, v54, v61
    v_dot2_f32_bf16 v60, v55, v62, v60
    v_dot2_f32_bf16 v61, v55, v55, v61
    s_nop 1
    v_add_f32_dpp v60, v60, v60 row_half_mirror row_mask:0xf bank_mask:0xf
    v_add_f32_dpp v61, v61, v61 row_half_mirror row_mask:0xf bank_mask:0xf
    s_nop 0
    v_add_f32_dpp v60, v60, v60 quad_perm:[2,3,0,1] row_mask:0xf bank_mask:0xf
    v_add_f32_dpp v61, v61, v61 quad_perm:[2,3,0,1] row_mask:0xf bank_mask:0xf
    s_nop 0
    v_add_f32_dpp v60, v60, v60 quad_perm:[1,0,3,2] row_mask:0xf bank_mask:0xf
    v_add_f32_dpp v61, v61, v61 quad_perm:[1,0,3,2] row_mask:0xf bank_mask:0xf
    v_mul_f32 v64, 0x3acccccd, v60
    v_mul_f32 v65, 0x3acccccd, v61
    v_fma_f32 v65, -v64, v64, v65
    v_max_f32_e64 v65, 0, v65
    v_cvt_pk_bf16_f32 v65, v65, v65
    v_lshlrev_b32_e64 v65, 16, v65
    v_add_f32 v65, 0x3727c5ac, v65
    v_cvt_pk_bf16_f32 v65, v65, v65
    v_lshlrev_b32 v65, 16, v65
    v_sqrt_f32 v65, v65
    v_cvt_pk_bf16_f32 v64, v64, v64
    v_lshlrev_b32_e64 v64, 16, v64
    v_cvt_pk_bf16_f32 v65, v65, v65
    v_lshlrev_b32_e64 v65, 16, v65
    v_rcp_f32 v63, v65
    s_nop 0
    v_mul_f32 v64, v64, v63
    v_cndmask_b32 v63, v63, v64, vcc
    s_mov_b32 exec_lo, 0x03030303
    s_mov_b32 exec_hi, 0x03030303
    buffer_store_dword v63, v7, s[8:11], s28 offen sc1
    s_mov_b64 exec, -1
    s_and_b32 s29, s2, 3
    s_lshl_b32 s29, s29, 6
    v_mov_b32 v66, s29
    v_mov_b32 v67, 1
    s_waitcnt vmcnt(0)
    s_barrier
    s_cmp_lg_u32 s20, 0
    s_cbranch_scc1 L_ar
    s_mov_b64 exec, 1
    global_atomic_add v66, v67, s[66:67] sc1
    s_mov_b64 exec, -1
L_ar:
    s_cmp_lt_u32 s23, 48
    s_cbranch_scc1 L_hout
    s_sub_u32 s34, s22, 20
    s_lshl_b32 s34, s34, 18
    s_add_u32 s33, s89, s34
    s_add_u32 s33, s33, 0
    v_lshrrev_b32 v60, 2, v1
    v_lshlrev_b32 v60, 12, v60
    v_and_b32 v61, 3, v1
    v_lshl_add_u32 v60, v61, 7, v60
    buffer_load_dword v61, v60, s[12:15], s33 offen
    s_sub_u32 s34, s22, 26
    s_lshl_b32 s34, s34, 20
    s_add_u32 s33, s89, s34
    s_add_u32 s33, s33, 512
    v_lshrrev_b32 v60, 1, v1
    v_lshlrev_b32 v60, 12, v60
    v_and_b32 v62, 1, v1
    v_lshl_add_u32 v60, v62, 7, v60
    buffer_load_dword v61, v60, s[12:15], s33 offen
    s_add_u32 s33, s33, 524288
    buffer_load_dword v61, v60, s[12:15], s33 offen
    s_waitcnt vmcnt(0)
    s_branch L_hdone
L_nostat:
    v_lshlrev_b32 v2, 4, v0
    v_and_b32 v5, 15, v0
    v_lshrrev_b32 v6, 4, v0
    s_lshr_b32 s80, s21, 1
    s_and_b32 s79, s21, 1
    s_and_b32 s81, s22, 7
    s_lshr_b32 s82, s22, 3
    s_lshr_b32 s83, s81, 1
    s_add_u32 s82, s82, s83
    s_and_b32 s82, s82, 3
    s_lshl_b32 s70, s80, 2
    s_add_u32 s70, s70, s82
    s_lshl_b32 s71, s81, 1
    s_add_u32 s71, s71, s79
    s_lshl_b32 s72, s70, 1
    s_add_u32 s72, s72, s79
    s_mov_b32 s73, s81
    s_lshl_b32 s89, s80, 10
    s_add_u32 s89, s89, s79
    s_lshl_b32 s89, s89, 11
    s_lshl_b32 s78, s70, 2
    s_add_u32 s78, s78, s20
    s_lshl_b32 s74, s78, 17
    s_lshl_b32 s79, s79, 11
    s_add_u32 s74, s74, s79
    s_lshl_b32 s85, s78, 4
    s_add_u32 s85, s85, s71
    s_mul_i32 s86, s85, 3072
    s_add_u32 s86, s86, 12582912
    s_xor_b32 s87, s85, 1
    s_mul_i32 s87, s87, 3072
    s_add_u32 s87, s87, 12582912
    v_lshrrev_b32 v8, 3, v0
    v_lshrrev_b32 v9, 1, v8
    v_and_b32 v10, 7, v0
    v_xor_b32 v10, v10, v9
    v_lshlrev_b32_e64 v8, 13, v8
    v_lshl_add_u32 v8, v10, 4, v8
    v_add_u32 v8, s74, v8
    v_xor_b32 v9, 64, v8
    v_add_u32 v10, 4096-2048, v8
    v_add_u32 v11, 65536+4096-3072, v9
    v_add_u32 v9, 65536-1024, v9
    s_mul_i32 s75, s20, 20480
    s_add_u32 s75, s75, 81920
    v_lshrrev_b32_e64 v12, 1, v5
    v_xor_b32 v12, v12, v6
    v_lshlrev_b32 v12, 4, v12
    v_lshl_add_u32 v12, v5, 7, v12
    v_add_u32 v12, s75, v12
    v_xor_b32 v13, 64, v12
    s_waitcnt lgkmcnt(0)
    s_mov_b32 s8, s68
    s_and_b32 s9, s69, 0xffff
    s_mov_b32 s10, 0xf00000
    s_mov_b32 s11, 0x20000
    s_mov_b32 s12, s58
    s_and_b32 s13, s59, 0xffff
    s_mov_b32 s14, 0x800000
    s_mov_b32 s15, 0x20000
    s_mov_b32 s16, s56
    s_and_b32 s17, s57, 0xffff
    s_mov_b32 s18, 0x1e0000
    s_mov_b32 s19, 0x20000
    s_and_b32 s25, s23, 7
    s_bfe_u32 s26, s23, 0x20003
    s_mul_i32 s27, s26, 491520
    s_mul_i32 s28, s20, 24576
    s_add_u32 s27, s27, s28
    s_mul_i32 s28, s25, 384
    s_add_u32 s27, s27, s28
    s_mul_i32 m0, s20, 3072
    v_add_u32 v7, 0, v0
    v_mul_u32_u24 v3, 2731, v7
    v_lshrrev_b32_e64 v3, 16, v3
    v_mul_u32_u24 v3, 2688, v3
    v_add_u32 v100, v2, v3
    v_add_u32 v7, 64, v0
    v_mul_u32_u24 v3, 2731, v7
    v_lshrrev_b32_e64 v3, 16, v3
    v_mul_u32_u24 v3, 2688, v3
    v_add_u32_e64 v101, v2, v3
    v_add_u32 v7, 128, v0
    v_mul_u32_u24 v3, 2731, v7
    v_lshrrev_b32_e64 v3, 16, v3
    v_mul_u32_u24 v3, 2688, v3
    v_add_u32_e64 v102, v2, v3
    buffer_load_dwordx4 v100, s[16:19], s27 offen offset:0 lds
    buffer_load_dwordx4 v101, s[16:19], s27 offen offset:1024 lds
    buffer_load_dwordx4 v102, s[16:19], s27 offen offset:2048 lds
    s_add_u32 m0, m0, 12288
    s_add_u32 s27, s27, 98304
    buffer_load_dwordx4 v100, s[16:19], s27 offen offset:0 lds
    buffer_load_dwordx4 v101, s[16:19], s27 offen offset:1024 lds
    buffer_load_dwordx4 v102, s[16:19], s27 offen offset:2048 lds
    s_add_u32 m0, m0, 12288
    s_add_u32 s27, s27, 98304
    buffer_load_dwordx4 v100, s[16:19], s27 offen offset:0 lds
    buffer_load_dwordx4 v101, s[16:19], s27 offen offset:1024 lds
    buffer_load_dwordx4 v102, s[16:19], s27 offen offset:2048 lds
    s_add_u32 m0, m0, 12288
    s_add_u32 s27, s27, 98304
    buffer_load_dwordx4 v100, s[16:19], s27 offen offset:0 lds
    buffer_load_dwordx4 v101, s[16:19], s27 offen offset:1024 lds
    buffer_load_dwordx4 v102, s[16:19], s27 offen offset:2048 lds
    s_add_u32 m0, m0, 12288
    s_add_u32 s27, s27, 98304
    buffer_load_dwordx4 v100, s[16:19], s27 offen offset:0 lds
    buffer_load_dwordx4 v101, s[16:19], s27 offen offset:1024 lds
    buffer_load_dwordx4 v102, s[16:19], s27 offen offset:2048 lds
    v_bfe_u32 v7, v0, 2, 2
    v_lshl_add_u32 v7, v6, 3, v7
    v_mul_u32_u24 v7, 384, v7
    v_and_b32_e64 v3, 3, v0
    v_lshl_add_u32 v7, v3, 3, v7
    s_mul_i32 s28, s20, 96
    v_add_u32 v7, s28, v7
    s_lshl_b32 s27, s25, 2
    s_add_u32 s27, s27, s20
    s_and_b32 s30, s27, 15
    s_mul_i32 s30, s30, 120
    s_cmp_ge_u32 s27, 16
    s_cselect_b32 s29, 0, 60
    s_add_u32 s30, s30, s29
    s_mul_i32 s29, s26, 15
    s_add_u32 s30, s30, s29
    s_lshl_b32 s30, s30, 10
    s_add_u32 s30, s30, 2621440
    v_mov_b32 v99, 0x3f803f80
    s_waitcnt vmcnt(0)
    s_barrier
    ds_read_b64_tr_b16 v[16:17], v7 offset:0
    ds_read_b64_tr_b16 v[18:19], v7 offset:1536
    ds_read_b64_tr_b16 v[20:21], v7 offset:32
    ds_read_b64_tr_b16 v[22:23], v7 offset:1568
    ds_read_b64_tr_b16 v[24:25], v7 offset:64
    ds_read_b64_tr_b16 v[26:27], v7 offset:1600
    ds_read_b64_tr_b16 v[28:29], v7 offset:12288
    ds_read_b64_tr_b16 v[30:31], v7 offset:13824
    ds_read_b64_tr_b16 v[32:33], v7 offset:12320
    ds_read_b64_tr_b16 v[34:35], v7 offset:13856
    ds_read_b64_tr_b16 v[36:37], v7 offset:12352
    ds_read_b64_tr_b16 v[38:39], v7 offset:13888
    ds_read_b64_tr_b16 v[40:41], v7 offset:24576
    ds_read_b64_tr_b16 v[42:43], v7 offset:26112
    ds_read_b64_tr_b16 v[44:45], v7 offset:24608
    ds_read_b64_tr_b16 v[46:47], v7 offset:26144
    ds_read_b64_tr_b16 v[48:49], v7 offset:24640
    ds_read_b64_tr_b16 v[50:51], v7 offset:26176
    ds_read_b64_tr_b16 v[52:53], v7 offset:36864
    ds_read_b64_tr_b16 v[54:55], v7 offset:38400
    ds_read_b64_tr_b16 v[56:57], v7 offset:36896
    ds_read_b64_tr_b16 v[58:59], v7 offset:38432
    ds_read_b64_tr_b16 v[60:61], v7 offset:36928
    ds_read_b64_tr_b16 v[62:63], v7 offset:38464
    ds_read_b64_tr_b16 v[64:65], v7 offset:49152
    ds_read_b64_tr_b16 v[66:67], v7 offset:50688
    ds_read_b64_tr_b16 v[68:69], v7 offset:49184
    ds_read_b64_tr_b16 v[70:71], v7 offset:50720
    ds_read_b64_tr_b16 v[72:73], v7 offset:49216
    ds_read_b64_tr_b16 v[74:75], v7 offset:50752
    s_waitcnt lgkmcnt(15)
    buffer_store_dwordx4 v[16:19], v2, s[8:11], s30 offen offset:0 sc1
    v_dot2_f32_bf16 v96, v16, v99, 0
    v_dot2_f32_bf16 v96, v17, v99, v96
    v_dot2_f32_bf16 v96, v18, v99, v96
    v_dot2_f32_bf16 v96, v19, v99, v96
    s_waitcnt lgkmcnt(15)
    buffer_store_dwordx4 v[20:23], v2, s[8:11], s30 offen offset:1024 sc1
    v_dot2_f32_bf16 v97, v20, v99, 0
    v_dot2_f32_bf16 v97, v21, v99, v97
    v_dot2_f32_bf16 v97, v22, v99, v97
    v_dot2_f32_bf16 v97, v23, v99, v97
    s_waitcnt lgkmcnt(15)
    buffer_store_dwordx4 v[24:27], v2, s[8:11], s30 offen offset:2048 sc1
    s_add_u32 s30, s30, 3072
    v_dot2_f32_bf16 v98, v24, v99, 0
    v_dot2_f32_bf16 v98, v25, v99, v98
    v_dot2_f32_bf16 v98, v26, v99, v98
    v_dot2_f32_bf16 v98, v27, v99, v98
    s_waitcnt lgkmcnt(15)
    buffer_store_dwordx4 v[28:31], v2, s[8:11], s30 offen offset:0 sc1
    v_dot2_f32_bf16 v96, v28, v99, v96
    v_dot2_f32_bf16 v96, v29, v99, v96
    v_dot2_f32_bf16 v96, v30, v99, v96
    v_dot2_f32_bf16 v96, v31, v99, v96
    s_waitcnt lgkmcnt(15)
    buffer_store_dwordx4 v[32:35], v2, s[8:11], s30 offen offset:1024 sc1
    v_dot2_f32_bf16 v97, v32, v99, v97
    v_dot2_f32_bf16 v97, v33, v99, v97
    v_dot2_f32_bf16 v97, v34, v99, v97
    v_dot2_f32_bf16 v97, v35, v99, v97
    s_waitcnt lgkmcnt(15)
    buffer_store_dwordx4 v[36:39], v2, s[8:11], s30 offen offset:2048 sc1
    s_add_u32 s30, s30, 3072
    v_dot2_f32_bf16 v98, v36, v99, v98
    v_dot2_f32_bf16 v98, v37, v99, v98
    v_dot2_f32_bf16 v98, v38, v99, v98
    v_dot2_f32_bf16 v98, v39, v99, v98
    s_waitcnt lgkmcnt(15)
    buffer_store_dwordx4 v[40:43], v2, s[8:11], s30 offen offset:0 sc1
    v_dot2_f32_bf16 v96, v40, v99, v96
    v_dot2_f32_bf16 v96, v41, v99, v96
    v_dot2_f32_bf16 v96, v42, v99, v96
    v_dot2_f32_bf16 v96, v43, v99, v96
    s_waitcnt lgkmcnt(14)
    buffer_store_dwordx4 v[44:47], v2, s[8:11], s30 offen offset:1024 sc1
    v_dot2_f32_bf16 v97, v44, v99, v97
    v_dot2_f32_bf16 v97, v45, v99, v97
    v_dot2_f32_bf16 v97, v46, v99, v97
    v_dot2_f32_bf16 v97, v47, v99, v97
    s_waitcnt lgkmcnt(12)
    buffer_store_dwordx4 v[48:51], v2, s[8:11], s30 offen offset:2048 sc1
    s_add_u32 s30, s30, 3072
    v_dot2_f32_bf16 v98, v48, v99, v98
    v_dot2_f32_bf16 v98, v49, v99, v98
    v_dot2_f32_bf16 v98, v50, v99, v98
    v_dot2_f32_bf16 v98, v51, v99, v98
    s_waitcnt lgkmcnt(10)
    buffer_store_dwordx4 v[52:55], v2, s[8:11], s30 offen offset:0 sc1
    v_dot2_f32_bf16 v96, v52, v99, v96
    v_dot2_f32_bf16 v96, v53, v99, v96
    v_dot2_f32_bf16 v96, v54, v99, v96
    v_dot2_f32_bf16 v96, v55, v99, v96
    s_waitcnt lgkmcnt(8)
    buffer_store_dwordx4 v[56:59], v2, s[8:11], s30 offen offset:1024 sc1
    v_dot2_f32_bf16 v97, v56, v99, v97
    v_dot2_f32_bf16 v97, v57, v99, v97
    v_dot2_f32_bf16 v97, v58, v99, v97
    v_dot2_f32_bf16 v97, v59, v99, v97
    s_waitcnt lgkmcnt(6)
    buffer_store_dwordx4 v[60:63], v2, s[8:11], s30 offen offset:2048 sc1
    s_add_u32 s30, s30, 3072
    v_dot2_f32_bf16 v98, v60, v99, v98
    v_dot2_f32_bf16 v98, v61, v99, v98
    v_dot2_f32_bf16 v98, v62, v99, v98
    v_dot2_f32_bf16 v98, v63, v99, v98
    s_waitcnt lgkmcnt(4)
    buffer_store_dwordx4 v[64:67], v2, s[8:11], s30 offen offset:0 sc1
    v_dot2_f32_bf16 v96, v64, v99, v96
    v_dot2_f32_bf16 v96, v65, v99, v96
    v_dot2_f32_bf16 v96, v66, v99, v96
    v_dot2_f32_bf16 v96, v67, v99, v96
    s_waitcnt lgkmcnt(2)
    buffer_store_dwordx4 v[68:71], v2, s[8:11], s30 offen offset:1024 sc1
    v_dot2_f32_bf16 v97, v68, v99, v97
    v_dot2_f32_bf16 v97, v69, v99, v97
    v_dot2_f32_bf16 v97, v70, v99, v97
    v_dot2_f32_bf16 v97, v71, v99, v97
    s_waitcnt lgkmcnt(0)
    s_nop 0
    buffer_store_dwordx4 v[72:75], v2, s[8:11], s30 offen offset:2048 sc1
    s_add_u32 s30, s30, 3072
    v_dot2_f32_bf16 v98, v72, v99, v98
    v_dot2_f32_bf16 v98, v73, v99, v98
    v_dot2_f32_bf16 v98, v74, v99, v98
    v_dot2_f32_bf16 v98, v75, v99, v98
    v_mov_b32 v100, v96
    s_nop 1
    v_permlane16_swap_b32 v96, v100
    v_add_f32 v96, v96, v100
    v_mov_b32 v100, v96
    s_nop 1
    v_permlane32_swap_b32 v96, v100
    v_add_f32 v96, v96, v100
    v_mov_b32 v100, v97
    s_nop 1
    v_permlane16_swap_b32 v97, v100
    v_add_f32 v97, v97, v100
    v_mov_b32 v100, v97
    s_nop 1
    v_permlane32_swap_b32 v97, v100
    v_add_f32 v97, v97, v100
    v_mov_b32 v100, v98
    s_nop 1
    v_permlane16_swap_b32 v98, v100
    v_add_f32 v98, v98, v100
    v_mov_b32 v100, v98
    s_nop 1
    v_permlane32_swap_b32 v98, v100
    v_add_f32 v98, v98, v100
    s_mul_i32 s27, s27, 768
    s_lshl_b32 s28, s26, 4
    s_add_u32 s27, s27, s28
    s_add_u32 s27, s27, 5570560
    v_cmp_eq_u32_e64 vcc, 1, v6
    v_cmp_eq_u32 s[30:31], 2, v6
    v_and_b32 v7, 60, v0
    v_lshlrev_b32 v7, 4, v7
    v_lshl_add_u32 v7, v3, 2, v7
    v_cndmask_b32 v96, v96, v97, vcc
    v_cndmask_b32 v96, v96, v98, s[30:31]
    s_mov_b32 exec_hi, 0xffff
    buffer_store_dword v96, v7, s[8:11], s27 offen sc1
    s_mov_b32 exec_hi, -1
    s_branch L_hdone
L_hout:
    s_mov_b32 s16, s62
    s_and_b32 s17, s63, 0xffff
    s_mov_b32 s18, 0xf0000
    s_mov_b32 s19, 0x20000
    s_and_b32 s24, s23, 7
    s_lshr_b32 s25, s23, 3
    s_lshl_b32 s25, s25, 2
    s_add_u32 s25, s25, s20
    s_mul_i32 s30, s25, 43691
    s_lshr_b32 s30, s30, 17
    s_mul_i32 s31, s30, 3
    s_sub_u32 s31, s25, s31
    s_mul_i32 s30, s30, 96
    s_mul_i32 s32, s31, 24
    s_cmp_eq_u32 s31, 1
    s_cselect_b32 s32, 32, s32
    s_cselect_b32 s33, 40960, 0
    s_movk_i32 s34, 640
    s_cmovk_i32 s34, 1280
    s_movk_i32 s79, 2560
    s_cmovk_i32 s79, 640
    s_add_u32 s30, s30, s32
    s_mul_i32 s26, s30, 1280
    s_mul_i32 s27, s24, 160
    s_add_u32 s26, s26, s27
    s_mul_i32 s27, s20, 5120
    s_mov_b32 m0, s27
    v_add_u32 v7, 0, v0
    v_mul_u32_u24 v3, 6554, v7
    v_lshrrev_b32 v3, 16, v3
    v_lshrrev_b32 v15, 4, v3
    v_mul_u32_u24 v3, 1120, v3
    v_lshl_add_u32 v7, v7, 4, v3
    v_mad_u32_u24 v7, v15, s33, v7
    buffer_load_dwordx4 v7, s[16:19], s26 offen lds
    s_add_u32 m0, m0, 1024
    v_add_u32_e64 v7, 64, v0
    v_mul_u32_u24 v3, 6554, v7
    v_lshrrev_b32 v3, 16, v3
    v_lshrrev_b32 v15, 4, v3
    v_mul_u32_u24 v3, 1120, v3
    v_lshl_add_u32 v7, v7, 4, v3
    v_mad_u32_u24 v7, v15, s33, v7
    buffer_load_dwordx4 v7, s[16:19], s26 offen lds
    s_add_u32 m0, m0, 1024
    v_add_u32 v7, 128, v0
    v_mul_u32_u24 v3, 6554, v7
    v_lshrrev_b32 v3, 16, v3
    v_lshrrev_b32 v15, 4, v3
    v_mul_u32_u24 v3, 1120, v3
    v_lshl_add_u32 v7, v7, 4, v3
    v_mad_u32_u24 v7, v15, s33, v7
    buffer_load_dwordx4 v7, s[16:19], s26 offen lds
    s_add_u32 m0, m0, 1024
    v_add_u32 v7, 192, v0
    v_mul_u32_u24 v3, 6554, v7
    v_lshrrev_b32 v3, 16, v3
    v_lshrrev_b32 v15, 4, v3
    v_mul_u32_u24 v3, 1120, v3
    v_lshl_add_u32 v7, v7, 4, v3
    v_mad_u32_u24 v7, v15, s33, v7
    buffer_load_dwordx4 v7, s[16:19], s26 offen lds
    s_add_u32 m0, m0, 1024
    v_add_u32 v7, 256, v0
    v_mul_u32_u24 v3, 6554, v7
    v_lshrrev_b32 v3, 16, v3
    v_lshrrev_b32 v15, 4, v3
    v_mul_u32_u24 v3, 1120, v3
    v_lshl_add_u32 v7, v7, 4, v3
    v_mad_u32_u24 v7, v15, s33, v7
    buffer_load_dwordx4 v7, s[16:19], s26 offen lds
    v_bfe_u32 v56, v0, 2, 2
    v_mul_u32_u24 v56, 160, v56
    v_mad_u32_u24 v56, v6, s34, v56
    v_add_u32 v56, s27, v56
    v_and_b32 v3, 3, v0
    v_lshl_add_u32 v57, v3, 3, v56
    v_lshl_add_u32 v56, v3, 4, v56
    v_add_u32_e64 v58, s79, v56
    v_add_u32 v59, s79, v57
    s_sub_u32 s34, s22, 20
    s_lshl_b32 s34, s34, 18
    s_add_u32 s33, s89, s34
    s_add_u32 s33, s33, 0
    v_lshrrev_b32 v60, 2, v1
    v_lshlrev_b32 v60, 12, v60
    v_and_b32 v61, 3, v1
    v_lshl_add_u32 v60, v61, 7, v60
    buffer_load_dword v61, v60, s[12:15], s33 offen
    s_mul_i32 s28, s25, 43691
    s_lshr_b32 s28, s28, 18
    s_mul_i32 s28, s28, 6
    s_sub_u32 s29, s25, s28
    s_lshl_b32 s29, s29, 2
    s_lshr_b32 s29, 0x352140, s29
    s_and_b32 s29, s29, 15
    s_add_u32 s25, s28, s29
    s_mul_i32 s28, s24, 24
    s_add_u32 s28, s28, s25
    s_mul_i32 s28, s28, 5120
    s_add_u32 s28, s28, 4587520
    s_add_u32 s29, s28, 4096
    s_waitcnt vmcnt(1)
    s_nop 0
    ds_read_b64_tr_b16 v[16:17], v56 offset:0
    ds_read_b64_tr_b16 v[18:19], v58 offset:0
    ds_read_b64_tr_b16 v[20:21], v56 offset:8
    ds_read_b64_tr_b16 v[22:23], v58 offset:8
    ds_read_b64_tr_b16 v[24:25], v56 offset:64
    ds_read_b64_tr_b16 v[26:27], v58 offset:64
    ds_read_b64_tr_b16 v[28:29], v56 offset:72
    ds_read_b64_tr_b16 v[30:31], v58 offset:72
    ds_read_b64_tr_b16 v[32:33], v57 offset:128
    ds_read_b64_tr_b16 v[34:35], v59 offset:128
    s_waitcnt lgkmcnt(8)
    buffer_store_dwordx4 v[16:19], v2, s[8:11], s28 offen offset:0 sc1
    s_waitcnt lgkmcnt(6)
    buffer_store_dwordx4 v[20:23], v2, s[8:11], s28 offen offset:1024 sc1
    s_waitcnt lgkmcnt(4)
    buffer_store_dwordx4 v[24:27], v2, s[8:11], s28 offen offset:2048 sc1
    s_waitcnt lgkmcnt(2)
    buffer_store_dwordx4 v[28:31], v2, s[8:11], s28 offen offset:3072 sc1
    s_waitcnt lgkmcnt(0)
    buffer_store_dwordx4 v[32:35], v2, s[8:11], s29 offen sc1
L_hdone:
    v_and_b32 v7, 3, v0
    v_lshlrev_b32_e64 v7, 6, v7
    v_and_b32 v3, 31, v0
    v_lshlrev_b32 v3, 4, v3
    s_mov_b32 s29, 5964800
    global_load_dword v14, v7, s[66:67] sc1
    s_add_u32 m0, s75, 0
    s_nop 0
    buffer_load_dwordx4 v8, s[12:15], 0 offen offset:0 lds
    buffer_load_dwordx4 v9, s[12:15], 0 offen offset:1024 lds
    buffer_load_dwordx4 v10, s[12:15], 0 offen offset:2048 lds
    buffer_load_dwordx4 v11, s[12:15], 0 offen offset:3072 lds
    s_add_u32 m0, s75, 3968
    s_nop 0
    buffer_load_dwordx4 v8, s[12:15], 0 offen offset:128 lds
    buffer_load_dwordx4 v9, s[12:15], 0 offen offset:1152 lds
    buffer_load_dwordx4 v10, s[12:15], 0 offen offset:2176 lds
    buffer_load_dwordx4 v11, s[12:15], 0 offen offset:3200 lds
    s_add_u32 m0, s75, 7936
    s_nop 0
    buffer_load_dwordx4 v8, s[12:15], 0 offen offset:256 lds
    buffer_load_dwordx4 v9, s[12:15], 0 offen offset:1280 lds
    buffer_load_dwordx4 v10, s[12:15], 0 offen offset:2304 lds
    buffer_load_dwordx4 v11, s[12:15], 0 offen offset:3328 lds
    s_waitcnt vmcnt(12)
    v_cmp_gt_u32 vcc, 16, v14
    s_cbranch_vccnz H1_r
H1_d:
    s_barrier
    s_cmp_lg_u32 s20, 0
    s_cbranch_scc1 L_f1b
    s_lshl_b32 s28, s23, 4
    s_add_u32 s28, s28, 5963776
    s_mov_b64 exec, 1
    buffer_store_dword v0, v0, s[8:11], s28 offen sc1
    s_mov_b64 exec, -1
L_f1b:
L_nt:
    s_add_u32 m0, s75, 11904
    s_nop 0
    buffer_load_dwordx4 v8, s[12:15], 0 offen offset:384 lds
    buffer_load_dwordx4 v9, s[12:15], 0 offen offset:1408 lds
    buffer_load_dwordx4 v10, s[12:15], 0 offen offset:2432 lds
    buffer_load_dwordx4 v11, s[12:15], 0 offen offset:3456 lds
    s_add_u32 m0, s75, 15872
    s_nop 0
    buffer_load_dwordx4 v8, s[12:15], 0 offen offset:512 lds
    buffer_load_dwordx4 v9, s[12:15], 0 offen offset:1536 lds
    buffer_load_dwordx4 v10, s[12:15], 0 offen offset:2560 lds
    buffer_load_dwordx4 v11, s[12:15], 0 offen offset:3584 lds
    s_waitcnt vmcnt(16)
    ds_read_b128 a[0:3], v12 offset:0
    ds_read_b128 a[4:7], v12 offset:2048
    ds_read_b128 a[8:11], v13 offset:0
    ds_read_b128 a[12:15], v13 offset:2048
    s_waitcnt lgkmcnt(0)
    s_add_u32 m0, s75, -640
    s_nop 0
    buffer_load_dwordx4 v8, s[12:15], 0 offen offset:640 lds
    buffer_load_dwordx4 v9, s[12:15], 0 offen offset:1664 lds
    buffer_load_dwordx4 v10, s[12:15], 0 offen offset:2688 lds
    buffer_load_dwordx4 v11, s[12:15], 0 offen offset:3712 lds
    s_waitcnt vmcnt(16)
    ds_read_b128 a[16:19], v12 offset:4096
    ds_read_b128 a[20:23], v12 offset:6144
    ds_read_b128 a[24:27], v13 offset:4096
    ds_read_b128 a[28:31], v13 offset:6144
    s_waitcnt lgkmcnt(0)
    s_add_u32 m0, s75, 3328
    s_nop 0
    buffer_load_dwordx4 v8, s[12:15], 0 offen offset:768 lds
    buffer_load_dwordx4 v9, s[12:15], 0 offen offset:1792 lds
    buffer_load_dwordx4 v10, s[12:15], 0 offen offset:2816 lds
    buffer_load_dwordx4 v11, s[12:15], 0 offen offset:3840 lds
    s_waitcnt vmcnt(16)
    ds_read_b128 a[32:35], v12 offset:8192
    ds_read_b128 a[36:39], v12 offset:10240
    ds_read_b128 a[40:43], v13 offset:8192
    ds_read_b128 a[44:47], v13 offset:10240
    s_waitcnt lgkmcnt(0)
    s_add_u32 m0, s75, 7296
    s_nop 0
    buffer_load_dwordx4 v8, s[12:15], 0 offen offset:896 lds
    buffer_load_dwordx4 v9, s[12:15], 0 offen offset:1920 lds
    buffer_load_dwordx4 v10, s[12:15], 0 offen offset:2944 lds
    buffer_load_dwordx4 v11, s[12:15], 0 offen offset:3968 lds
    s_waitcnt vmcnt(16)
    ds_read_b128 a[48:51], v12 offset:12288
    ds_read_b128 a[52:55], v12 offset:14336
    ds_read_b128 a[56:59], v13 offset:12288
    ds_read_b128 a[60:63], v13 offset:14336
    s_waitcnt lgkmcnt(0)
    v_add_u32 v8, 1024, v8
    v_add_u32 v9, 1024, v9
    v_add_u32 v10, 1024, v10
    v_add_u32 v11, 1024, v11
    s_add_u32 m0, s75, 12288
    s_nop 0
    buffer_load_dwordx4 v8, s[12:15], 0 offen offset:0 lds
    buffer_load_dwordx4 v9, s[12:15], 0 offen offset:1024 lds
    buffer_load_dwordx4 v10, s[12:15], 0 offen offset:2048 lds
    buffer_load_dwordx4 v11, s[12:15], 0 offen offset:3072 lds
    s_waitcnt vmcnt(16)
    ds_read_b128 a[64:67], v12 offset:16384
    ds_read_b128 a[68:71], v12 offset:18432
    ds_read_b128 a[72:75], v13 offset:16384
    ds_read_b128 a[76:79], v13 offset:18432
    s_waitcnt lgkmcnt(0)
    s_add_u32 m0, s75, 16256
    s_nop 0
    buffer_load_dwordx4 v8, s[12:15], 0 offen offset:128 lds
    buffer_load_dwordx4 v9, s[12:15], 0 offen offset:1152 lds
    buffer_load_dwordx4 v10, s[12:15], 0 offen offset:2176 lds
    buffer_load_dwordx4 v11, s[12:15], 0 offen offset:3200 lds
    s_waitcnt vmcnt(16)
    ds_read_b128 a[80:83], v12 offset:0
    ds_read_b128 a[84:87], v12 offset:2048
    ds_read_b128 a[88:91], v13 offset:0
    ds_read_b128 a[92:95], v13 offset:2048
    buffer_load_dword v14, v3, s[8:11], s29 offen sc1
    s_waitcnt lgkmcnt(0)
    s_add_u32 m0, s75, -256
    s_nop 0
    buffer_load_dwordx4 v8, s[12:15], 0 offen offset:256 lds
    buffer_load_dwordx4 v9, s[12:15], 0 offen offset:1280 lds
    buffer_load_dwordx4 v10, s[12:15], 0 offen offset:2304 lds
    buffer_load_dwordx4 v11, s[12:15], 0 offen offset:3328 lds
    s_waitcnt vmcnt(17)
    ds_read_b128 a[96:99], v12 offset:4096
    ds_read_b128 a[100:103], v12 offset:6144
    ds_read_b128 a[104:107], v13 offset:4096
    ds_read_b128 a[108:111], v13 offset:6144
    s_waitcnt lgkmcnt(0)
    s_add_u32 m0, s75, 3712
    s_nop 0
    buffer_load_dwordx4 v8, s[12:15], 0 offen offset:384 lds
    buffer_load_dwordx4 v9, s[12:15], 0 offen offset:1408 lds
    buffer_load_dwordx4 v10, s[12:15], 0 offen offset:2432 lds
    buffer_load_dwordx4 v11, s[12:15], 0 offen offset:3456 lds
    s_waitcnt vmcnt(8)
    v_cmp_eq_u32 vcc, -1, v14
    s_cbranch_vccnz H1b_r
H1b_d:
    s_mul_i32 s27, s71, 122880
    s_mul_i32 s25, s20, 15360
    s_add_u32 s27, s27, s25
    s_add_u32 s27, s27, 2621440
    s_mul_i32 s26, s20, 17408
    s_mov_b32 m0, s26
    s_lshl_b32 s24, s20, 12
    buffer_load_dwordx4 v2, s[8:11], s27 offen offset:0 sc1 lds
    buffer_load_dwordx4 v2, s[8:11], s27 offen offset:1024 sc1 lds
    buffer_load_dwordx4 v2, s[8:11], s27 offen offset:2048 sc1 lds
    buffer_load_dwordx4 v2, s[8:11], s27 offen offset:3072 sc1 lds
    s_add_u32 m0, m0, 4096
    s_add_u32 s27, s27, 4096
    buffer_load_dwordx4 v2, s[8:11], s27 offen offset:0 sc1 lds
    buffer_load_dwordx4 v2, s[8:11], s27 offen offset:1024 sc1 lds
    buffer_load_dwordx4 v2, s[8:11], s27 offen offset:2048 sc1 lds
    buffer_load_dwordx4 v2, s[8:11], s27 offen offset:3072 sc1 lds
    ds_read_b128 a[112:115], v12 offset:8192
    ds_read_b128 a[116:119], v12 offset:10240
    ds_read_b128 a[120:123], v13 offset:8192
    ds_read_b128 a[124:127], v13 offset:10240
    ds_read_b128 a[128:131], v12 offset:12288
    ds_read_b128 a[132:135], v12 offset:14336
    ds_read_b128 a[136:139], v13 offset:12288
    ds_read_b128 a[140:143], v13 offset:14336
    ds_read_b128 a[144:147], v12 offset:16384
    ds_read_b128 a[148:151], v12 offset:18432
    ds_read_b128 a[152:155], v13 offset:16384
    ds_read_b128 a[156:159], v13 offset:18432
    s_waitcnt vmcnt(12)
    ds_read_b128 a[160:163], v12 offset:0
    ds_read_b128 a[164:167], v12 offset:2048
    ds_read_b128 a[168:171], v13 offset:0
    ds_read_b128 a[172:175], v13 offset:2048
    s_waitcnt vmcnt(8)
    ds_read_b128 a[176:179], v12 offset:4096
    ds_read_b128 a[180:183], v12 offset:6144
    ds_read_b128 a[184:187], v13 offset:4096
    ds_read_b128 a[188:191], v13 offset:6144
    s_waitcnt lgkmcnt(0)
    s_barrier
    s_add_u32 m0, s24, 69632
    s_add_u32 s27, s27, 4096
    buffer_load_dwordx4 v2, s[8:11], s27 offen offset:0 sc1 lds
    buffer_load_dwordx4 v2, s[8:11], s27 offen offset:1024 sc1 lds
    buffer_load_dwordx4 v2, s[8:11], s27 offen offset:2048 sc1 lds
    buffer_load_dwordx4 v2, s[8:11], s27 offen offset:3072 sc1 lds
    s_mov_b64 exec, 0
    s_cmp_eq_u32 s20, 1
    s_cbranch_scc1 L_pg4
    s_cmp_eq_u32 s20, 2
    s_cbranch_scc1 L_pg5
    s_cmp_eq_u32 s20, 3
    s_cbranch_scc1 L_pg8
L_w2:
    s_mov_b64 exec, -1
    s_lshl_b32 s34, s2, 7
    s_add_u32 s34, s34, 5967872
    s_branch L_common
H1_r:
    s_mov_b32 s35, 0x3ffff
H1_l:
    s_sleep 8
    global_load_dword v14, v7, s[66:67] sc1
    s_waitcnt vmcnt(0)
    v_cmp_gt_u32 vcc, 16, v14
    s_cbranch_vccz H1_x
    s_sub_u32 s35, s35, 1
    s_cbranch_scc0 H1_l
H1_x:
    s_branch H1_d
H1b_r:
    s_mov_b32 s35, 0x3ffff
H1b_l:
    s_sleep 4
    buffer_load_dword v14, v3, s[8:11], s29 offen sc1
    s_waitcnt vmcnt(0)
    v_cmp_eq_u32 vcc, -1, v14
    s_cbranch_vccz H1b_x
    s_sub_u32 s35, s35, 1
    s_cbranch_scc0 H1b_l
H1b_x:
    s_branch H1b_d
.p2align 8
.fill 3072, 4, 0xbf800000
.section .rodata,"a"
.p2align 6
.amdhsa_kernel sequential_preLN__ssm_conv_s4__mixer_gmlp__prompt_kernel
  .amdhsa_next_free_vgpr 512
  .amdhsa_next_free_sgpr 102
  .amdhsa_accum_offset 256
  .amdhsa_group_segment_fixed_size 0
  .amdhsa_kernarg_size 136
  .amdhsa_user_sgpr_count 2
  .amdhsa_user_sgpr_kernarg_segment_ptr 1
  .amdhsa_system_sgpr_workgroup_id_x 1
  .amdhsa_float_denorm_mode_32 3
.end_amdhsa_kernel
```
